```python
import torch

def _softmax(x, axis=-1):
    return torch.softmax(x, dim=axis)
def _gelu(x):
    return torch.nn.functional.gelu(x, approximate="tanh")
def _silu(x):
    return torch.nn.functional.silu(x)
def _sigmoid(x):
    return torch.sigmoid(x)
def _layernorm(x, axis=-1, eps=1e-5):
    m = x.mean(dim=axis, keepdim=True)
    v = x.var(dim=axis, keepdim=True, unbiased=False)
    return (x - m) / torch.sqrt(v + eps)
def _scatter_add(tgt, idx, src, axis=0):
    return tgt.clone().index_add_(axis, idx, src)
def _segment_sum(src, seg, n):
    out = torch.zeros((n,) + src.shape[1:], dtype=src.dtype)
    return out.index_add_(0, seg, src)
def _pad(x, pw):
    flat = tuple(v for pair in reversed(pw) for v in pair)
    return torch.nn.functional.pad(x, flat)

kernel_name = 'interleave_layers__ssm_conv_h3__glu_gated_glu__prompt'

def setup_inputs():

    _w = (lambda a: (lambda t: t.to(torch.bfloat16) if t.is_floating_point() else t)(torch.as_tensor(a)))
    def _A_setup():
        B, S, D = 1, 2048, 512
        ks = 4
        return {
            "q": _w((lambda *s: torch.randn(*s, dtype=torch.bfloat16) * 0.05)(B, S, D)),
            "k": _w((lambda *s: torch.randn(*s, dtype=torch.bfloat16) * 0.4)(B, S, D)),
            "v": _w((lambda *s: torch.randn(*s, dtype=torch.bfloat16) * 0.4)(B, S, D)),
            "shift_k": _w((lambda *s: torch.randn(*s, dtype=torch.bfloat16) * 0.4)(D, ks) * 0.5),
            "ssm_k": _w((lambda *s: torch.randn(*s, dtype=torch.bfloat16) * 0.4)(D, S) * (1.0 / S ** 0.5)),
            "ssm_D": _w((lambda *s: torch.randn(*s, dtype=torch.bfloat16) * 0.4)(D)),
        }
    _A_in = _A_setup()

    def _B_setup():
        B, S, D, F = 1, 2048, 512, 1792
        return {
            "x": _w((lambda *s: torch.randn(*s, dtype=torch.bfloat16) * 0.05)(B, S, D)),
            "w_gate": _w((lambda *s: torch.randn(*s, dtype=torch.bfloat16) * 0.05)(D, F)),
            "w_up": _w((lambda *s: torch.randn(*s, dtype=torch.bfloat16) * 0.05)(D, F)),
            "w_down": _w((lambda *s: torch.randn(*s, dtype=torch.bfloat16) * 0.05)(F, D)),
        }
    _B_in = _B_setup()

    return {
        "A_q": _A_in["q"],
        "A_k": _A_in["k"],
        "A_v": _A_in["v"],
        "A_shift_k": _A_in["shift_k"],
        "A_ssm_k": _A_in["ssm_k"],
        "A_ssm_D": _A_in["ssm_D"],
        "B_x": _B_in["x"],
        "B_w_gate": _B_in["w_gate"],
        "B_w_up": _B_in["w_up"],
        "B_w_down": _B_in["w_down"],
    }

def reference(A_q, A_k, A_v, A_shift_k, A_ssm_k, A_ssm_D, B_x, B_w_gate, B_w_up, B_w_down):
    def _A_ref(q, k, v, shift_k, ssm_k, ssm_D):
        B, S, D = q.shape
        ks = shift_k.shape[-1]
        k_pad = _pad(k, ((0, 0), (ks - 1, 0), (0, 0)))
        k_shift = torch.zeros_like(k)
        for t in range(ks):
            k_shift = k_shift + k_pad[:, t:t + S, :] * shift_k[:, ks - 1 - t][None, None, :]
        kv = k_shift * v
        L = 2 * S
        kv_pad = _pad(kv, ((0, 0), (0, S), (0, 0)))
        kf_pad = _pad(ssm_k, ((0, 0), (0, S)))
        kv_f = (lambda x, axes=(-2,-1): torch.fft.rfft2(x.float(), dim=axes))(kv_pad[:, None, :, :], axes=(1, 2))
        kf_f = (lambda x, axes=(-2,-1): torch.fft.rfft2(x.float(), dim=axes))(kf_pad[:, None, :], axes=(1, 2))
        kf_f = (lambda x, *d: x.permute(*d))(kf_f, 1, 2, 0)
        y_f = kv_f * kf_f[None, :, :, :]
        y = (lambda x, s, axes=(-2,-1): torch.fft.irfft2(x, s=s, dim=axes).to(torch.bfloat16))(y_f, (1, L), axes=(1, 2))[:, 0, :S, :]
        y = y + kv * ssm_D[None, None, :]
        return q * y

    def _B_ref(x, w_gate, w_up, w_down):
        g = torch.einsum("bsd,df->bsf", x, w_gate)
        u = torch.einsum("bsd,df->bsf", x, w_up)
        h = _sigmoid(g) * u
        return torch.einsum("bsf,fd->bsd", h, w_down)

    x = A_q
    x = x + _A_ref(_layernorm(x, axis=-1), A_k, A_v, A_shift_k, A_ssm_k, A_ssm_D)
    x = x + _B_ref(_layernorm(x, axis=-1), B_w_gate, B_w_up, B_w_down)
    x = x + _A_ref(_layernorm(x, axis=-1), A_k, A_v, A_shift_k, A_ssm_k, A_ssm_D)
    x = x + _B_ref(_layernorm(x, axis=-1), B_w_gate, B_w_up, B_w_down)
    return x
```

```asm
; @launch grid=(256,1,1) block=(256,1,1) lds=163840
.amdgcn_target "amdgcn-amd-amdhsa--gfx950"
.text
.globl interleave_layers__ssm_conv_h3__glu_gated_glu__prompt_kernel
.p2align 8
.type interleave_layers__ssm_conv_h3__glu_gated_glu__prompt_kernel,@function
interleave_layers__ssm_conv_h3__glu_gated_glu__prompt_kernel:
    s_cmp_ge_u32 s2, 256
    s_cbranch_scc1 L_end
    s_load_dwordx2 s[52:53], s[0:1], 8
    s_load_dwordx2 s[64:65], s[0:1], 16
    s_load_dwordx2 s[4:5], s[0:1], 96
    s_load_dwordx8 s[56:63], s[0:1], 24
    s_load_dwordx8 s[68:75], s[0:1], 56
    s_load_dwordx2 s[8:9], s[0:1], 0
    v_lshrrev_b32 v20, 6, v0
    v_and_b32 v8, 63, v0
    s_and_b32 s88, s2, 7
    s_lshr_b32 s89, s2, 3
    v_readfirstlane_b32 s16, v20
    v_lshlrev_b32 v1, 4, v8
    v_lshrrev_b32 v21, 3, v8
    v_and_b32 v22, 7, v8
    s_lshl_b32 s84, s88, 6
    s_lshl_b32 s24, s89, 1
    s_add_u32 s84, s84, s24
    s_lshl_b32 s24, s88, 9
    s_lshl_b32 s25, s16, 7
    s_add_u32 s24, s24, s25
    v_lshlrev_b32 v30, 4, v21
    v_add_u32 v30, s24, v30
    s_lshr_b32 s24, s2, 2
    s_and_b32 s25, s2, 3
    s_mul_i32 s26, s24, 28672
    s_mul_i32 s27, s25, 896
    s_add_u32 s26, s26, s27
    v_mul_u32_u24 v224, 3584, v21
    v_lshl_add_u32 v224, v22, 4, v224
    v_add_u32 v224, s26, v224
    v_lshlrev_b32 v225, 10, v21
    v_lshl_add_u32 v225, v22, 4, v225
    s_and_b32 s25, s16, 1
    s_lshl_b32 s26, s2, 13
    s_lshl_b32 s27, s25, 9
    s_add_u32 s26, s26, s27
    v_add_u32 v225, s26, v225
    s_mul_i32 s26, s25, 11264
    s_add_u32 s94, s26, 98304
    v_lshlrev_b32 v33, 12, v21
    v_lshl_add_u32 v33, v22, 4, v33
    v_mov_b32 v36, -1
    v_mov_b32 v37, -1
    v_mov_b32 v38, -1
    v_mov_b32 v39, -1
    s_lshl_b32 s95, s88, 18
    s_lshl_b32 s27, s89, 7
    s_sub_u32 s95, s95, s27
    s_lshl_b32 s27, s16, 16
    s_add_u32 s95, s95, s27
    s_add_u32 s95, s95, 1052544
    s_cmp_eq_u32 s16, 3
    s_cbranch_scc1 L_w3
    v_lshlrev_b32 v32, 10, v21
    v_lshl_add_u32 v32, v22, 4, v32
    s_lshl_b32 s24, s89, 16
    s_lshl_b32 s25, s88, 7
    s_add_u32 s24, s24, s25
    v_add_u32 v32, s24, v32
    s_cmp_eq_u32 s16, 2
    s_cbranch_scc1 L_w2
    s_cmp_eq_u32 s16, 1
    s_cbranch_scc1 L_w1
    v_add_u32 v40, 0xfffff000, v32
    v_add_u32 v41, 0x1000, v32
    v_add_u32 v42, 0x3000, v32
    v_add_u32 v43, 0x5000, v32
    v_add_u32 v44, 0x7000, v32
    v_add_u32 v45, 0x9000, v32
    s_waitcnt lgkmcnt(0)
    s_load_dword s63, s[4:5], 0
    s_and_b32 s5, s5, 0xffff
    s_mov_b32 s6, 23068672
    s_mov_b32 s7, 0x20000
    buffer_store_dwordx4 v[36:39], v33, s[4:7], s95 offen sc1
    s_add_u32 s95, s95, 32768
    buffer_store_dwordx4 v[36:39], v33, s[4:7], s95 offen sc1
    s_and_b32 s53, s53, 0xffff
    s_mov_b32 s54, 2097152
    s_mov_b32 s55, 0x20000
    s_mov_b32 m0, 65536
    s_nop 0
    buffer_load_dwordx4 v40, s[52:55], 0 offen nt lds
    s_mov_b32 m0, 66592
    s_nop 0
    buffer_load_dwordx4 v41, s[52:55], 0 offen nt lds
    s_mov_b32 m0, 67648
    s_nop 0
    buffer_load_dwordx4 v42, s[52:55], 0 offen nt lds
    s_mov_b32 m0, 68704
    s_nop 0
    buffer_load_dwordx4 v43, s[52:55], 0 offen nt lds
    s_mov_b32 m0, 69760
    s_nop 0
    buffer_load_dwordx4 v44, s[52:55], 0 offen nt lds
    s_mov_b32 m0, 70816
    s_nop 0
    buffer_load_dwordx4 v45, s[52:55], 0 offen nt lds
    s_branch L_w01
L_w1:
    v_add_u32 v40, 0xb000, v32
    v_add_u32 v41, 0xd000, v32
    v_add_u32 v42, 0xf000, v32
    v_add_u32 v43, 0xfffffc00, v32
    v_add_u32 v44, 0x1c00, v32
    v_add_u32 v45, 0x3c00, v32
    s_waitcnt lgkmcnt(0)
    s_load_dword s63, s[4:5], 0
    s_and_b32 s5, s5, 0xffff
    s_mov_b32 s6, 23068672
    s_mov_b32 s7, 0x20000
    buffer_store_dwordx4 v[36:39], v33, s[4:7], s95 offen sc1
    s_add_u32 s95, s95, 32768
    buffer_store_dwordx4 v[36:39], v33, s[4:7], s95 offen sc1
    s_and_b32 s53, s53, 0xffff
    s_mov_b32 s54, 2097152
    s_mov_b32 s55, 0x20000
    s_and_b32 s65, s65, 0xffff
    s_mov_b32 s66, 2097152
    s_mov_b32 s67, 0x20000
    s_mov_b32 m0, 71872
    s_nop 0
    buffer_load_dwordx4 v40, s[52:55], 0 offen nt lds
    s_mov_b32 m0, 72928
    s_nop 0
    buffer_load_dwordx4 v41, s[52:55], 0 offen nt lds
    s_mov_b32 m0, 73984
    s_nop 0
    buffer_load_dwordx4 v42, s[52:55], 0 offen nt lds
    s_mov_b32 m0, 75040
    s_nop 0
    buffer_load_dwordx4 v43, s[64:67], 0 offen nt lds
    s_mov_b32 m0, 76096
    s_nop 0
    buffer_load_dwordx4 v44, s[64:67], 0 offen nt lds
    s_mov_b32 m0, 77152
    s_nop 0
    buffer_load_dwordx4 v45, s[64:67], 0 offen nt lds
L_w01:
    global_load_dwordx4 v[56:59], v30, s[56:57]
    s_mov_b32 s76, s58
    s_mov_b32 s77, s59
    s_and_b32 s77, s77, 0xffff
    s_mov_b32 s78, 2097152
    s_mov_b32 s79, 0x20000
    s_add_u32 s24, s84, s16
    s_lshl_b32 s24, s24, 12
    s_mul_i32 s25, s16, 16640
    s_add_u32 s26, s24, 4
    s_add_u32 m0, s25, 64
    s_nop 0
    buffer_load_dwordx4 v1, s[76:79], s26 offen lds
    buffer_load_dwordx4 v1, s[76:79], s26 offen offset:1024 lds
    buffer_load_dwordx4 v1, s[76:79], s26 offen offset:2048 lds
    buffer_load_dwordx4 v1, s[76:79], s26 offen offset:3072 lds
    s_branch L_join
L_w2:
    v_add_u32 v40, 0x5c00, v32
    v_add_u32 v41, 0x7c00, v32
    v_add_u32 v42, 0x9c00, v32
    v_add_u32 v43, 0xbc00, v32
    v_add_u32 v44, 0xdc00, v32
    v_add_u32 v45, 0xfc00, v32
    s_waitcnt lgkmcnt(0)
    s_load_dword s63, s[4:5], 0
    s_and_b32 s5, s5, 0xffff
    s_mov_b32 s6, 23068672
    s_mov_b32 s7, 0x20000
    buffer_store_dwordx4 v[36:39], v33, s[4:7], s95 offen sc1
    s_add_u32 s95, s95, 32768
    buffer_store_dwordx4 v[36:39], v33, s[4:7], s95 offen sc1
    s_and_b32 s65, s65, 0xffff
    s_mov_b32 s66, 2097152
    s_mov_b32 s67, 0x20000
    s_mov_b32 m0, 78208
    s_nop 0
    buffer_load_dwordx4 v40, s[64:67], 0 offen nt lds
    s_mov_b32 m0, 79264
    s_nop 0
    buffer_load_dwordx4 v41, s[64:67], 0 offen nt lds
    s_mov_b32 m0, 80320
    s_nop 0
    buffer_load_dwordx4 v42, s[64:67], 0 offen nt lds
    s_mov_b32 m0, 81376
    s_nop 0
    buffer_load_dwordx4 v43, s[64:67], 0 offen nt lds
    s_mov_b32 m0, 82432
    s_nop 0
    buffer_load_dwordx4 v44, s[64:67], 0 offen nt lds
    s_mov_b32 m0, 83488
    s_nop 0
    buffer_load_dwordx4 v45, s[64:67], 0 offen nt lds
    global_load_dwordx4 v[56:59], v30, s[56:57]
    s_branch L_w23
L_w3:
    s_waitcnt lgkmcnt(0)
    s_mov_b32 s68, s70
    s_mov_b32 s69, s71
    s_load_dword s63, s[4:5], 0
    s_and_b32 s5, s5, 0xffff
    s_mov_b32 s6, 23068672
    s_mov_b32 s7, 0x20000
    buffer_store_dwordx4 v[36:39], v33, s[4:7], s95 offen sc1
    s_add_u32 s95, s95, 32768
    buffer_store_dwordx4 v[36:39], v33, s[4:7], s95 offen sc1
    global_load_dwordx4 v[56:59], v30, s[56:57]
L_w23:
    s_and_b32 s69, s69, 0xffff
    s_mov_b32 s70, 1835008
    s_mov_b32 s71, 0x20000
    s_mov_b32 s52, s72
    s_mov_b32 s53, s73
    s_and_b32 s53, s53, 0xffff
    s_mov_b32 s54, 1835008
    s_mov_b32 s55, 0x20000
L_join:
    s_and_b32 s5, s5, 0xffff
    s_mov_b32 s6, 23068672
    s_mov_b32 s7, 0x20000
    s_lshr_b32 s85, s84, 1
    s_mov_b32 s76, s58
    s_mov_b32 s77, s59
    s_and_b32 s77, s77, 0xffff
    s_mov_b32 s78, 2097152
    s_mov_b32 s79, 0x20000
    s_lshl_b32 s24, s84, 1
    s_load_dword s62, s[60:61], s24
    v_and_b32 v23, 31, v0
    v_lshrrev_b32 v24, 7, v0
    v_bfe_u32 v25, v0, 5, 2
    v_lshl_add_u32 v26, v25, 1, v23
    v_add_u32 v26, -30, v26
    v_add_u32 v27, s84, v24
    v_lshlrev_b32 v27, 12, v27
    v_lshl_add_u32 v27, v26, 1, v27
    v_cmp_gt_i32 vcc, 0, v26
    v_mov_b32 v31, -16
    v_mul_u32_u24 v61, 16640, v24
    v_cndmask_b32 v27, v27, v31, vcc
    buffer_load_ushort v60, v27, s[76:79], 0 offen
    v_mul_u32_u24 v31, 4160, v25
    v_add_u32 v61, v61, v31
    v_lshl_add_u32 v61, v23, 1, v61
    s_getpc_b64 s[32:33]
L_pc:
    s_lshl_b32 s24, s89, 2
    s_add_u32 s24, s24, s16
    s_nop 0
    s_lshl_b32 s24, s24, 9
    v_and_b32 v31, 3, v8
    v_lshlrev_b32 v31, 7, v31
    v_add_u32 v31, s24, v31
    v_min_u32 v31, L_codeend-L_pc-64, v31
    global_load_dword v255, v31, s[32:33]
    s_mov_b32 s12, s74
    s_mov_b32 s13, s75
    s_and_b32 s17, s89, 15
    s_lshr_b32 s24, s89, 4
    s_lshl_b32 s24, s24, 3
    s_add_u32 s18, s88, s24
    s_lshr_b32 s19, s17, 3
    s_and_b32 s20, s17, 7
    v_and_b32 v20, 7, v8
    v_bfe_u32 v21, v8, 3, 1
    v_lshrrev_b32 v22, 4, v8
    v_lshlrev_b32 v9, 10, v20
    v_lshl_add_u32 v9, v22, 5, v9
    v_lshl_add_u32 v9, v21, 4, v9
    s_lshl_b32 s24, s18, 7
    s_lshl_b32 s25, s17, 3
    s_add_u32 s24, s24, s25
    s_lshl_b32 s24, s24, 10
    s_lshl_b32 s25, s16, 8
    s_add_u32 s87, s24, s25
    s_and_b32 s9, s9, 0xffff
    s_mov_b32 s10, 2097152
    s_mov_b32 s11, 0x20000
    s_getreg_b32 s22, hwreg(HW_REG_XCC_ID, 0, 4)
    s_lshl_b32 s23, s16, 13
    s_mul_i32 s39, s17, 229376
    s_add_u32 s39, s39, s23
    s_add_u32 s39, s39, 7340032
    s_and_b32 s13, s13, 0xffff
    s_mov_b32 s14, 2097152
    s_mov_b32 s15, 0x20000
    s_mov_b32 s31, 0xffff0000
    s_mov_b32 s98, 0x3f317218
    s_mov_b32 s99, 0x3f317218
    s_mov_b32 s21, 1
    s_and_b32 s22, s22, 7
    v_add_u32 v2, 65536, v1
    v_add_u32 v3, 131072, v1
    v_lshlrev_b32 v4, 2, v20
    v_and_b32 v5, 15, v8
    v_lshlrev_b32 v5, 2, v5
    v_mov_b32 v6, 2147483648
    v_cmp_eq_u32 vcc, 0, v8
    v_mov_b32 v31, 0
    s_lshr_b32 s30, s17, 2
    s_and_b32 s24, s17, 3
    v_cndmask_b32 v6, v6, v31, vcc
    s_lshl_b32 s25, s24, 7
    v_lshlrev_b32 v7, 10, v22
    v_lshl_add_u32 v7, v21, 9, v7
    v_lshl_add_u32 v7, v20, 4, v7
    v_add_u32 v7, s25, v7
    v_lshlrev_b32 v12, 5, v20
    v_add_u32 v12, 57344, v12
    v_and_b32 v31, 1, v22
    v_lshl_add_u32 v11, v31, 2, v12
    s_lshl_b32 s25, s16, 3
    v_add_u32 v11, s25, v11
    v_lshlrev_b32 v10, 12, v22
    v_lshl_add_u32 v10, v21, 11, v10
    v_lshl_add_u32 v10, v20, 2, v10
    s_lshl_b32 s25, s88, 18
    s_lshr_b32 s26, s18, 3
    s_lshl_b32 s26, s26, 17
    s_add_u32 s25, s25, s26
    s_lshl_b32 s26, s30, 15
    s_add_u32 s34, s25, s26
    s_lshl_b32 s26, s16, 13
    s_add_u32 s34, s34, s26
    s_lshl_b32 s26, s16, 15
    s_add_u32 s35, s25, s26
    s_lshl_b32 s26, s18, 2
    s_add_u32 s27, s26, s16
    s_mul_i32 s27, s27, 114688
    s_lshr_b32 s28, s17, 2
    s_mul_i32 s28, s28, 28
    s_and_b32 s29, s17, 3
    s_add_u32 s28, s28, s29
    s_lshl_b32 s28, s28, 10
    s_add_u32 s36, s27, s28
    s_lshl_b32 s27, s19, 1
    s_add_u32 s27, s27, s26
    s_mul_i32 s27, s27, 114688
    s_mul_i32 s28, s16, 28672
    s_add_u32 s37, s27, s28
    s_and_b32 s26, s16, 1
    s_lshl_b32 s26, s26, 1
    s_lshr_b32 s27, s16, 1
    s_add_u32 s26, s26, s27
    s_lshl_b32 s27, s20, 2
    s_add_u32 s26, s26, s27
    s_lshl_b32 s27, s26, 10
    s_lshl_b32 s28, s19, 16
    s_add_u32 s27, s27, s28
    s_add_u32 s38, s27, s25
    s_lshl_b32 s25, s18, 8
    s_lshl_b32 s27, s30, 6
    s_add_u32 s27, s27, s25
    s_lshl_b32 s28, s24, 4
    s_add_u32 s27, s27, s28
    s_lshl_b32 s28, s16, 2
    s_add_u32 s40, s27, s28
    s_lshl_b32 s27, s16, 6
    s_add_u32 s41, s25, s27
    s_lshl_b32 s25, s18, 10
    s_lshr_b32 s27, s16, 1
    s_lshl_b32 s27, s27, 7
    s_add_u32 s27, s27, s25
    s_lshl_b32 s29, s17, 3
    s_add_u32 s27, s27, s29
    s_and_b32 s29, s16, 1
    s_lshl_b32 s29, s29, 2
    s_add_u32 s42, s27, s29
    s_lshl_b32 s27, s19, 7
    s_add_u32 s27, s27, s25
    s_lshl_b32 s29, s16, 5
    s_add_u32 s43, s27, s29
    s_lshl_b32 s25, s18, 9
    s_lshl_b32 s27, s19, 7
    s_add_u32 s27, s27, s25
    s_lshl_b32 s29, s20, 4
    s_add_u32 s27, s27, s29
    s_add_u32 s44, s27, s28
    s_lshr_b32 s27, s30, 1
    s_lshl_b32 s27, s27, 7
    s_add_u32 s27, s27, s25
    s_lshl_b32 s29, s16, 5
    s_add_u32 s45, s27, s29
    s_add_u32 s40, s40, 32768
    s_add_u32 s41, s41, 32768
    s_add_u32 s42, s42, 40960
    s_add_u32 s43, s43, 40960
    s_add_u32 s44, s44, 73728
    s_add_u32 s45, s45, 73728
    s_mul_i32 s25, s16, 6144
    s_add_u32 s25, s25, 32768
    v_add_u32 v16, s25, v1
    s_xor_b32 s25, s16, 1
    s_mul_i32 s25, s25, 6144
    s_add_u32 s25, s25, 32768
    v_add_u32 v13, s25, v1
    s_xor_b32 s25, s16, 2
    s_mul_i32 s25, s25, 6144
    s_add_u32 s25, s25, 34816
    v_add_u32 v14, s25, v1
    s_xor_b32 s25, s16, 3
    s_mul_i32 s25, s25, 6144
    s_add_u32 s25, s25, 36864
    v_add_u32 v15, s25, v1
    s_lshl_b32 s30, s20, 2
    s_add_u32 s30, s30, s16
    s_mul_i32 s30, s30, 57344
    s_add_u32 s30, s30, 11534336
    s_lshr_b32 s25, s16, 1
    s_lshl_b32 s25, s25, 8
    v_xor_b32 v31, s25, v1
    s_and_b32 s25, s16, 1
    s_lshl_b32 s25, s25, 10
    v_add_u32 v28, s25, v31
    s_xor_b32 s25, s25, 1024
    v_add_u32 v29, s25, v31
    s_waitcnt lgkmcnt(0)
    s_mul_i32 s51, s63, 0x9e3779b1
    s_add_u32 s51, s51, 0x7f4a7c15
    s_and_b32 s51, s51, 0xfffffff0
    s_or_b32 s22, s22, s51
    v_mov_b32 v18, s51
    s_and_b32 s86, s2, 63
    s_lshl_b32 s86, s86, 7
    s_lshr_b32 s24, s2, 6
    s_lshl_b32 s24, s24, 2
    s_add_u32 s86, s86, s24
    s_lshl_b32 s24, s17, 1
    v_add_u32 v20, s24, v8
    v_min_u32 v20, 23, v20
    v_lshrrev_b32 v21, 1, v20
    v_and_b32 v22, 1, v20
    v_lshlrev_b32 v21, 12, v21
    v_lshl_add_u32 v21, v22, 7, v21
    s_lshl_b32 s24, s18, 8
    s_add_u32 s24, s24, 32768
    v_add_u32 v21, s24, v21
    v_subrev_u32 v22, 4, v20
    v_lshrrev_b32 v23, 3, v22
    v_and_b32 v22, 7, v22
    v_lshlrev_b32 v23, 14, v23
    v_lshl_add_u32 v23, v22, 7, v23
    s_lshl_b32 s24, s18, 10
    s_add_u32 s24, s24, 40960
    v_add_u32 v23, s24, v23
    v_cmp_lt_u32 vcc, 3, v20
    s_nop 1
    v_cndmask_b32 v21, v21, v23, vcc
    v_subrev_u32 v22, 20, v20
    v_lshlrev_b32 v22, 7, v22
    s_lshl_b32 s24, s18, 9
    s_add_u32 s24, s24, 73728
    v_add_u32 v22, s24, v22
    v_cmp_lt_u32 vcc, 19, v20
    s_nop 1
    v_cndmask_b32 v21, v21, v22, vcc
    v_cmp_lt_u32 vcc, 1, v8
    v_mov_b32 v22, 2147483648
    s_nop 0
    v_cndmask_b32 v231, v21, v22, vcc
    s_cmp_eq_u32 s16, 3
    s_cselect_b32 s28, 256, 0
    s_cselect_b32 s29, 4, 0
    s_lshr_b32 s24, s2, 2
    s_and_b32 s25, s2, 3
    v_bfe_u32 v20, v8, 2, 2
    v_lshlrev_b32 v226, 7, v20
    v_lshrrev_b32 v21, 4, v8
    v_lshl_add_u32 v226, v21, 5, v226
    v_and_b32 v20, 3, v8
    v_lshl_add_u32 v226, v20, 3, v226
    v_add_u32 v226, s94, v226
    v_and_b32 v20, 3, v8
    v_bfe_u32 v23, v8, 2, 1
    v_lshl_or_b32 v20, v23, 3, v20
    v_bfe_u32 v23, v8, 3, 1
    v_lshl_or_b32 v20, v23, 2, v20
    v_lshlrev_b32 v20, 4, v20
    v_lshl_add_u32 v227, v21, 15, v20
    s_mul_i32 s26, s25, 917504
    s_lshr_b32 s27, s24, 1
    s_lshl_b32 s27, s27, 10
    s_add_u32 s26, s26, s27
    s_and_b32 s27, s24, 1
    s_lshl_b32 s27, s27, 9
    s_add_u32 s26, s26, s27
    s_add_u32 s26, s26, s28
    s_add_u32 s64, s26, 7340032
    v_lshrrev_b32 v23, 1, v21
    v_lshl_add_u32 v228, v23, 10, v20
    v_and_b32 v23, 1, v21
    v_lshl_add_u32 v228, v23, 8, v228
    s_lshr_b32 s24, s2, 1
    s_mul_i32 s25, s24, 2341
    s_lshr_b32 s25, s25, 16
    s_mul_i32 s26, s25, 28
    s_sub_u32 s26, s24, s26
    s_mul_i32 s25, s25, 57344
    s_lshl_b32 s26, s26, 11
    s_add_u32 s25, s25, s26
    s_and_b32 s26, s2, 1
    s_lshl_b32 s26, s26, 9
    s_add_u32 s25, s25, s26
    s_mul_i32 s26, s29, 229376
    s_add_u32 s25, s25, s26
    s_add_u32 s25, s25, 11534336
    s_cmp_ge_u32 s2, 224
    s_cselect_b32 s65, 0xf0000000, s25
    v_lshrrev_b32 v229, 5, v8
    v_and_b32 v20, 31, v8
    v_lshlrev_b32 v229, 17, v229
    v_lshl_add_u32 v229, v20, 4, v229
    s_lshl_b32 s24, s85, 9
    s_lshl_b32 s25, s29, 18
    s_add_u32 s24, s24, s25
    s_add_u32 s66, s24, 5242880
    s_lshl_b32 s24, s2, 1
    s_and_b32 s25, s16, 1
    s_add_u32 s24, s24, s25
    s_and_b32 s25, s24, 127
    s_lshl_b32 s25, s25, 7
    s_lshr_b32 s24, s24, 7
    s_lshl_b32 s24, s24, 2
    s_add_u32 s24, s24, s25
    s_add_u32 s67, s24, 81920
    s_cmp_ge_u32 s16, 2
    s_cselect_b32 s24, 0, 2147483648
    v_or_b32 v230, s24, v6
    v_or_b32 v228, s24, v228
    s_lshl_b32 s24, s16, 12
    s_add_u32 s24, s24, 81920
    v_and_b32 v20, 31, v8
    v_lshlrev_b32 v253, 7, v20
    v_add_u32 v253, s24, v253
    v_and_b32 v20, 15, v8
    v_lshrrev_b32 v21, 4, v8
    v_and_b32 v22, 3, v8
    v_bfe_u32 v23, v8, 2, 2
    s_lshr_b32 s24, s16, 1
    s_and_b32 s25, s16, 1
    s_lshl_b32 s25, s25, 8
    s_mul_i32 s26, s24, 16640
    s_add_u32 s26, s26, s25
    v_mul_u32_u24 v24, 4160, v22
    v_add_u32 v25, v21, v23
    v_lshl_add_u32 v24, v25, 4, v24
    v_add_u32 v62, s26, v24
    s_mul_i32 s26, s24, 9472
    s_add_u32 s26, s26, s25
    s_add_u32 s26, s26, 33728
    v_and_b32 v22, 7, v8
    v_bfe_u32 v23, v8, 3, 1
    v_mul_u32_u24 v24, 4640, v23
    v_lshlrev_b32 v25, 6, v22
    v_sub_u32 v24, v24, v25
    v_lshl_add_u32 v24, v21, 4, v24
    v_add_u32 v63, s26, v24
    v_lshrrev_b32 v20, 6, v0
    v_and_b32 v20, 1, v20
    v_mul_u32_u24 v20, 9472, v20
    v_bfe_u32 v21, v0, 5, 1
    v_mul_u32_u24 v21, 4640, v21
    v_add_u32 v20, v20, v21
    v_and_b32 v21, 31, v0
    v_lshl_add_u32 v20, v21, 4, v20
    v_add_u32 v20, 37376, v20
    v_mov_b32 v24, 0
    v_mov_b32 v25, 0
    v_mov_b32 v26, 0
    v_mov_b32 v27, 0
    ds_write_b128 v20, v[24:27]
    v_lshrrev_b32 v20, 3, v0
    v_and_b32 v21, 7, v8
    v_lshlrev_b32 v53, 13, v20
    v_lshlrev_b32 v23, 4, v21
    v_sub_u32 v53, v53, v23
    s_lshl_b32 s24, s89, 7
    s_sub_u32 s24, 4080, s24
    v_add_u32 v53, s24, v53
    v_mul_u32_u24 v54, 1056, v21
    v_lshl_add_u32 v54, v20, 2, v54
    v_add_u32 v55, 75040, v54
    v_add_u32 v54, 65536, v54
    v_and_b32 v30, 7, v8
    v_lshlrev_b32 v30, 10, v30
    s_lshl_b32 s24, s88, 7
    s_add_u32 s24, s24, 8192
    v_add_u32 v30, s24, v30
    s_and_b32 s25, s16, 1
    s_mul_i32 s24, s25, 9472
    s_add_u32 s24, s24, 33280
    v_add_u32 v22, s24, v1
    s_add_u32 s24, s84, s25
    s_lshl_b32 s24, s24, 12
    s_add_u32 s72, s24, 1048576
    s_add_u32 s73, s24, 1052672
    v_and_b32 v20, 7, v8
    v_bfe_u32 v21, v8, 3, 1
    v_lshrrev_b32 v23, 4, v8
    v_lshlrev_b32 v31, 6, v20
    v_lshl_add_u32 v31, v23, 4, v31
    v_mul_u32_u24 v248, 4640, v21
    v_sub_u32 v248, v248, v31
    s_lshl_b32 s24, s16, 10
    s_sub_u32 s24, 36848, s24
    v_add_u32 v248, s24, v248
    v_lshrrev_b32 v31, 2, v20
    v_lshlrev_b32 v249, 17, v31
    v_and_b32 v31, 3, v20
    v_lshl_add_u32 v249, v31, 7, v249
    v_lshl_add_u32 v249, v23, 5, v249
    v_lshl_add_u32 v249, v21, 4, v249
    s_lshl_b32 s24, s85, 9
    s_lshl_b32 s25, s16, 19
    s_add_u32 s24, s24, s25
    s_add_u32 s58, s24, 5242880
    s_lshl_b32 s24, s18, 17
    s_lshl_b32 s25, s17, 5
    s_add_u32 s24, s24, s25
    s_lshl_b32 s25, s16, 15
    s_add_u32 s24, s24, s25
    s_add_u32 s59, s24, 5242880
    s_lshl_b32 s60, s62, 16
    s_and_b32 s61, s62, 0xffff0000
    v_mov_b32 v250, 2147483648
    v_mov_b32 v31, 0
    v_cmp_eq_u32 vcc, 0, v0
    s_lshl_b32 s24, s88, 18
    s_add_u32 s80, s24, 1048576
    v_cndmask_b32 v250, v250, v31, vcc
    s_cmp_eq_u32 s2, 0
    s_cselect_b32 s24, 0, 2147483648
    v_add_u32 v254, s24, v250
    v_or_b32 v254, v254, v250
    s_add_u32 s81, s80, 4096
    s_add_u32 s82, s80, 8192
    s_add_u32 s83, s80, 12288
    s_cmp_ge_u32 s16, 2
    s_cbranch_scc1 L_bm2
    s_waitcnt vmcnt(13)
    s_branch L_bmx
L_bm2:
    s_cmp_eq_u32 s16, 3
    s_cbranch_scc1 L_bm3
    s_waitcnt vmcnt(9)
    s_branch L_bmx
L_bm3:
    s_waitcnt vmcnt(3)
L_bmx:
    s_barrier
    s_cmp_lg_u32 s16, 0
    s_cbranch_scc1 L_bmy
    v_mov_b32 v31, s22
    s_add_u32 s25, s86, 8192
    buffer_store_dword v31, v6, s[4:7], s25 offen sc1
L_bmy:
    s_cmp_lg_u32 s16, 0
    s_cbranch_scc1 L_ft_1
    buffer_load_dword v231, v231, s[4:7], 0 offen
L_ft_1:
    s_cmp_ge_u32 s16, 2
    s_cbranch_scc1 L_g2b
    s_cmp_eq_u32 s16, 0
    s_cbranch_scc1 L_g2c
    s_waitcnt vmcnt(6)
    s_branch L_g2x
L_g2c:
    s_waitcnt vmcnt(8)
    s_branch L_g2x
L_g2b:
    s_and_b32 s69, s69, 0xffff
    s_mov_b32 s70, 1835008
    s_mov_b32 s71, 0x20000
    s_add_u32 m0, s94, 0
    s_nop 0
    buffer_load_dwordx4 v224, s[68:71], 0 offen nt lds
    s_add_u32 m0, s94, 896
    s_nop 0
    buffer_load_dwordx4 v224, s[68:71], 0 offen offset:128 nt lds
    s_add_u32 m0, s94, 1792
    s_nop 0
    buffer_load_dwordx4 v224, s[68:71], 0 offen offset:256 nt lds
    s_add_u32 m0, s94, 2688
    s_nop 0
    buffer_load_dwordx4 v224, s[68:71], 0 offen offset:384 nt lds
    s_add_u32 m0, s94, 3584
    s_nop 0
    buffer_load_dwordx4 v224, s[68:71], 0 offen offset:512 nt lds
    s_add_u32 m0, s94, 4480
    s_nop 0
    buffer_load_dwordx4 v224, s[68:71], 0 offen offset:640 nt lds
    s_add_u32 m0, s94, 5376
    s_nop 0
    buffer_load_dwordx4 v224, s[68:71], 0 offen offset:768 nt lds
    s_add_u32 m0, s94, 7168
    s_nop 0
    buffer_load_dwordx4 v225, s[52:55], 0 offen nt lds
    s_add_u32 m0, s94, 8064
    s_nop 0
    buffer_load_dwordx4 v225, s[52:55], 0 offen offset:128 nt lds
    s_add_u32 m0, s94, 8960
    s_nop 0
    buffer_load_dwordx4 v225, s[52:55], 0 offen offset:256 nt lds
    s_add_u32 m0, s94, 9856
    s_nop 0
    buffer_load_dwordx4 v225, s[52:55], 0 offen offset:384 nt lds
    s_waitcnt vmcnt(11)
L_g2x:
    s_waitcnt lgkmcnt(0)
    s_barrier
    ds_read2_b32 v[32:33], v54 offset0:0 offset1:32
    ds_read2_b32 v[34:35], v54 offset0:64 offset1:96
    ds_read2_b32 v[36:37], v54 offset0:128 offset1:160
    ds_read2_b32 v[38:39], v54 offset0:192 offset1:224
    v_add_u32 v20, 1056, v54
    v_add_u32 v21, 1056, v55
    ds_read2_b32 v[40:41], v20 offset0:0 offset1:32
    ds_read2_b32 v[42:43], v20 offset0:64 offset1:96
    ds_read2_b32 v[44:45], v55 offset0:0 offset1:32
    ds_read2_b32 v[46:47], v55 offset0:64 offset1:96
    ds_read2_b32 v[48:49], v55 offset0:128 offset1:160
    ds_read2_b32 v[50:51], v55 offset0:192 offset1:224
    ds_read_b32 v52, v21
    v_lshlrev_b32 v136, 16, v56
    v_lshlrev_b32 v137, 16, v58
    v_and_b32 v138, s31, v56
    v_and_b32 v139, s31, v58
    v_lshlrev_b32 v140, 16, v57
    v_lshlrev_b32 v141, 16, v59
    v_and_b32 v142, s31, v57
    v_and_b32 v143, s31, v59
    s_waitcnt lgkmcnt(0)
    v_lshlrev_b32 v96, 16, v32
    v_and_b32 v97, s31, v32
    v_lshlrev_b32 v98, 16, v33
    v_and_b32 v99, s31, v33
    v_lshlrev_b32 v100, 16, v34
    v_and_b32 v101, s31, v34
    v_lshlrev_b32 v102, 16, v35
    v_and_b32 v103, s31, v35
    v_lshlrev_b32 v104, 16, v36
    v_and_b32 v105, s31, v36
    v_lshlrev_b32 v106, 16, v37
    v_and_b32 v107, s31, v37
    v_lshlrev_b32 v108, 16, v38
    v_and_b32 v109, s31, v38
    v_lshlrev_b32 v110, 16, v39
    v_and_b32 v111, s31, v39
    v_lshlrev_b32 v112, 16, v40
    v_and_b32 v113, s31, v40
    v_lshlrev_b32 v114, 16, v41
    v_and_b32 v115, s31, v41
    v_lshlrev_b32 v116, 16, v42
    v_and_b32 v117, s31, v42
    v_lshlrev_b32 v118, 16, v43
    v_and_b32 v119, s31, v43
    buffer_load_dwordx4 v[24:27], v30, s[4:7], 0 offen sc1
    v_lshlrev_b32 v164, 16, v44
    v_and_b32 v165, s31, v44
    v_lshlrev_b32 v166, 16, v45
    v_and_b32 v167, s31, v45
    v_lshlrev_b32 v168, 16, v46
    v_and_b32 v169, s31, v46
    v_lshlrev_b32 v170, 16, v47
    v_and_b32 v171, s31, v47
    v_lshlrev_b32 v172, 16, v48
    v_and_b32 v173, s31, v48
    v_lshlrev_b32 v174, 16, v49
    v_and_b32 v175, s31, v49
    v_lshlrev_b32 v176, 16, v50
    v_and_b32 v177, s31, v50
    v_lshlrev_b32 v178, 16, v51
    v_and_b32 v179, s31, v51
    v_lshlrev_b32 v180, 16, v52
    v_and_b32 v181, s31, v52
    v_pk_mul_f32 v[146:147], v[136:137], v[104:105]
    v_pk_mul_f32 v[148:149], v[136:137], v[106:107]
    v_pk_mul_f32 v[150:151], v[136:137], v[108:109]
    v_pk_mul_f32 v[152:153], v[136:137], v[110:111]
    v_pk_mul_f32 v[154:155], v[136:137], v[112:113]
    v_pk_mul_f32 v[156:157], v[136:137], v[114:115]
    v_pk_mul_f32 v[158:159], v[136:137], v[116:117]
    v_pk_mul_f32 v[160:161], v[136:137], v[118:119]
    v_pk_fma_f32 v[146:147], v[138:139], v[102:103], v[146:147]
    v_pk_fma_f32 v[148:149], v[138:139], v[104:105], v[148:149]
    v_pk_fma_f32 v[150:151], v[138:139], v[106:107], v[150:151]
    v_pk_fma_f32 v[152:153], v[138:139], v[108:109], v[152:153]
    v_pk_fma_f32 v[154:155], v[138:139], v[110:111], v[154:155]
    v_pk_fma_f32 v[156:157], v[138:139], v[112:113], v[156:157]
    v_pk_fma_f32 v[158:159], v[138:139], v[114:115], v[158:159]
    v_pk_fma_f32 v[160:161], v[138:139], v[116:117], v[160:161]
    v_pk_fma_f32 v[146:147], v[140:141], v[100:101], v[146:147]
    v_pk_fma_f32 v[148:149], v[140:141], v[102:103], v[148:149]
    v_pk_fma_f32 v[150:151], v[140:141], v[104:105], v[150:151]
    v_pk_fma_f32 v[152:153], v[140:141], v[106:107], v[152:153]
    v_pk_fma_f32 v[154:155], v[140:141], v[108:109], v[154:155]
    v_pk_fma_f32 v[156:157], v[140:141], v[110:111], v[156:157]
    v_pk_fma_f32 v[158:159], v[140:141], v[112:113], v[158:159]
    v_pk_fma_f32 v[160:161], v[140:141], v[114:115], v[160:161]
    v_pk_fma_f32 v[146:147], v[142:143], v[98:99], v[146:147]
    v_pk_fma_f32 v[148:149], v[142:143], v[100:101], v[148:149]
    v_pk_fma_f32 v[150:151], v[142:143], v[102:103], v[150:151]
    v_pk_fma_f32 v[152:153], v[142:143], v[104:105], v[152:153]
    v_pk_fma_f32 v[154:155], v[142:143], v[106:107], v[154:155]
    v_pk_fma_f32 v[156:157], v[142:143], v[108:109], v[156:157]
    v_pk_fma_f32 v[158:159], v[142:143], v[110:111], v[158:159]
    v_pk_fma_f32 v[160:161], v[142:143], v[112:113], v[160:161]
    v_pk_mul_f32 v[146:147], v[146:147], v[166:167]
    v_pk_mul_f32 v[148:149], v[148:149], v[168:169]
    v_pk_mul_f32 v[150:151], v[150:151], v[170:171]
    v_pk_mul_f32 v[152:153], v[152:153], v[172:173]
    v_pk_mul_f32 v[154:155], v[154:155], v[174:175]
    v_pk_mul_f32 v[156:157], v[156:157], v[176:177]
    v_pk_mul_f32 v[158:159], v[158:159], v[178:179]
    v_pk_mul_f32 v[160:161], v[160:161], v[180:181]
    v_cvt_pk_bf16_f32 v32, v160, v158
    v_cvt_pk_bf16_f32 v33, v156, v154
    v_cvt_pk_bf16_f32 v34, v152, v150
    v_cvt_pk_bf16_f32 v35, v148, v146
    buffer_store_dwordx4 v[32:35], v53, s[4:7], s80 offen
    v_cvt_pk_bf16_f32 v40, v161, v159
    v_cvt_pk_bf16_f32 v41, v157, v155
    v_cvt_pk_bf16_f32 v42, v153, v151
    v_cvt_pk_bf16_f32 v43, v149, v147
    buffer_store_dwordx4 v[40:43], v53, s[4:7], s81 offen
    s_cmp_lt_u32 s16, 2
    s_cbranch_scc1 L_pe0
    v_mov_b32 v108, -1
    v_mov_b32 v109, -1
    v_mov_b32 v110, -1
    v_mov_b32 v111, -1
    s_and_b32 s25, s16, 1
    s_add_u32 s24, s84, s25
    s_lshl_b32 s24, s24, 12
    s_mul_i32 s25, s25, 16640
    s_add_u32 s26, s24, 8
    s_add_u32 m0, s25, 4224
    s_nop 0
    buffer_load_dwordx4 v1, s[76:79], s26 offen lds
    buffer_load_dwordx4 v1, s[76:79], s26 offen offset:1024 lds
    buffer_load_dwordx4 v1, s[76:79], s26 offen offset:2048 lds
    buffer_load_dwordx4 v1, s[76:79], s26 offen offset:3072 lds
    s_add_u32 s26, s24, 12
    s_add_u32 m0, s25, 8384
    s_nop 0
    buffer_load_dwordx4 v1, s[76:79], s26 offen lds
    buffer_load_dwordx4 v1, s[76:79], s26 offen offset:1024 lds
    buffer_load_dwordx4 v1, s[76:79], s26 offen offset:2048 lds
    buffer_load_dwordx4 v1, s[76:79], s26 offen offset:3072 lds
    s_add_u32 s26, s24, 16
    s_add_u32 m0, s25, 12544
    s_nop 0
    buffer_load_dwordx4 v1, s[76:79], s26 offen lds
    buffer_load_dwordx4 v1, s[76:79], s26 offen offset:1024 lds
    buffer_load_dwordx4 v1, s[76:79], s26 offen offset:2048 lds
    buffer_load_dwordx4 v1, s[76:79], s26 offen offset:3072 lds
    s_waitcnt vmcnt(15)
    ds_read_b64_tr_b16 v[64:65], v226 offset:0
    ds_read_b64_tr_b16 v[66:67], v226 offset:512
    ds_read_b64_tr_b16 v[68:69], v226 offset:1024
    ds_read_b64_tr_b16 v[70:71], v226 offset:1536
    ds_read_b64_tr_b16 v[72:73], v226 offset:2048
    ds_read_b64_tr_b16 v[74:75], v226 offset:2560
    ds_read_b64_tr_b16 v[76:77], v226 offset:3072
    ds_read_b64_tr_b16 v[78:79], v226 offset:3584
    ds_read_b64_tr_b16 v[80:81], v226 offset:4096
    ds_read_b64_tr_b16 v[82:83], v226 offset:4608
    s_waitcnt lgkmcnt(8)
    buffer_store_dwordx4 v[64:67], v227, s[4:7], s64 offen sc1
    ds_read_b64_tr_b16 v[84:85], v226 offset:5120
    ds_read_b64_tr_b16 v[86:87], v226 offset:5632
    s_waitcnt lgkmcnt(8)
    s_add_u32 s64, s64, 131072
    buffer_store_dwordx4 v[68:71], v227, s[4:7], s64 offen sc1
    ds_read_b64_tr_b16 v[88:89], v226 offset:6144
    ds_read_b64_tr_b16 v[90:91], v226 offset:6656
    s_waitcnt lgkmcnt(8)
    s_add_u32 s64, s64, 131072
    buffer_store_dwordx4 v[72:75], v227, s[4:7], s64 offen sc1
    ds_read_b64_tr_b16 a[0:1], v226 offset:7168
    ds_read_b64_tr_b16 a[2:3], v226 offset:7680
    s_waitcnt lgkmcnt(8)
    s_add_u32 s64, s64, 131072
    buffer_store_dwordx4 v[76:79], v227, s[4:7], s64 offen sc1
    ds_read_b64_tr_b16 a[4:5], v226 offset:8192
    ds_read_b64_tr_b16 a[6:7], v226 offset:8704
    s_waitcnt lgkmcnt(8)
    s_add_u32 s64, s64, 131072
    buffer_store_dwordx4 v[80:83], v227, s[4:7], s64 offen sc1
    ds_read_b64_tr_b16 a[8:9], v226 offset:9216
    ds_read_b64_tr_b16 a[10:11], v226 offset:9728
    s_waitcnt lgkmcnt(8)
    s_add_u32 s64, s64, 131072
    buffer_store_dwordx4 v[84:87], v227, s[4:7], s64 offen sc1
    ds_read_b64_tr_b16 a[12:13], v226 offset:10240
    ds_read_b64_tr_b16 a[14:15], v226 offset:10752
    s_waitcnt lgkmcnt(8)
    s_add_u32 s64, s64, 131072
    buffer_store_dwordx4 v[88:91], v227, s[4:7], s64 offen sc1
    s_waitcnt vmcnt(21)
    s_branch L_pe1
L_pe0:
    s_waitcnt vmcnt(2)
L_pe1:
    v_xor_b32 v24, s22, v24
    v_xor_b32 v25, s22, v25
    v_xor_b32 v26, s22, v26
    v_xor_b32 v27, s22, v27
    v_or3_b32 v24, v24, v25, v26
    v_or_b32 v24, v24, v27
    v_cmp_ne_u32 vcc, 0, v24
    s_cbranch_vccnz L_s0s
L_s0b:
    ds_write_b16 v61, v60
    s_cmp_ge_u32 s16, 2
    s_cbranch_scc1 L_xp_2
    buffer_load_dwordx4 v[64:67], v1, s[4:7], s72 offen sc1
    buffer_load_dwordx4 v[68:71], v1, s[4:7], s72 offen offset:1024 sc1
    buffer_load_dwordx4 v[72:75], v1, s[4:7], s72 offen offset:2048 sc1
    buffer_load_dwordx4 v[76:79], v1, s[4:7], s72 offen offset:3072 sc1
    v_mov_b32 v192, 0
    v_mov_b32 v193, 0
    v_mov_b32 v194, 0
    v_mov_b32 v195, 0
    v_mov_b32 v196, 0
    v_mov_b32 v197, 0
    v_mov_b32 v198, 0
    v_mov_b32 v199, 0
    v_mov_b32 v200, 0
    v_mov_b32 v201, 0
    v_mov_b32 v202, 0
    v_mov_b32 v203, 0
    v_mov_b32 v204, 0
    v_mov_b32 v205, 0
    v_mov_b32 v206, 0
    v_mov_b32 v207, 0
    v_mov_b32 v208, 0
    v_mov_b32 v209, 0
    v_mov_b32 v210, 0
    v_mov_b32 v211, 0
    v_mov_b32 v212, 0
    v_mov_b32 v213, 0
    v_mov_b32 v214, 0
    v_mov_b32 v215, 0
    v_mov_b32 v216, 0
    v_mov_b32 v217, 0
    v_mov_b32 v218, 0
    v_mov_b32 v219, 0
    v_mov_b32 v220, 0
    v_mov_b32 v221, 0
    v_mov_b32 v222, 0
    v_mov_b32 v223, 0
    s_waitcnt vmcnt(0)
    v_max3_u32 v31, v64, v68, v72
    v_max_u32 v31, v31, v76
    v_cmp_eq_u32 vcc, -1, v31
    s_cbranch_vccnz L_mks_4
L_mkb_5:
    ds_write_b128 v22, v[64:67] offset:0
    ds_write_b128 v22, v[68:71] offset:1024
    ds_write_b128 v22, v[72:75] offset:2048
    ds_write_b128 v22, v[76:79] offset:3072
    v_mov_b32_dpp v96, v68 wave_rol:1 row_mask:0xf bank_mask:0xf
    v_mov_b32_dpp v97, v72 wave_rol:1 row_mask:0xf bank_mask:0xf
    v_mov_b32_dpp v98, v76 wave_rol:1 row_mask:0xf bank_mask:0xf
    v_mov_b32 v99, 0
    v_alignbit_b32 v80, v65, v64, 16
    v_alignbit_b32 v81, v66, v65, 16
    v_alignbit_b32 v82, v67, v66, 16
    v_alignbit_b32 v84, v69, v68, 16
    v_alignbit_b32 v85, v70, v69, 16
    v_alignbit_b32 v86, v71, v70, 16
    v_alignbit_b32 v88, v73, v72, 16
    v_alignbit_b32 v89, v74, v73, 16
    v_alignbit_b32 v90, v75, v74, 16
    v_alignbit_b32 v92, v77, v76, 16
    v_alignbit_b32 v93, v78, v77, 16
    v_alignbit_b32 v94, v79, v78, 16
    v_mov_b32_dpp v96, v64 wave_shl:1 row_mask:0xf bank_mask:0xf
    v_mov_b32_dpp v97, v68 wave_shl:1 row_mask:0xf bank_mask:0xf
    v_mov_b32_dpp v98, v72 wave_shl:1 row_mask:0xf bank_mask:0xf
    v_mov_b32_dpp v99, v76 wave_shl:1 row_mask:0xf bank_mask:0xf
    v_alignbit_b32 v83, v96, v67, 16
    v_alignbit_b32 v87, v97, v71, 16
    v_alignbit_b32 v91, v98, v75, 16
    v_alignbit_b32 v95, v99, v79, 16
    ds_write_b128 v22, v[80:83] offset:4640
    ds_write_b128 v22, v[84:87] offset:5664
    ds_write_b128 v22, v[88:91] offset:6688
    ds_write_b128 v22, v[92:95] offset:7712
    s_branch L_bx_3
L_xp_2:
    v_mov_b32 v192, 0
    v_mov_b32 v193, 0
    v_mov_b32 v194, 0
    v_mov_b32 v195, 0
    v_mov_b32 v196, 0
    v_mov_b32 v197, 0
    v_mov_b32 v198, 0
    v_mov_b32 v199, 0
    v_mov_b32 v200, 0
    v_mov_b32 v201, 0
    v_mov_b32 v202, 0
    v_mov_b32 v203, 0
    v_mov_b32 v204, 0
    v_mov_b32 v205, 0
    v_mov_b32 v206, 0
    v_mov_b32 v207, 0
    v_mov_b32 v208, 0
    v_mov_b32 v209, 0
    v_mov_b32 v210, 0
    v_mov_b32 v211, 0
    v_mov_b32 v212, 0
    v_mov_b32 v213, 0
    v_mov_b32 v214, 0
    v_mov_b32 v215, 0
    v_mov_b32 v216, 0
    v_mov_b32 v217, 0
    v_mov_b32 v218, 0
    v_mov_b32 v219, 0
    v_mov_b32 v220, 0
    v_mov_b32 v221, 0
    v_mov_b32 v222, 0
    v_mov_b32 v223, 0
    s_waitcnt vmcnt(7)
    s_waitcnt vmcnt(0)
    buffer_store_dword v18, v230, s[4:7], s67 offen sc1
L_bx_3:
    s_waitcnt lgkmcnt(0)
    s_barrier
    ds_read_b128 v[128:131], v63 offset:3584
    ds_read_b128 v[64:67], v62 offset:0
    ds_read_b128 v[132:135], v63 offset:3072
    ds_read_b128 v[68:71], v62 offset:512
    ds_read_b128 v[136:139], v63 offset:2560
    ds_read_b128 v[72:75], v62 offset:1024
    ds_read_b128 v[140:143], v63 offset:2048
    ds_read_b128 v[76:79], v62 offset:1536
    ds_read_b128 v[144:147], v63 offset:1536
    ds_read_b128 v[80:83], v62 offset:2048
    ds_read_b128 v[148:151], v63 offset:1024
    ds_read_b128 v[84:87], v62 offset:2560
    ds_read_b128 v[152:155], v63 offset:512
    ds_read_b128 v[88:91], v62 offset:3072
    s_waitcnt lgkmcnt(12)
    v_mfma_f32_16x16x32_bf16 v[192:195], v[64:67], v[128:131], v[192:195]
    ds_read_b128 v[156:159], v63 offset:0
    s_waitcnt lgkmcnt(11)
    v_mfma_f32_16x16x32_bf16 v[196:199], v[64:67], v[132:135], v[196:199]
    ds_read_b128 v[92:95], v62 offset:3584
    v_mfma_f32_16x16x32_bf16 v[196:199], v[68:71], v[128:131], v[196:199]
    ds_read_b128 v[160:163], v63 offset:3648
    s_waitcnt lgkmcnt(11)
    v_mfma_f32_16x16x32_bf16 v[200:203], v[64:67], v[136:139], v[200:203]
    ds_read_b128 v[96:99], v62 offset:64
    v_mfma_f32_16x16x32_bf16 v[200:203], v[68:71], v[132:135], v[200:203]
    ds_read_b128 v[164:167], v63 offset:3136
    v_mfma_f32_16x16x32_bf16 v[200:203], v[72:75], v[128:131], v[200:203]
    ds_read_b128 v[100:103], v62 offset:576
    s_waitcnt lgkmcnt(12)
    v_mfma_f32_16x16x32_bf16 v[204:207], v[64:67], v[140:143], v[204:207]
    ds_read_b128 v[168:171], v63 offset:2624
    v_mfma_f32_16x16x32_bf16 v[204:207], v[68:71], v[136:139], v[204:207]
    ds_read_b128 v[104:107], v62 offset:1088
    v_mfma_f32_16x16x32_bf16 v[204:207], v[72:75], v[132:135], v[204:207]
    v_mfma_f32_16x16x32_bf16 v[204:207], v[76:79], v[128:131], v[204:207]
    s_waitcnt lgkmcnt(12)
    v_mfma_f32_16x16x32_bf16 v[208:211], v[64:67], v[144:147], v[208:211]
    ds_read_b128 v[172:175], v63 offset:2112
    v_mfma_f32_16x16x32_bf16 v[208:211], v[68:71], v[140:143], v[208:211]
    v_mov_b32 v24, -1
    v_mov_b32 v25, -1
    v_mov_b32 v26, -1
    v_mov_b32 v27, -1
    s_add_u32 s24, s58, 262144
    ds_read_b128 v[108:111], v62 offset:1600
    v_mfma_f32_16x16x32_bf16 v[208:211], v[72:75], v[136:139], v[208:211]
    buffer_store_dwordx4 v[24:27], v249, s[4:7], s58 offen sc1
    v_mfma_f32_16x16x32_bf16 v[208:211], v[76:79], v[132:135], v[208:211]
    v_mfma_f32_16x16x32_bf16 v[208:211], v[80:83], v[128:131], v[208:211]
    buffer_store_dwordx4 v[24:27], v249, s[4:7], s24 offen sc1
    s_waitcnt lgkmcnt(12)
    v_mfma_f32_16x16x32_bf16 v[212:215], v[64:67], v[148:151], v[212:215]
    ds_read_b128 v[176:179], v63 offset:1600
    v_mfma_f32_16x16x32_bf16 v[212:215], v[68:71], v[144:147], v[212:215]
    ds_read_b128 v[112:115], v62 offset:2112
    v_mfma_f32_16x16x32_bf16 v[212:215], v[72:75], v[140:143], v[212:215]
    v_mfma_f32_16x16x32_bf16 v[212:215], v[76:79], v[136:139], v[212:215]
    v_mfma_f32_16x16x32_bf16 v[212:215], v[80:83], v[132:135], v[212:215]
    v_mfma_f32_16x16x32_bf16 v[212:215], v[84:87], v[128:131], v[212:215]
    s_waitcnt lgkmcnt(12)
    v_mfma_f32_16x16x32_bf16 v[216:219], v[64:67], v[152:155], v[216:219]
    ds_read_b128 v[180:183], v63 offset:1088
    v_mfma_f32_16x16x32_bf16 v[216:219], v[68:71], v[148:151], v[216:219]
    ds_read_b128 v[116:119], v62 offset:2624
    v_mfma_f32_16x16x32_bf16 v[216:219], v[72:75], v[144:147], v[216:219]
    v_mfma_f32_16x16x32_bf16 v[216:219], v[76:79], v[140:143], v[216:219]
    v_mfma_f32_16x16x32_bf16 v[216:219], v[80:83], v[136:139], v[216:219]
    v_mfma_f32_16x16x32_bf16 v[216:219], v[84:87], v[132:135], v[216:219]
    v_mfma_f32_16x16x32_bf16 v[216:219], v[88:91], v[128:131], v[216:219]
    s_waitcnt lgkmcnt(12)
    v_mfma_f32_16x16x32_bf16 v[220:223], v[64:67], v[156:159], v[220:223]
    ds_read_b128 v[184:187], v63 offset:576
    v_mfma_f32_16x16x32_bf16 v[220:223], v[68:71], v[152:155], v[220:223]
    ds_read_b128 v[120:123], v62 offset:3136
    v_mfma_f32_16x16x32_bf16 v[220:223], v[72:75], v[148:151], v[220:223]
    v_mfma_f32_16x16x32_bf16 v[220:223], v[76:79], v[144:147], v[220:223]
    v_mfma_f32_16x16x32_bf16 v[220:223], v[80:83], v[140:143], v[220:223]
    s_waitcnt lgkmcnt(8)
    ds_read_b128 v[188:191], v63 offset:64
    v_mfma_f32_16x16x32_bf16 v[220:223], v[84:87], v[136:139], v[220:223]
    ds_read_b128 v[124:127], v62 offset:3648
    v_mfma_f32_16x16x32_bf16 v[220:223], v[88:91], v[132:135], v[220:223]
    v_mfma_f32_16x16x32_bf16 v[220:223], v[92:95], v[128:131], v[220:223]
    s_waitcnt lgkmcnt(0)
    v_mfma_f32_16x16x32_bf16 v[192:195], v[96:99], v[160:163], v[192:195]
    ds_read_b128 v[128:131], v63 offset:3712
    v_mfma_f32_16x16x32_bf16 v[196:199], v[96:99], v[164:167], v[196:199]
    v_mfma_f32_16x16x32_bf16 v[196:199], v[100:103], v[160:163], v[196:199]
    ds_read_b128 v[64:67], v62 offset:128
    v_mfma_f32_16x16x32_bf16 v[200:203], v[96:99], v[168:171], v[200:203]
    v_mfma_f32_16x16x32_bf16 v[200:203], v[100:103], v[164:167], v[200:203]
    buffer_load_dwordx4 a[232:235], v9, s[8:11], s87 offen nt
    buffer_load_dwordx4 a[236:239], v9, s[8:11], s87 offen offset:128 nt
    ds_read_b128 v[132:135], v63 offset:3200
    v_mfma_f32_16x16x32_bf16 v[200:203], v[104:107], v[160:163], v[200:203]
    v_mfma_f32_16x16x32_bf16 v[204:207], v[96:99], v[172:175], v[204:207]
    ds_read_b128 v[68:71], v62 offset:640
    v_mfma_f32_16x16x32_bf16 v[204:207], v[100:103], v[168:171], v[204:207]
    v_mfma_f32_16x16x32_bf16 v[204:207], v[104:107], v[164:167], v[204:207]
    ds_read_b128 v[136:139], v63 offset:2688
    v_mfma_f32_16x16x32_bf16 v[204:207], v[108:111], v[160:163], v[204:207]
    v_mfma_f32_16x16x32_bf16 v[208:211], v[96:99], v[176:179], v[208:211]
    ds_read_b128 v[72:75], v62 offset:1152
    v_mfma_f32_16x16x32_bf16 v[208:211], v[100:103], v[172:175], v[208:211]
    v_mfma_f32_16x16x32_bf16 v[208:211], v[104:107], v[168:171], v[208:211]
    ds_read_b128 v[140:143], v63 offset:2176
    v_mfma_f32_16x16x32_bf16 v[208:211], v[108:111], v[164:167], v[208:211]
    v_mfma_f32_16x16x32_bf16 v[208:211], v[112:115], v[160:163], v[208:211]
    ds_read_b128 v[76:79], v62 offset:1664
    v_mfma_f32_16x16x32_bf16 v[212:215], v[96:99], v[180:183], v[212:215]
    v_mfma_f32_16x16x32_bf16 v[212:215], v[100:103], v[176:179], v[212:215]
    ds_read_b128 v[144:147], v63 offset:1664
    v_mfma_f32_16x16x32_bf16 v[212:215], v[104:107], v[172:175], v[212:215]
    v_mfma_f32_16x16x32_bf16 v[212:215], v[108:111], v[168:171], v[212:215]
    ds_read_b128 v[80:83], v62 offset:2176
    v_mfma_f32_16x16x32_bf16 v[212:215], v[112:115], v[164:167], v[212:215]
    v_mfma_f32_16x16x32_bf16 v[212:215], v[116:119], v[160:163], v[212:215]
    ds_read_b128 v[148:151], v63 offset:1152
    v_mfma_f32_16x16x32_bf16 v[216:219], v[96:99], v[184:187], v[216:219]
    v_mfma_f32_16x16x32_bf16 v[216:219], v[100:103], v[180:183], v[216:219]
    ds_read_b128 v[84:87], v62 offset:2688
    v_mfma_f32_16x16x32_bf16 v[216:219], v[104:107], v[176:179], v[216:219]
    v_mfma_f32_16x16x32_bf16 v[216:219], v[108:111], v[172:175], v[216:219]
    ds_read_b128 v[152:155], v63 offset:640
    v_mfma_f32_16x16x32_bf16 v[216:219], v[112:115], v[168:171], v[216:219]
    v_mfma_f32_16x16x32_bf16 v[216:219], v[116:119], v[164:167], v[216:219]
    ds_read_b128 v[88:91], v62 offset:3200
    v_mfma_f32_16x16x32_bf16 v[216:219], v[120:123], v[160:163], v[216:219]
    v_mfma_f32_16x16x32_bf16 v[220:223], v[96:99], v[188:191], v[220:223]
    ds_read_b128 v[156:159], v63 offset:128
    v_mfma_f32_16x16x32_bf16 v[220:223], v[100:103], v[184:187], v[220:223]
    v_mfma_f32_16x16x32_bf16 v[220:223], v[104:107], v[180:183], v[220:223]
    ds_read_b128 v[92:95], v62 offset:3712
    v_mfma_f32_16x16x32_bf16 v[220:223], v[108:111], v[176:179], v[220:223]
    v_mfma_f32_16x16x32_bf16 v[220:223], v[112:115], v[172:175], v[220:223]
    v_mfma_f32_16x16x32_bf16 v[220:223], v[116:119], v[168:171], v[220:223]
    v_mfma_f32_16x16x32_bf16 v[220:223], v[120:123], v[164:167], v[220:223]
    v_mfma_f32_16x16x32_bf16 v[220:223], v[124:127], v[160:163], v[220:223]
    s_waitcnt lgkmcnt(0)
    v_mfma_f32_16x16x32_bf16 v[192:195], v[64:67], v[128:131], v[192:195]
    buffer_store_dwordx4 a[0:3], v228, s[4:7], s65 offen sc1
    ds_read_b128 v[160:163], v63 offset:3776
    v_mfma_f32_16x16x32_bf16 v[196:199], v[64:67], v[132:135], v[196:199]
    v_mfma_f32_16x16x32_bf16 v[196:199], v[68:71], v[128:131], v[196:199]
    s_add_u32 s65, s65, 229376
    buffer_store_dwordx4 a[4:7], v228, s[4:7], s65 offen sc1
    ds_read_b128 v[96:99], v62 offset:192
    v_mfma_f32_16x16x32_bf16 v[200:203], v[64:67], v[136:139], v[200:203]
    v_mfma_f32_16x16x32_bf16 v[200:203], v[68:71], v[132:135], v[200:203]
    s_add_u32 s65, s65, 229376
    buffer_store_dwordx4 a[8:11], v228, s[4:7], s65 offen sc1
    ds_read_b128 v[164:167], v63 offset:3264
    v_mfma_f32_16x16x32_bf16 v[200:203], v[72:75], v[128:131], v[200:203]
    v_mfma_f32_16x16x32_bf16 v[204:207], v[64:67], v[140:143], v[204:207]
    s_add_u32 s65, s65, 229376
    buffer_store_dwordx4 a[12:15], v228, s[4:7], s65 offen sc1
    ds_read_b128 v[100:103], v62 offset:704
    v_mfma_f32_16x16x32_bf16 v[204:207], v[68:71], v[136:139], v[204:207]
    v_mfma_f32_16x16x32_bf16 v[204:207], v[72:75], v[132:135], v[204:207]
    ds_read_b128 v[168:171], v63 offset:2752
    v_mfma_f32_16x16x32_bf16 v[204:207], v[76:79], v[128:131], v[204:207]
    v_mfma_f32_16x16x32_bf16 v[208:211], v[64:67], v[144:147], v[208:211]
    ds_read_b128 v[104:107], v62 offset:1216
    v_mfma_f32_16x16x32_bf16 v[208:211], v[68:71], v[140:143], v[208:211]
    v_mfma_f32_16x16x32_bf16 v[208:211], v[72:75], v[136:139], v[208:211]
    ds_read_b128 v[172:175], v63 offset:2240
    v_mfma_f32_16x16x32_bf16 v[208:211], v[76:79], v[132:135], v[208:211]
    v_mfma_f32_16x16x32_bf16 v[208:211], v[80:83], v[128:131], v[208:211]
    ds_read_b128 v[108:111], v62 offset:1728
    v_mfma_f32_16x16x32_bf16 v[212:215], v[64:67], v[148:151], v[212:215]
    v_mfma_f32_16x16x32_bf16 v[212:215], v[68:71], v[144:147], v[212:215]
    ds_read_b128 v[176:179], v63 offset:1728
    v_mfma_f32_16x16x32_bf16 v[212:215], v[72:75], v[140:143], v[212:215]
    v_mfma_f32_16x16x32_bf16 v[212:215], v[76:79], v[136:139], v[212:215]
    ds_read_b128 v[112:115], v62 offset:2240
    v_mfma_f32_16x16x32_bf16 v[212:215], v[80:83], v[132:135], v[212:215]
    v_mfma_f32_16x16x32_bf16 v[212:215], v[84:87], v[128:131], v[212:215]
    ds_read_b128 v[180:183], v63 offset:1216
    v_mfma_f32_16x16x32_bf16 v[216:219], v[64:67], v[152:155], v[216:219]
    v_mfma_f32_16x16x32_bf16 v[216:219], v[68:71], v[148:151], v[216:219]
    ds_read_b128 v[116:119], v62 offset:2752
    v_mfma_f32_16x16x32_bf16 v[216:219], v[72:75], v[144:147], v[216:219]
    v_mfma_f32_16x16x32_bf16 v[216:219], v[76:79], v[140:143], v[216:219]
    ds_read_b128 v[184:187], v63 offset:704
    v_mfma_f32_16x16x32_bf16 v[216:219], v[80:83], v[136:139], v[216:219]
    v_mfma_f32_16x16x32_bf16 v[216:219], v[84:87], v[132:135], v[216:219]
    ds_read_b128 v[120:123], v62 offset:3264
    v_mfma_f32_16x16x32_bf16 v[216:219], v[88:91], v[128:131], v[216:219]
    v_mfma_f32_16x16x32_bf16 v[220:223], v[64:67], v[156:159], v[220:223]
    ds_read_b128 v[188:191], v63 offset:192
    v_mfma_f32_16x16x32_bf16 v[220:223], v[68:71], v[152:155], v[220:223]
    v_mfma_f32_16x16x32_bf16 v[220:223], v[72:75], v[148:151], v[220:223]
    ds_read_b128 v[124:127], v62 offset:3776
    v_mfma_f32_16x16x32_bf16 v[220:223], v[76:79], v[144:147], v[220:223]
    v_mfma_f32_16x16x32_bf16 v[220:223], v[80:83], v[140:143], v[220:223]
    v_mfma_f32_16x16x32_bf16 v[220:223], v[84:87], v[136:139], v[220:223]
    v_mfma_f32_16x16x32_bf16 v[220:223], v[88:91], v[132:135], v[220:223]
    v_mfma_f32_16x16x32_bf16 v[220:223], v[92:95], v[128:131], v[220:223]
    s_waitcnt lgkmcnt(0)
    v_mfma_f32_16x16x32_bf16 v[192:195], v[96:99], v[160:163], v[192:195]
    v_mfma_f32_16x16x32_bf16 v[196:199], v[96:99], v[164:167], v[196:199]
    v_mfma_f32_16x16x32_bf16 v[196:199], v[100:103], v[160:163], v[196:199]
    buffer_load_dwordx4 v[24:27], v253, s[4:7], 0 offen sc1
    v_mfma_f32_16x16x32_bf16 v[200:203], v[96:99], v[168:171], v[200:203]
    v_mfma_f32_16x16x32_bf16 v[200:203], v[100:103], v[164:167], v[200:203]
    v_mfma_f32_16x16x32_bf16 v[200:203], v[104:107], v[160:163], v[200:203]
    v_mfma_f32_16x16x32_bf16 v[204:207], v[96:99], v[172:175], v[204:207]
    v_mfma_f32_16x16x32_bf16 v[204:207], v[100:103], v[168:171], v[204:207]
    v_mfma_f32_16x16x32_bf16 v[204:207], v[104:107], v[164:167], v[204:207]
    v_mfma_f32_16x16x32_bf16 v[204:207], v[108:111], v[160:163], v[204:207]
    v_mfma_f32_16x16x32_bf16 v[208:211], v[96:99], v[176:179], v[208:211]
    v_mfma_f32_16x16x32_bf16 v[208:211], v[100:103], v[172:175], v[208:211]
    v_mfma_f32_16x16x32_bf16 v[208:211], v[104:107], v[168:171], v[208:211]
    v_mfma_f32_16x16x32_bf16 v[208:211], v[108:111], v[164:167], v[208:211]
    v_mfma_f32_16x16x32_bf16 v[208:211], v[112:115], v[160:163], v[208:211]
    v_mfma_f32_16x16x32_bf16 v[212:215], v[96:99], v[180:183], v[212:215]
    v_mfma_f32_16x16x32_bf16 v[212:215], v[100:103], v[176:179], v[212:215]
    v_mfma_f32_16x16x32_bf16 v[212:215], v[104:107], v[172:175], v[212:215]
    v_mfma_f32_16x16x32_bf16 v[212:215], v[108:111], v[168:171], v[212:215]
    v_mfma_f32_16x16x32_bf16 v[212:215], v[112:115], v[164:167], v[212:215]
    v_mfma_f32_16x16x32_bf16 v[212:215], v[116:119], v[160:163], v[212:215]
    v_mfma_f32_16x16x32_bf16 v[216:219], v[96:99], v[184:187], v[216:219]
    v_mfma_f32_16x16x32_bf16 v[216:219], v[100:103], v[180:183], v[216:219]
    v_mfma_f32_16x16x32_bf16 v[216:219], v[104:107], v[176:179], v[216:219]
    v_mfma_f32_16x16x32_bf16 v[216:219], v[108:111], v[172:175], v[216:219]
    v_mfma_f32_16x16x32_bf16 v[216:219], v[112:115], v[168:171], v[216:219]
    v_mfma_f32_16x16x32_bf16 v[216:219], v[116:119], v[164:167], v[216:219]
    v_mfma_f32_16x16x32_bf16 v[216:219], v[120:123], v[160:163], v[216:219]
    v_mfma_f32_16x16x32_bf16 v[220:223], v[96:99], v[188:191], v[220:223]
    v_mfma_f32_16x16x32_bf16 v[220:223], v[100:103], v[184:187], v[220:223]
    v_mfma_f32_16x16x32_bf16 v[220:223], v[104:107], v[180:183], v[220:223]
    v_mfma_f32_16x16x32_bf16 v[220:223], v[108:111], v[176:179], v[220:223]
    v_mfma_f32_16x16x32_bf16 v[220:223], v[112:115], v[172:175], v[220:223]
    v_mfma_f32_16x16x32_bf16 v[220:223], v[116:119], v[168:171], v[220:223]
    v_mfma_f32_16x16x32_bf16 v[220:223], v[120:123], v[164:167], v[220:223]
    v_mfma_f32_16x16x32_bf16 v[220:223], v[124:127], v[160:163], v[220:223]
    s_waitcnt vmcnt(7)
    s_barrier
    s_add_u32 s24, s86, 24576
    buffer_store_dword v18, v250, s[4:7], s24 offen sc1
    v_add_u32 v20, s23, v1
    s_lshl_b32 s24, s16, 11
    v_add_u32 v21, s24, v1
    s_nop 4
    ds_write_b128 v20, v[192:195] offset:0
    ds_write_b128 v20, v[196:199] offset:1024
    ds_write_b128 v20, v[200:203] offset:2048
    ds_write_b128 v20, v[204:207] offset:3072
    ds_write_b128 v20, v[208:211] offset:4096
    ds_write_b128 v20, v[212:215] offset:5120
    ds_write_b128 v20, v[216:219] offset:6144
    ds_write_b128 v20, v[220:223] offset:7168
    s_waitcnt lgkmcnt(0)
    s_waitcnt vmcnt(2)
    s_waitcnt vmcnt(1)
    v_xor_b32 v24, s51, v24
    v_xor_b32 v25, s51, v25
    v_xor_b32 v26, s51, v26
    v_xor_b32 v27, s51, v27
    v_or3_b32 v24, v24, v25, v26
    v_or_b32 v24, v24, v27
    v_cmp_ne_u32 vcc, 0, v24
    s_cbranch_vccnz L_afs_11
L_afb_12:
    s_barrier
    s_add_u32 s24, s86, 98304
    buffer_store_dword v18, v250, s[4:7], s24 offen sc1
    s_add_u32 m0, s23, 65536
    s_mov_b32 s50, s39
    buffer_load_dwordx4 v1, s[4:7], s50 offen lds
    buffer_load_dwordx4 v1, s[4:7], s50 offen offset:1024 lds
    buffer_load_dwordx4 v1, s[4:7], s50 offen offset:2048 lds
    buffer_load_dwordx4 v1, s[4:7], s50 offen offset:3072 lds
    s_add_u32 m0, s23, 69632
    s_add_u32 s50, s39, 4096
    buffer_load_dwordx4 v1, s[4:7], s50 offen lds
    buffer_load_dwordx4 v1, s[4:7], s50 offen offset:1024 lds
    buffer_load_dwordx4 v1, s[4:7], s50 offen offset:2048 lds
    buffer_load_dwordx4 v1, s[4:7], s50 offen offset:3072 lds
    ds_read_b128 v[64:67], v21 offset:0
    ds_read_b128 v[68:71], v21 offset:8192
    ds_read_b128 v[72:75], v21 offset:16384
    ds_read_b128 v[76:79], v21 offset:24576
    ds_read_b128 v[128:131], v248 offset:512
    ds_read_b128 v[132:135], v248 offset:9984
    ds_read_b128 v[96:99], v21 offset:1024
    ds_read_b128 v[100:103], v21 offset:9216
    ds_read_b128 v[104:107], v21 offset:17408
    ds_read_b128 v[108:111], v21 offset:25600
    ds_read_b128 v[136:139], v248 offset:0
    ds_read_b128 v[140:143], v248 offset:9472
    s_waitcnt lgkmcnt(6)
    v_add_f32 v64, v64, v68
    v_add_f32 v65, v65, v69
    v_add_f32 v66, v66, v70
    v_add_f32 v67, v67, v71
    v_lshlrev_b32 v128, 16, v128
    v_lshlrev_b32 v129, 16, v129
    v_lshlrev_b32 v130, 16, v130
    v_lshlrev_b32 v131, 16, v131
    v_fmac_f32 v64, s60, v131
    v_fmac_f32 v65, s60, v130
    v_fmac_f32 v66, s60, v129
    v_fmac_f32 v67, s60, v128
    v_add_f32 v72, v72, v76
    v_add_f32 v73, v73, v77
    v_add_f32 v74, v74, v78
    v_add_f32 v75, v75, v79
    v_lshlrev_b32 v132, 16, v132
    v_lshlrev_b32 v133, 16, v133
    v_lshlrev_b32 v134, 16, v134
    v_lshlrev_b32 v135, 16, v135
    v_fmac_f32 v72, s61, v135
    v_fmac_f32 v73, s61, v134
    v_fmac_f32 v74, s61, v133
    v_fmac_f32 v75, s61, v132
    v_cvt_pk_bf16_f32 v148, v64, v72
    v_cvt_pk_bf16_f32 v149, v65, v73
    v_cvt_pk_bf16_f32 v150, v66, v74
    v_cvt_pk_bf16_f32 v151, v67, v75
    v_mov_b32 v152, v150
    v_mov_b32 v153, v148
    v_mov_b32 v154, v151
    v_mov_b32 v155, v149
    v_mov_b32_dpp v152, v148 row_ror:8 row_mask:0xf bank_mask:0x3
    v_mov_b32_dpp v153, v150 row_ror:8 row_mask:0xf bank_mask:0xc
    v_mov_b32_dpp v154, v149 row_ror:8 row_mask:0xf bank_mask:0x3
    v_mov_b32_dpp v155, v151 row_ror:8 row_mask:0xf bank_mask:0xc
    buffer_store_dwordx4 v[152:155], v249, s[4:7], s58 offen sc1
    s_waitcnt lgkmcnt(0)
    v_add_f32 v96, v96, v100
    v_add_f32 v97, v97, v101
    v_add_f32 v98, v98, v102
    v_add_f32 v99, v99, v103
    v_lshlrev_b32 v136, 16, v136
    v_lshlrev_b32 v137, 16, v137
    v_lshlrev_b32 v138, 16, v138
    v_lshlrev_b32 v139, 16, v139
    v_fmac_f32 v96, s60, v139
    v_fmac_f32 v97, s60, v138
    v_fmac_f32 v98, s60, v137
    v_fmac_f32 v99, s60, v136
    v_add_f32 v104, v104, v108
    v_add_f32 v105, v105, v109
    v_add_f32 v106, v106, v110
    v_add_f32 v107, v107, v111
    v_lshlrev_b32 v140, 16, v140
    v_lshlrev_b32 v141, 16, v141
    v_lshlrev_b32 v142, 16, v142
    v_lshlrev_b32 v143, 16, v143
    v_fmac_f32 v104, s61, v143
    v_fmac_f32 v105, s61, v142
    v_fmac_f32 v106, s61, v141
    v_fmac_f32 v107, s61, v140
    v_cvt_pk_bf16_f32 v148, v96, v104
    v_cvt_pk_bf16_f32 v149, v97, v105
    v_cvt_pk_bf16_f32 v150, v98, v106
    v_cvt_pk_bf16_f32 v151, v99, v107
    v_mov_b32 v156, v150
    v_mov_b32 v157, v148
    v_mov_b32 v158, v151
    v_mov_b32 v159, v149
    v_mov_b32_dpp v156, v148 row_ror:8 row_mask:0xf bank_mask:0x3
    v_mov_b32_dpp v157, v150 row_ror:8 row_mask:0xf bank_mask:0xc
    v_mov_b32_dpp v158, v149 row_ror:8 row_mask:0xf bank_mask:0x3
    v_mov_b32_dpp v159, v151 row_ror:8 row_mask:0xf bank_mask:0xc
    s_add_u32 s58, s58, 262144
    buffer_store_dwordx4 v[156:159], v249, s[4:7], s58 offen sc1
    s_add_u32 s24, s59, 16384
    s_add_u32 m0, s23, 98304
    s_add_u32 s50, s39, 32768
    buffer_load_dwordx4 v1, s[4:7], s50 offen lds
    buffer_load_dwordx4 v1, s[4:7], s50 offen offset:1024 lds
    buffer_load_dwordx4 v1, s[4:7], s50 offen offset:2048 lds
    buffer_load_dwordx4 v1, s[4:7], s50 offen offset:3072 lds
    s_add_u32 m0, s23, 102400
    s_add_u32 s50, s39, 36864
    buffer_load_dwordx4 v1, s[4:7], s50 offen lds
    buffer_load_dwordx4 v1, s[4:7], s50 offen offset:1024 lds
    buffer_load_dwordx4 v1, s[4:7], s50 offen offset:2048 lds
    buffer_load_dwordx4 v1, s[4:7], s50 offen offset:3072 lds
    v_lshrrev_b32 v30, 2, v8
    v_lshlrev_b32 v30, 7, v30
    v_and_b32 v31, 3, v8
    v_lshl_add_u32 v30, v31, 2, v30
    s_lshl_b32 s25, s16, 11
    v_add_u32 v30, s25, v30
    s_mov_b32 s25, 24576
    buffer_load_dword v17, v30, s[4:7], s25 offen sc1
    s_add_u32 m0, s23, 131072
    s_add_u32 s50, s39, 65536
    buffer_load_dwordx4 v1, s[4:7], s50 offen lds
    buffer_load_dwordx4 v1, s[4:7], s50 offen offset:1024 lds
    buffer_load_dwordx4 v1, s[4:7], s50 offen offset:2048 lds
    buffer_load_dwordx4 v1, s[4:7], s50 offen offset:3072 lds
    v_accvgpr_read_b32 v128, a232
    v_accvgpr_read_b32 v129, a233
    v_accvgpr_read_b32 v130, a234
    v_accvgpr_read_b32 v131, a235
    v_accvgpr_read_b32 v132, a236
    v_accvgpr_read_b32 v133, a237
    v_accvgpr_read_b32 v134, a238
    v_accvgpr_read_b32 v135, a239
    v_lshlrev_b32 v144, 16, v128
    v_and_b32 v145, s31, v128
    v_lshlrev_b32 v146, 16, v129
    v_and_b32 v147, s31, v129
    v_lshlrev_b32 v148, 16, v130
    v_and_b32 v149, s31, v130
    v_lshlrev_b32 v150, 16, v131
    v_and_b32 v151, s31, v131
    v_lshlrev_b32 v152, 16, v132
    v_and_b32 v153, s31, v132
    v_lshlrev_b32 v154, 16, v133
    v_and_b32 v155, s31, v133
    v_lshlrev_b32 v156, 16, v134
    v_and_b32 v157, s31, v134
    v_lshlrev_b32 v158, 16, v135
    v_and_b32 v159, s31, v135
    v_pk_add_f32 v[192:193], v[144:145], v[146:147]
    v_pk_mul_f32 v[194:195], v[144:145], v[144:145]
    v_pk_fma_f32 v[194:195], v[146:147], v[146:147], v[194:195]
    v_pk_fma_f32 v[194:195], v[148:149], v[148:149], v[194:195]
    v_pk_add_f32 v[192:193], v[192:193], v[148:149]
    v_pk_fma_f32 v[194:195], v[150:151], v[150:151], v[194:195]
    v_pk_add_f32 v[192:193], v[192:193], v[150:151]
    v_pk_fma_f32 v[194:195], v[152:153], v[152:153], v[194:195]
    v_pk_add_f32 v[192:193], v[192:193], v[152:153]
    v_pk_fma_f32 v[194:195], v[154:155], v[154:155], v[194:195]
    v_pk_add_f32 v[192:193], v[192:193], v[154:155]
    v_pk_fma_f32 v[194:195], v[156:157], v[156:157], v[194:195]
    v_pk_add_f32 v[192:193], v[192:193], v[156:157]
    v_pk_fma_f32 v[194:195], v[158:159], v[158:159], v[194:195]
    v_pk_add_f32 v[192:193], v[192:193], v[158:159]
    v_add_f32 v192, v192, v193
    v_add_f32 v194, v194, v195
    s_nop 1
    v_permlane16_swap_b32 v192, v194
    v_add_f32 v192, v192, v194
    s_nop 1
    v_add_f32_dpp v192, v192, v192 row_ror:8 row_mask:0xf bank_mask:0xf
    v_mov_b32 v193, v192
    s_nop 1
    v_permlane32_swap_b32 v192, v193
    v_add_f32 v192, v192, v193
    s_mov_b64 exec, 0x00ff00ff
    ds_write_b32 v11, v192 offset:0
    s_mov_b64 exec, -1
    s_waitcnt lgkmcnt(0)
    s_waitcnt vmcnt(4)
    v_cmp_ne_u32 vcc, s51, v17
    s_cbranch_vccnz L_qs_14
L_qb_15:
    s_barrier
    ds_read_b128 v[196:199], v12 offset:0
    ds_read_b128 v[200:203], v12 offset:16
    buffer_load_dword v136, v10, s[4:7], s59 offen sc1
    buffer_load_dword v137, v10, s[4:7], s59 offen offset:512 sc1
    buffer_load_dword v138, v10, s[4:7], s59 offen offset:1024 sc1
    buffer_load_dword v139, v10, s[4:7], s59 offen offset:1536 sc1
    buffer_load_dword v140, v10, s[4:7], s24 offen sc1
    buffer_load_dword v141, v10, s[4:7], s24 offen offset:512 sc1
    buffer_load_dword v142, v10, s[4:7], s24 offen offset:1024 sc1
    buffer_load_dword v143, v10, s[4:7], s24 offen offset:1536 sc1
    s_mov_b32 s25, 98304
    buffer_load_dword v17, v30, s[4:7], s25 offen sc1
    s_add_u32 m0, s23, 135168
    s_add_u32 s50, s39, 69632
    buffer_load_dwordx4 v1, s[4:7], s50 offen lds
    buffer_load_dwordx4 v1, s[4:7], s50 offen offset:1024 lds
    buffer_load_dwordx4 v1, s[4:7], s50 offen offset:2048 lds
    buffer_load_dwordx4 v1, s[4:7], s50 offen offset:3072 lds
    s_waitcnt lgkmcnt(0)
    v_pk_add_f32 v[196:197], v[196:197], v[198:199]
    v_pk_add_f32 v[200:201], v[200:201], v[202:203]
    v_pk_add_f32 v[196:197], v[196:197], v[200:201]
    v_mul_f32 v196, 0x3b000000, v196
    v_mul_f32 v197, 0x3b000000, v197
    v_fma_f32 v197, -v196, v196, v197
    v_max_f32 v197, 0, v197
    v_add_f32 v197, 0x3727c5ac, v197
    v_rsq_f32 v204, v197
    s_nop 0
    v_mul_f32_e64 v206, -v196, v204
    v_pk_fma_f32 v[176:177], v[144:145], v[204:205], v[206:207] op_sel_hi:[1,0,0]
    v_pk_fma_f32 v[178:179], v[146:147], v[204:205], v[206:207] op_sel_hi:[1,0,0]
    v_pk_fma_f32 v[180:181], v[148:149], v[204:205], v[206:207] op_sel_hi:[1,0,0]
    v_pk_fma_f32 v[182:183], v[150:151], v[204:205], v[206:207] op_sel_hi:[1,0,0]
    v_pk_fma_f32 v[184:185], v[152:153], v[204:205], v[206:207] op_sel_hi:[1,0,0]
    v_pk_fma_f32 v[186:187], v[154:155], v[204:205], v[206:207] op_sel_hi:[1,0,0]
    v_pk_fma_f32 v[188:189], v[156:157], v[204:205], v[206:207] op_sel_hi:[1,0,0]
    v_pk_fma_f32 v[190:191], v[158:159], v[204:205], v[206:207] op_sel_hi:[1,0,0]
    s_add_u32 m0, s23, 0
    s_add_u32 s50, s39, 98304
    buffer_load_dwordx4 v1, s[4:7], s50 offen lds
    buffer_load_dwordx4 v1, s[4:7], s50 offen offset:1024 lds
    buffer_load_dwordx4 v1, s[4:7], s50 offen offset:2048 lds
    buffer_load_dwordx4 v1, s[4:7], s50 offen offset:3072 lds
    s_add_u32 m0, s23, 4096
    s_add_u32 s50, s39, 102400
    buffer_load_dwordx4 v1, s[4:7], s50 offen lds
    buffer_load_dwordx4 v1, s[4:7], s50 offen offset:1024 lds
    buffer_load_dwordx4 v1, s[4:7], s50 offen offset:2048 lds
    buffer_load_dwordx4 v1, s[4:7], s50 offen offset:3072 lds
    s_waitcnt vmcnt(13)
    v_max3_u32 v31, v136, v137, v138
    v_max3_u32 v31, v31, v139, v140
    v_max3_u32 v31, v31, v141, v142
    v_max_u32 v31, v31, v143
    v_cmp_eq_u32 vcc, -1, v31
    s_cbranch_vccnz L_mks_17
L_mkb_18:
    v_accvgpr_write_b32 a224, v136
    v_accvgpr_write_b32 a225, v137
    v_accvgpr_write_b32 a226, v138
    v_accvgpr_write_b32 a227, v139
    v_accvgpr_write_b32 a228, v140
    v_accvgpr_write_b32 a229, v141
    v_accvgpr_write_b32 a230, v142
    v_accvgpr_write_b32 a231, v143
    v_lshlrev_b32 v160, 16, v136
    v_and_b32 v161, s31, v136
    v_lshlrev_b32 v162, 16, v137
    v_and_b32 v163, s31, v137
    v_lshlrev_b32 v164, 16, v138
    v_and_b32 v165, s31, v138
    v_lshlrev_b32 v166, 16, v139
    v_and_b32 v167, s31, v139
    v_lshlrev_b32 v168, 16, v140
    v_and_b32 v169, s31, v140
    v_lshlrev_b32 v170, 16, v141
    v_and_b32 v171, s31, v141
    v_lshlrev_b32 v172, 16, v142
    v_and_b32 v173, s31, v142
    v_lshlrev_b32 v174, 16, v143
    v_and_b32 v175, s31, v143
    v_pk_fma_f32 v[144:145], v[176:177], v[160:161], v[144:145]
    v_pk_fma_f32 v[146:147], v[178:179], v[162:163], v[146:147]
    v_pk_fma_f32 v[148:149], v[180:181], v[164:165], v[148:149]
    v_pk_fma_f32 v[150:151], v[182:183], v[166:167], v[150:151]
    v_pk_fma_f32 v[152:153], v[184:185], v[168:169], v[152:153]
    v_pk_fma_f32 v[154:155], v[186:187], v[170:171], v[154:155]
    v_pk_fma_f32 v[156:157], v[188:189], v[172:173], v[156:157]
    v_pk_fma_f32 v[158:159], v[190:191], v[174:175], v[158:159]
    v_pk_add_f32 v[192:193], v[144:145], v[146:147]
    v_pk_mul_f32 v[194:195], v[144:145], v[144:145]
    v_pk_fma_f32 v[194:195], v[146:147], v[146:147], v[194:195]
    v_pk_fma_f32 v[194:195], v[148:149], v[148:149], v[194:195]
    v_pk_add_f32 v[192:193], v[192:193], v[148:149]
    v_pk_fma_f32 v[194:195], v[150:151], v[150:151], v[194:195]
    v_pk_add_f32 v[192:193], v[192:193], v[150:151]
    v_pk_fma_f32 v[194:195], v[152:153], v[152:153], v[194:195]
    v_pk_add_f32 v[192:193], v[192:193], v[152:153]
    v_pk_fma_f32 v[194:195], v[154:155], v[154:155], v[194:195]
    v_pk_add_f32 v[192:193], v[192:193], v[154:155]
    v_pk_fma_f32 v[194:195], v[156:157], v[156:157], v[194:195]
    v_pk_add_f32 v[192:193], v[192:193], v[156:157]
    v_pk_fma_f32 v[194:195], v[158:159], v[158:159], v[194:195]
    v_pk_add_f32 v[192:193], v[192:193], v[158:159]
    v_add_f32 v192, v192, v193
    v_add_f32 v194, v194, v195
    s_nop 1
    v_permlane16_swap_b32 v192, v194
    v_add_f32 v192, v192, v194
    s_nop 1
    v_add_f32_dpp v192, v192, v192 row_ror:8 row_mask:0xf bank_mask:0xf
    v_mov_b32 v193, v192
    s_nop 1
    v_permlane32_swap_b32 v192, v193
    v_add_f32 v192, v192, v193
    s_mov_b64 exec, 0x00ff00ff
    ds_write_b32 v11, v192 offset:256
    s_mov_b64 exec, -1
    s_waitcnt lgkmcnt(0)
    s_waitcnt vmcnt(12)
    v_cmp_ne_u32 vcc, s51, v17
    s_cbranch_vccnz L_qs_28
L_qb_29:
    s_barrier
    ds_read_b128 v[196:199], v12 offset:256
    ds_read_b128 v[200:203], v12 offset:272
    buffer_store_dword v18, v254, s[4:7], 0 offen sc1
    s_waitcnt lgkmcnt(0)
    v_pk_add_f32 v[196:197], v[196:197], v[198:199]
    v_pk_add_f32 v[200:201], v[200:201], v[202:203]
    v_pk_add_f32 v[196:197], v[196:197], v[200:201]
    v_mul_f32 v196, 0x3b000000, v196
    v_mul_f32 v197, 0x3b000000, v197
    v_fma_f32 v197, -v196, v196, v197
    v_max_f32 v197, 0, v197
    v_add_f32 v197, 0x3727c5ac, v197
    v_rsq_f32 v204, v197
    s_nop 0
    v_mul_f32 v204, 0x3fb8aa3b, v204
    v_mul_f32_e64 v206, -v196, v204
    v_pk_fma_f32 v[176:177], v[144:145], v[204:205], v[206:207] op_sel_hi:[1,0,0]
    v_pk_fma_f32 v[178:179], v[146:147], v[204:205], v[206:207] op_sel_hi:[1,0,0]
    v_pk_fma_f32 v[180:181], v[148:149], v[204:205], v[206:207] op_sel_hi:[1,0,0]
    v_pk_fma_f32 v[182:183], v[150:151], v[204:205], v[206:207] op_sel_hi:[1,0,0]
    v_pk_fma_f32 v[184:185], v[152:153], v[204:205], v[206:207] op_sel_hi:[1,0,0]
    v_pk_fma_f32 v[186:187], v[154:155], v[204:205], v[206:207] op_sel_hi:[1,0,0]
    v_pk_fma_f32 v[188:189], v[156:157], v[204:205], v[206:207] op_sel_hi:[1,0,0]
    v_pk_fma_f32 v[190:191], v[158:159], v[204:205], v[206:207] op_sel_hi:[1,0,0]
    v_cvt_pk_bf16_f32 v216, v176, v177
    v_cvt_pk_bf16_f32 v217, v178, v179
    v_cvt_pk_bf16_f32 v218, v180, v181
    v_cvt_pk_bf16_f32 v219, v182, v183
    v_cvt_pk_bf16_f32 v220, v184, v185
    v_cvt_pk_bf16_f32 v221, v186, v187
    v_cvt_pk_bf16_f32 v222, v188, v189
    v_cvt_pk_bf16_f32 v223, v190, v191
    s_add_u32 s46, s34, 1048576
    s_add_u32 s47, s34, 1052672
    buffer_store_dwordx4 v[216:219], v7, s[4:7], s46 offen
    buffer_store_dwordx4 v[220:223], v7, s[4:7], s47 offen
    v_cvt_pk_bf16_f32 v20, v144, v145
    v_cvt_pk_bf16_f32 v21, v146, v147
    v_cvt_pk_bf16_f32 v22, v148, v149
    v_cvt_pk_bf16_f32 v23, v150, v151
    v_cvt_pk_bf16_f32 v24, v152, v153
    v_cvt_pk_bf16_f32 v25, v154, v155
    v_cvt_pk_bf16_f32 v26, v156, v157
    v_cvt_pk_bf16_f32 v27, v158, v159
    s_waitcnt vmcnt(0)
    buffer_store_dword v18, v6, s[4:7], s40 offen
    s_barrier
    buffer_load_dword v17, v5, s[4:7], s41 offen sc1
    s_waitcnt vmcnt(0)
    v_cmp_ne_u32 vcc, s51, v17
    s_cbranch_vccnz L_polls_31
L_pollb_32:
    s_add_u32 s3, s35, 1048576
    buffer_load_dwordx4 v[128:131], v1, s[4:7], s3 offen sc1
    buffer_load_dwordx4 v[132:135], v1, s[4:7], s3 offen offset:1024 sc1
    buffer_load_dwordx4 v[136:139], v1, s[4:7], s3 offen offset:2048 sc1
    buffer_load_dwordx4 v[140:143], v1, s[4:7], s3 offen offset:3072 sc1
    s_add_u32 s3, s35, 1052672
    buffer_load_dwordx4 v[144:147], v1, s[4:7], s3 offen sc1
    s_waitcnt vmcnt(4)
    ds_read_b128 v[32:35], v2 offset:0
    ds_read_b128 v[36:39], v2 offset:32768
    ds_read_b128 v[40:43], v3 offset:0
    ds_read_b128 v[44:47], v2 offset:1024
    ds_read_b128 v[48:51], v2 offset:33792
    ds_read_b128 v[52:55], v3 offset:1024
    s_waitcnt lgkmcnt(4)
    v_mfma_f32_32x32x16_bf16 v[64:79], v[32:35], v[128:131], 0
    ds_read_b128 v[56:59], v2 offset:2048
    buffer_load_dwordx4 v[148:151], v1, s[4:7], s3 offen offset:1024 sc1
    v_mfma_f32_32x32x16_bf16 v[80:95], v[36:39], v[128:131], 0
    ds_read_b128 v[60:63], v2 offset:34816
    s_waitcnt lgkmcnt(4)
    v_mfma_f32_32x32x16_bf16 v[96:111], v[40:43], v[128:131], 0
    ds_read_b128 v[32:35], v3 offset:2048
    buffer_load_dwordx4 v[152:155], v1, s[4:7], s3 offen offset:2048 sc1
    s_waitcnt vmcnt(5)
    v_mfma_f32_32x32x16_bf16 v[64:79], v[44:47], v[132:135], v[64:79]
    ds_read_b128 v[36:39], v2 offset:3072
    s_waitcnt lgkmcnt(4)
    v_mfma_f32_32x32x16_bf16 v[80:95], v[48:51], v[132:135], v[80:95]
    ds_read_b128 v[40:43], v2 offset:35840
    buffer_load_dwordx4 v[156:159], v1, s[4:7], s3 offen offset:3072 sc1
    v_mfma_f32_32x32x16_bf16 v[96:111], v[52:55], v[132:135], v[96:111]
    ds_read_b128 v[44:47], v3 offset:3072
    s_waitcnt vmcnt(5)
    s_waitcnt lgkmcnt(4)
    v_mfma_f32_32x32x16_bf16 v[64:79], v[56:59], v[136:139], v[64:79]
    ds_read_b128 v[48:51], v2 offset:4096
    s_add_u32 s3, s35, 1056768
    v_mfma_f32_32x32x16_bf16 v[80:95], v[60:63], v[136:139], v[80:95]
    ds_read_b128 v[52:55], v2 offset:36864
    buffer_load_dwordx4 v[160:163], v1, s[4:7], s3 offen sc1
    s_waitcnt lgkmcnt(4)
    v_mfma_f32_32x32x16_bf16 v[96:111], v[32:35], v[136:139], v[96:111]
    ds_read_b128 v[56:59], v3 offset:4096
    s_waitcnt vmcnt(5)
    v_mfma_f32_32x32x16_bf16 v[64:79], v[36:39], v[140:143], v[64:79]
    ds_read_b128 v[60:63], v2 offset:5120
    buffer_load_dwordx4 v[164:167], v1, s[4:7], s3 offen offset:1024 sc1
    s_waitcnt lgkmcnt(4)
    v_mfma_f32_32x32x16_bf16 v[80:95], v[40:43], v[140:143], v[80:95]
    ds_read_b128 v[32:35], v2 offset:37888
    v_mfma_f32_32x32x16_bf16 v[96:111], v[44:47], v[140:143], v[96:111]
    ds_read_b128 v[36:39], v3 offset:5120
    buffer_load_dwordx4 v[168:171], v1, s[4:7], s3 offen offset:2048 sc1
    s_waitcnt vmcnt(6)
    s_waitcnt lgkmcnt(4)
    v_mfma_f32_32x32x16_bf16 v[64:79], v[48:51], v[144:147], v[64:79]
    ds_read_b128 v[40:43], v2 offset:6144
    v_mfma_f32_32x32x16_bf16 v[80:95], v[52:55], v[144:147], v[80:95]
    ds_read_b128 v[44:47], v2 offset:38912
    buffer_load_dwordx4 v[172:175], v1, s[4:7], s3 offen offset:3072 sc1
    s_waitcnt lgkmcnt(4)
    v_mfma_f32_32x32x16_bf16 v[96:111], v[56:59], v[144:147], v[96:111]
    ds_read_b128 v[48:51], v3 offset:6144
    s_add_u32 s3, s35, 1060864
    s_waitcnt vmcnt(6)
    v_mfma_f32_32x32x16_bf16 v[64:79], v[60:63], v[148:151], v[64:79]
    ds_read_b128 v[52:55], v2 offset:7168
    buffer_load_dwordx4 v[176:179], v1, s[4:7], s3 offen sc1
    s_waitcnt lgkmcnt(4)
    v_mfma_f32_32x32x16_bf16 v[80:95], v[32:35], v[148:151], v[80:95]
    ds_read_b128 v[56:59], v2 offset:39936
    v_mfma_f32_32x32x16_bf16 v[96:111], v[36:39], v[148:151], v[96:111]
    ds_read_b128 v[60:63], v3 offset:7168
    buffer_load_dwordx4 v[180:183], v1, s[4:7], s3 offen offset:1024 sc1
    s_waitcnt vmcnt(7)
    s_waitcnt lgkmcnt(4)
    v_mfma_f32_32x32x16_bf16 v[64:79], v[40:43], v[152:155], v[64:79]
    ds_read_b128 v[32:35], v2 offset:8192
    v_mfma_f32_32x32x16_bf16 v[80:95], v[44:47], v[152:155], v[80:95]
    ds_read_b128 v[36:39], v2 offset:40960
    buffer_load_dwordx4 v[184:187], v1, s[4:7], s3 offen offset:2048 sc1
    s_waitcnt lgkmcnt(4)
    v_mfma_f32_32x32x16_bf16 v[96:111], v[48:51], v[152:155], v[96:111]
    ds_read_b128 v[40:43], v3 offset:8192
    s_waitcnt vmcnt(7)
    v_mfma_f32_32x32x16_bf16 v[64:79], v[52:55], v[156:159], v[64:79]
    ds_read_b128 v[44:47], v2 offset:9216
    buffer_load_dwordx4 v[188:191], v1, s[4:7], s3 offen offset:3072 sc1
    s_waitcnt lgkmcnt(4)
    v_mfma_f32_32x32x16_bf16 v[80:95], v[56:59], v[156:159], v[80:95]
    ds_read_b128 v[48:51], v2 offset:41984
    s_add_u32 s3, s35, 1064960
    v_mfma_f32_32x32x16_bf16 v[96:111], v[60:63], v[156:159], v[96:111]
    ds_read_b128 v[52:55], v3 offset:9216
    buffer_load_dwordx4 v[192:195], v1, s[4:7], s3 offen sc1
    s_waitcnt vmcnt(8)
    s_waitcnt lgkmcnt(4)
    v_mfma_f32_32x32x16_bf16 v[64:79], v[32:35], v[160:163], v[64:79]
    ds_read_b128 v[56:59], v2 offset:10240
    v_mfma_f32_32x32x16_bf16 v[80:95], v[36:39], v[160:163], v[80:95]
    ds_read_b128 v[60:63], v2 offset:43008
    buffer_load_dwordx4 v[196:199], v1, s[4:7], s3 offen offset:1024 sc1
    s_waitcnt lgkmcnt(4)
    v_mfma_f32_32x32x16_bf16 v[96:111], v[40:43], v[160:163], v[96:111]
    ds_read_b128 v[32:35], v3 offset:10240
    s_waitcnt vmcnt(8)
    v_mfma_f32_32x32x16_bf16 v[64:79], v[44:47], v[164:167], v[64:79]
    ds_read_b128 v[36:39], v2 offset:11264
    buffer_load_dwordx4 v[200:203], v1, s[4:7], s3 offen offset:2048 sc1
    s_waitcnt lgkmcnt(4)
    v_mfma_f32_32x32x16_bf16 v[80:95], v[48:51], v[164:167], v[80:95]
    ds_read_b128 v[40:43], v2 offset:44032
    v_mfma_f32_32x32x16_bf16 v[96:111], v[52:55], v[164:167], v[96:111]
    ds_read_b128 v[44:47], v3 offset:11264
    buffer_load_dwordx4 v[204:207], v1, s[4:7], s3 offen offset:3072 sc1
    s_waitcnt vmcnt(9)
    s_waitcnt lgkmcnt(4)
    v_mfma_f32_32x32x16_bf16 v[64:79], v[56:59], v[168:171], v[64:79]
    ds_read_b128 v[48:51], v2 offset:12288
    s_add_u32 s3, s35, 1069056
    v_mfma_f32_32x32x16_bf16 v[80:95], v[60:63], v[168:171], v[80:95]
    ds_read_b128 v[52:55], v2 offset:45056
    buffer_load_dwordx4 v[208:211], v1, s[4:7], s3 offen sc1
    s_waitcnt lgkmcnt(4)
    v_mfma_f32_32x32x16_bf16 v[96:111], v[32:35], v[168:171], v[96:111]
    ds_read_b128 v[56:59], v3 offset:12288
    s_waitcnt vmcnt(9)
    v_mfma_f32_32x32x16_bf16 v[64:79], v[36:39], v[172:175], v[64:79]
    ds_read_b128 v[60:63], v2 offset:13312
    buffer_load_dwordx4 v[212:215], v1, s[4:7], s3 offen offset:1024 sc1
    s_waitcnt lgkmcnt(4)
    v_mfma_f32_32x32x16_bf16 v[80:95], v[40:43], v[172:175], v[80:95]
    ds_read_b128 v[32:35], v2 offset:46080
    v_mfma_f32_32x32x16_bf16 v[96:111], v[44:47], v[172:175], v[96:111]
    ds_read_b128 v[36:39], v3 offset:13312
    buffer_load_dwordx4 v[216:219], v1, s[4:7], s3 offen offset:2048 sc1
    s_waitcnt vmcnt(10)
    s_waitcnt lgkmcnt(4)
    v_mfma_f32_32x32x16_bf16 v[64:79], v[48:51], v[176:179], v[64:79]
    ds_read_b128 v[40:43], v2 offset:14336
    v_mfma_f32_32x32x16_bf16 v[80:95], v[52:55], v[176:179], v[80:95]
    ds_read_b128 v[44:47], v2 offset:47104
    buffer_load_dwordx4 v[220:223], v1, s[4:7], s3 offen offset:3072 sc1
    s_waitcnt lgkmcnt(4)
    v_mfma_f32_32x32x16_bf16 v[96:111], v[56:59], v[176:179], v[96:111]
    ds_read_b128 v[48:51], v3 offset:14336
    s_add_u32 s3, s35, 1073152
    s_waitcnt vmcnt(10)
    v_mfma_f32_32x32x16_bf16 v[64:79], v[60:63], v[180:183], v[64:79]
    ds_read_b128 v[52:55], v2 offset:15360
    buffer_load_dwordx4 v[224:227], v1, s[4:7], s3 offen sc1
    s_waitcnt lgkmcnt(4)
    v_mfma_f32_32x32x16_bf16 v[80:95], v[32:35], v[180:183], v[80:95]
    ds_read_b128 v[56:59], v2 offset:48128
    v_mfma_f32_32x32x16_bf16 v[96:111], v[36:39], v[180:183], v[96:111]
    ds_read_b128 v[60:63], v3 offset:15360
    buffer_load_dwordx4 v[228:231], v1, s[4:7], s3 offen offset:1024 sc1
    s_waitcnt vmcnt(11)
    s_waitcnt lgkmcnt(4)
    v_mfma_f32_32x32x16_bf16 v[64:79], v[40:43], v[184:187], v[64:79]
    ds_read_b128 v[32:35], v2 offset:16384
    v_mfma_f32_32x32x16_bf16 v[80:95], v[44:47], v[184:187], v[80:95]
    ds_read_b128 v[36:39], v2 offset:49152
    buffer_load_dwordx4 v[232:235], v1, s[4:7], s3 offen offset:2048 sc1
    s_waitcnt lgkmcnt(4)
    v_mfma_f32_32x32x16_bf16 v[96:111], v[48:51], v[184:187], v[96:111]
    ds_read_b128 v[40:43], v3 offset:16384
    s_waitcnt vmcnt(11)
    v_mfma_f32_32x32x16_bf16 v[64:79], v[52:55], v[188:191], v[64:79]
    ds_read_b128 v[44:47], v2 offset:17408
    buffer_load_dwordx4 v[236:239], v1, s[4:7], s3 offen offset:3072 sc1
    s_waitcnt lgkmcnt(4)
    v_mfma_f32_32x32x16_bf16 v[80:95], v[56:59], v[188:191], v[80:95]
    ds_read_b128 v[48:51], v2 offset:50176
    s_add_u32 s3, s35, 1077248
    v_mfma_f32_32x32x16_bf16 v[96:111], v[60:63], v[188:191], v[96:111]
    ds_read_b128 v[52:55], v3 offset:17408
    buffer_load_dwordx4 v[240:243], v1, s[4:7], s3 offen sc1
    s_waitcnt vmcnt(12)
    s_waitcnt lgkmcnt(4)
    v_mfma_f32_32x32x16_bf16 v[64:79], v[32:35], v[192:195], v[64:79]
    ds_read_b128 v[56:59], v2 offset:18432
    v_mfma_f32_32x32x16_bf16 v[80:95], v[36:39], v[192:195], v[80:95]
    ds_read_b128 v[60:63], v2 offset:51200
    buffer_load_dwordx4 v[244:247], v1, s[4:7], s3 offen offset:1024 sc1
    s_waitcnt lgkmcnt(4)
    v_mfma_f32_32x32x16_bf16 v[96:111], v[40:43], v[192:195], v[96:111]
    ds_read_b128 v[32:35], v3 offset:18432
    s_waitcnt vmcnt(12)
    v_mfma_f32_32x32x16_bf16 v[64:79], v[44:47], v[196:199], v[64:79]
    ds_read_b128 v[36:39], v2 offset:19456
    buffer_load_dwordx4 v[248:251], v1, s[4:7], s3 offen offset:2048 sc1
    s_waitcnt lgkmcnt(4)
    v_mfma_f32_32x32x16_bf16 v[80:95], v[48:51], v[196:199], v[80:95]
    ds_read_b128 v[40:43], v2 offset:52224
    v_mfma_f32_32x32x16_bf16 v[96:111], v[52:55], v[196:199], v[96:111]
    ds_read_b128 v[44:47], v3 offset:19456
    buffer_load_dwordx4 v[252:255], v1, s[4:7], s3 offen offset:3072 sc1
    s_waitcnt vmcnt(13)
    s_waitcnt lgkmcnt(4)
    v_mfma_f32_32x32x16_bf16 v[64:79], v[56:59], v[200:203], v[64:79]
    ds_read_b128 v[48:51], v2 offset:20480
    s_add_u32 m0, s23, 32768
    s_add_u32 s50, s39, 131072
    v_mfma_f32_32x32x16_bf16 v[80:95], v[60:63], v[200:203], v[80:95]
    ds_read_b128 v[52:55], v2 offset:53248
    buffer_load_dwordx4 v1, s[4:7], s50 offen lds
    s_waitcnt lgkmcnt(4)
    v_mfma_f32_32x32x16_bf16 v[96:111], v[32:35], v[200:203], v[96:111]
    ds_read_b128 v[56:59], v3 offset:20480
    s_waitcnt vmcnt(13)
    v_mfma_f32_32x32x16_bf16 v[64:79], v[36:39], v[204:207], v[64:79]
    ds_read_b128 v[60:63], v2 offset:21504
    buffer_load_dwordx4 v1, s[4:7], s50 offen offset:1024 lds
    s_waitcnt lgkmcnt(4)
    v_mfma_f32_32x32x16_bf16 v[80:95], v[40:43], v[204:207], v[80:95]
    ds_read_b128 v[32:35], v2 offset:54272
    v_mfma_f32_32x32x16_bf16 v[96:111], v[44:47], v[204:207], v[96:111]
    ds_read_b128 v[36:39], v3 offset:21504
    buffer_load_dwordx4 v1, s[4:7], s50 offen offset:2048 lds
    s_waitcnt vmcnt(14)
    s_waitcnt lgkmcnt(4)
    v_mfma_f32_32x32x16_bf16 v[64:79], v[48:51], v[208:211], v[64:79]
    ds_read_b128 v[40:43], v2 offset:22528
    v_mfma_f32_32x32x16_bf16 v[80:95], v[52:55], v[208:211], v[80:95]
    ds_read_b128 v[44:47], v2 offset:55296
    buffer_load_dwordx4 v1, s[4:7], s50 offen offset:3072 lds
    s_add_u32 m0, s23, 36864
    s_add_u32 s50, s39, 135168
    s_waitcnt lgkmcnt(4)
    v_mfma_f32_32x32x16_bf16 v[96:111], v[56:59], v[208:211], v[96:111]
    ds_read_b128 v[48:51], v3 offset:22528
    s_waitcnt vmcnt(14)
    v_mfma_f32_32x32x16_bf16 v[64:79], v[60:63], v[212:215], v[64:79]
    ds_read_b128 v[52:55], v2 offset:23552
    buffer_load_dwordx4 v1, s[4:7], s50 offen lds
    s_waitcnt lgkmcnt(4)
    v_mfma_f32_32x32x16_bf16 v[80:95], v[32:35], v[212:215], v[80:95]
    ds_read_b128 v[56:59], v2 offset:56320
    v_mfma_f32_32x32x16_bf16 v[96:111], v[36:39], v[212:215], v[96:111]
    ds_read_b128 v[60:63], v3 offset:23552
    buffer_load_dwordx4 v1, s[4:7], s50 offen offset:1024 lds
    s_waitcnt vmcnt(15)
    s_waitcnt lgkmcnt(4)
    v_mfma_f32_32x32x16_bf16 v[64:79], v[40:43], v[216:219], v[64:79]
    ds_read_b128 v[32:35], v2 offset:24576
    v_mfma_f32_32x32x16_bf16 v[80:95], v[44:47], v[216:219], v[80:95]
    ds_read_b128 v[36:39], v2 offset:57344
    buffer_load_dwordx4 v1, s[4:7], s50 offen offset:2048 lds
    s_waitcnt lgkmcnt(4)
    v_mfma_f32_32x32x16_bf16 v[96:111], v[48:51], v[216:219], v[96:111]
    ds_read_b128 v[40:43], v3 offset:24576
    s_waitcnt vmcnt(15)
    v_mfma_f32_32x32x16_bf16 v[64:79], v[52:55], v[220:223], v[64:79]
    ds_read_b128 v[44:47], v2 offset:25600
    buffer_load_dwordx4 v1, s[4:7], s50 offen offset:3072 lds
    s_add_u32 s26, s30, 0
    s_waitcnt lgkmcnt(4)
    v_mfma_f32_32x32x16_bf16 v[80:95], v[56:59], v[220:223], v[80:95]
    ds_read_b128 v[48:51], v2 offset:58368
    buffer_load_dwordx4 a[0:3], v28, s[4:7], s26 offen
    v_mfma_f32_32x32x16_bf16 v[96:111], v[60:63], v[220:223], v[96:111]
    ds_read_b128 v[52:55], v3 offset:25600
    s_waitcnt vmcnt(16)
    s_waitcnt lgkmcnt(4)
    v_mfma_f32_32x32x16_bf16 v[64:79], v[32:35], v[224:227], v[64:79]
    ds_read_b128 v[56:59], v2 offset:26624
    buffer_load_dwordx4 a[4:7], v29, s[4:7], s26 offen
    v_mfma_f32_32x32x16_bf16 v[80:95], v[36:39], v[224:227], v[80:95]
    ds_read_b128 v[60:63], v2 offset:59392
    s_add_u32 s26, s30, 14336
    s_waitcnt lgkmcnt(4)
    v_mfma_f32_32x32x16_bf16 v[96:111], v[40:43], v[224:227], v[96:111]
    ds_read_b128 v[32:35], v3 offset:26624
    buffer_load_dwordx4 a[56:59], v28, s[4:7], s26 offen
    s_waitcnt vmcnt(17)
    v_mfma_f32_32x32x16_bf16 v[64:79], v[44:47], v[228:231], v[64:79]
    ds_read_b128 v[36:39], v2 offset:27648
    s_waitcnt lgkmcnt(4)
    v_mfma_f32_32x32x16_bf16 v[80:95], v[48:51], v[228:231], v[80:95]
    ds_read_b128 v[40:43], v2 offset:60416
    buffer_load_dwordx4 a[60:63], v29, s[4:7], s26 offen
    v_mfma_f32_32x32x16_bf16 v[96:111], v[52:55], v[228:231], v[96:111]
    ds_read_b128 v[44:47], v3 offset:27648
    s_add_u32 s26, s30, 28672
    s_waitcnt vmcnt(17)
    s_waitcnt lgkmcnt(4)
    v_mfma_f32_32x32x16_bf16 v[64:79], v[56:59], v[232:235], v[64:79]
    ds_read_b128 v[48:51], v2 offset:28672
    buffer_load_dwordx4 a[112:115], v28, s[4:7], s26 offen
    v_mfma_f32_32x32x16_bf16 v[80:95], v[60:63], v[232:235], v[80:95]
    ds_read_b128 v[52:55], v2 offset:61440
    s_waitcnt lgkmcnt(4)
    v_mfma_f32_32x32x16_bf16 v[96:111], v[32:35], v[232:235], v[96:111]
    ds_read_b128 v[56:59], v3 offset:28672
    buffer_load_dwordx4 a[116:119], v29, s[4:7], s26 offen
    s_waitcnt vmcnt(18)
    v_mfma_f32_32x32x16_bf16 v[64:79], v[36:39], v[236:239], v[64:79]
    ds_read_b128 v[60:63], v2 offset:29696
    s_add_u32 s26, s30, 43008
    s_waitcnt lgkmcnt(4)
    v_mfma_f32_32x32x16_bf16 v[80:95], v[40:43], v[236:239], v[80:95]
    ds_read_b128 v[32:35], v2 offset:62464
    buffer_load_dwordx4 a[168:171], v28, s[4:7], s26 offen
    v_mfma_f32_32x32x16_bf16 v[96:111], v[44:47], v[236:239], v[96:111]
    ds_read_b128 v[36:39], v3 offset:29696
    s_waitcnt vmcnt(18)
    s_waitcnt lgkmcnt(4)
    v_mfma_f32_32x32x16_bf16 v[64:79], v[48:51], v[240:243], v[64:79]
    ds_read_b128 v[40:43], v2 offset:30720
    buffer_load_dwordx4 a[172:175], v29, s[4:7], s26 offen
    v_mfma_f32_32x32x16_bf16 v[80:95], v[52:55], v[240:243], v[80:95]
    ds_read_b128 v[44:47], v2 offset:63488
    s_add_u32 s26, s30, 2048
    s_waitcnt lgkmcnt(4)
    v_mfma_f32_32x32x16_bf16 v[96:111], v[56:59], v[240:243], v[96:111]
    ds_read_b128 v[48:51], v3 offset:30720
    buffer_load_dwordx4 a[8:11], v28, s[4:7], s26 offen
    s_waitcnt vmcnt(19)
    v_mfma_f32_32x32x16_bf16 v[64:79], v[60:63], v[244:247], v[64:79]
    ds_read_b128 v[52:55], v2 offset:31744
    s_waitcnt lgkmcnt(4)
    v_mfma_f32_32x32x16_bf16 v[80:95], v[32:35], v[244:247], v[80:95]
    ds_read_b128 v[56:59], v2 offset:64512
    buffer_load_dwordx4 a[12:15], v29, s[4:7], s26 offen
    v_mfma_f32_32x32x16_bf16 v[96:111], v[36:39], v[244:247], v[96:111]
    ds_read_b128 v[60:63], v3 offset:31744
    s_add_u32 s26, s30, 16384
    s_waitcnt vmcnt(19)
    s_waitcnt lgkmcnt(4)
    v_mfma_f32_32x32x16_bf16 v[64:79], v[40:43], v[248:251], v[64:79]
    ds_read_b128 v[32:35], v1 offset:0
    buffer_load_dwordx4 a[64:67], v28, s[4:7], s26 offen
    v_mfma_f32_32x32x16_bf16 v[80:95], v[44:47], v[248:251], v[80:95]
    ds_read_b128 v[36:39], v1 offset:1024
    s_waitcnt lgkmcnt(4)
    v_mfma_f32_32x32x16_bf16 v[96:111], v[48:51], v[248:251], v[96:111]
    ds_read_b128 v[40:43], v1 offset:2048
    buffer_load_dwordx4 a[68:71], v29, s[4:7], s26 offen
    s_waitcnt vmcnt(20)
    v_mfma_f32_32x32x16_bf16 v[64:79], v[52:55], v[252:255], v[64:79]
    ds_read_b128 v[44:47], v1 offset:3072
    s_add_u32 s26, s30, 30720
    s_waitcnt lgkmcnt(4)
    v_mfma_f32_32x32x16_bf16 v[80:95], v[56:59], v[252:255], v[80:95]
    ds_read_b128 v[48:51], v1 offset:4096
    buffer_load_dwordx4 a[120:123], v28, s[4:7], s26 offen
    v_mfma_f32_32x32x16_bf16 v[96:111], v[60:63], v[252:255], v[96:111]
    ds_read_b128 v[52:55], v1 offset:5120
    s_waitcnt lgkmcnt(4)
    v_mfma_f32_32x32x16_bf16 v[112:127], v[32:35], v[128:131], 0
    ds_read_b128 v[56:59], v1 offset:6144
    buffer_load_dwordx4 a[124:127], v29, s[4:7], s26 offen
    s_barrier
    v_mfma_f32_32x32x16_bf16 v[112:127], v[36:39], v[132:135], v[112:127]
    ds_read_b128 v[60:63], v1 offset:7168
    s_add_u32 m0, s23, 65536
    s_add_u32 s50, s39, 163840
    s_add_u32 s26, s30, 45056
    s_waitcnt lgkmcnt(4)
    v_mfma_f32_32x32x16_bf16 v[112:127], v[40:43], v[136:139], v[112:127]
    ds_read_b128 v[32:35], v1 offset:8192
    buffer_load_dwordx4 v1, s[4:7], s50 offen lds
    v_mfma_f32_32x32x16_bf16 v[112:127], v[44:47], v[140:143], v[112:127]
    ds_read_b128 v[36:39], v1 offset:9216
    buffer_load_dwordx4 a[176:179], v28, s[4:7], s26 offen
    v_exp_f32_e64 v64, -v64
    s_waitcnt lgkmcnt(4)
    v_mfma_f32_32x32x16_bf16 v[112:127], v[48:51], v[144:147], v[112:127]
    ds_read_b128 v[40:43], v1 offset:10240
    buffer_load_dwordx4 v1, s[4:7], s50 offen offset:1024 lds
    v_add_f32 v64, 1.0, v64
    v_exp_f32_e64 v65, -v65
    v_mfma_f32_32x32x16_bf16 v[112:127], v[52:55], v[148:151], v[112:127]
    ds_read_b128 v[44:47], v1 offset:11264
    buffer_load_dwordx4 a[180:183], v29, s[4:7], s26 offen
    v_add_f32 v65, 1.0, v65
    v_exp_f32_e64 v66, -v66
    s_waitcnt lgkmcnt(4)
    v_mfma_f32_32x32x16_bf16 v[112:127], v[56:59], v[152:155], v[112:127]
    ds_read_b128 v[48:51], v1 offset:12288
    buffer_load_dwordx4 v1, s[4:7], s50 offen offset:2048 lds
    s_add_u32 s26, s30, 4096
    v_add_f32 v66, 1.0, v66
    v_exp_f32_e64 v67, -v67
    v_mfma_f32_32x32x16_bf16 v[112:127], v[60:63], v[156:159], v[112:127]
    ds_read_b128 v[52:55], v1 offset:13312
    buffer_load_dwordx4 a[16:19], v28, s[4:7], s26 offen
    v_add_f32 v67, 1.0, v67
    v_exp_f32_e64 v68, -v68
    s_waitcnt lgkmcnt(4)
    v_mfma_f32_32x32x16_bf16 v[112:127], v[32:35], v[160:163], v[112:127]
    ds_read_b128 v[56:59], v1 offset:14336
    buffer_load_dwordx4 v1, s[4:7], s50 offen offset:3072 lds
    v_add_f32 v68, 1.0, v68
    v_exp_f32_e64 v69, -v69
    v_mfma_f32_32x32x16_bf16 v[112:127], v[36:39], v[164:167], v[112:127]
    ds_read_b128 v[60:63], v1 offset:15360
    buffer_load_dwordx4 a[20:23], v29, s[4:7], s26 offen
    s_add_u32 m0, s23, 69632
    s_add_u32 s50, s39, 167936
    v_add_f32 v69, 1.0, v69
    v_exp_f32_e64 v70, -v70
    s_waitcnt lgkmcnt(4)
    v_mfma_f32_32x32x16_bf16 v[112:127], v[40:43], v[168:171], v[112:127]
    ds_read_b128 v[32:35], v1 offset:16384
    buffer_load_dwordx4 v1, s[4:7], s50 offen lds
    s_add_u32 s26, s30, 18432
    v_add_f32 v70, 1.0, v70
    v_exp_f32_e64 v71, -v71
    v_mfma_f32_32x32x16_bf16 v[112:127], v[44:47], v[172:175], v[112:127]
    ds_read_b128 v[36:39], v1 offset:17408
    buffer_load_dwordx4 a[72:75], v28, s[4:7], s26 offen
    v_rcp_f32 v64, v64
    v_add_f32 v71, 1.0, v71
    s_waitcnt lgkmcnt(4)
    v_mfma_f32_32x32x16_bf16 v[112:127], v[48:51], v[176:179], v[112:127]
    ds_read_b128 v[40:43], v1 offset:18432
    buffer_load_dwordx4 v1, s[4:7], s50 offen offset:1024 lds
    v_mul_f32 v64, v64, v72
    v_rcp_f32 v65, v65
    v_mfma_f32_32x32x16_bf16 v[112:127], v[52:55], v[180:183], v[112:127]
    ds_read_b128 v[44:47], v1 offset:19456
    buffer_load_dwordx4 a[76:79], v29, s[4:7], s26 offen
    s_add_u32 s94, s36, 13631488
    v_mul_f32 v65, v65, v73
    v_rcp_f32 v66, v66
    s_waitcnt lgkmcnt(4)
    v_mfma_f32_32x32x16_bf16 v[112:127], v[56:59], v[184:187], v[112:127]
    ds_read_b128 v[48:51], v1 offset:20480
    s_add_u32 s26, s30, 32768
    v_mul_f32 v66, v66, v74
    v_rcp_f32 v67, v67
    v_cvt_pk_bf16_f32 v72, v64, v65
    v_mfma_f32_32x32x16_bf16 v[112:127], v[60:63], v[188:191], v[112:127]
    ds_read_b128 v[52:55], v1 offset:21504
    buffer_load_dwordx4 v1, s[4:7], s50 offen offset:2048 lds
    v_mul_f32 v67, v67, v75
    v_rcp_f32 v68, v68
    s_waitcnt lgkmcnt(4)
    v_mfma_f32_32x32x16_bf16 v[112:127], v[32:35], v[192:195], v[112:127]
    ds_read_b128 v[56:59], v1 offset:22528
    buffer_load_dwordx4 a[128:131], v28, s[4:7], s26 offen
    v_mul_f32 v68, v68, v76
    v_rcp_f32 v69, v69
    v_cvt_pk_bf16_f32 v73, v66, v67
    v_mfma_f32_32x32x16_bf16 v[112:127], v[36:39], v[196:199], v[112:127]
    ds_read_b128 v[60:63], v1 offset:23552
    buffer_load_dwordx4 v1, s[4:7], s50 offen offset:3072 lds
    v_mul_f32 v69, v69, v77
    v_rcp_f32 v70, v70
    s_waitcnt lgkmcnt(4)
    v_mfma_f32_32x32x16_bf16 v[112:127], v[40:43], v[200:203], v[112:127]
    ds_read_b128 v[32:35], v1 offset:24576
    buffer_load_dwordx4 a[132:135], v29, s[4:7], s26 offen
    v_mul_f32 v70, v70, v78
    v_rcp_f32 v71, v71
    v_cvt_pk_bf16_f32 v74, v68, v69
    v_mfma_f32_32x32x16_bf16 v[112:127], v[44:47], v[204:207], v[112:127]
    ds_read_b128 v[36:39], v1 offset:25600
    s_add_u32 m0, s23, 98304
    s_add_u32 s50, s39, 196608
    s_add_u32 s26, s30, 47104
    v_mul_f32 v71, v71, v79
    v_exp_f32_e64 v80, -v80
    s_waitcnt lgkmcnt(4)
    v_mfma_f32_32x32x16_bf16 v[112:127], v[48:51], v[208:211], v[112:127]
    ds_read_b128 v[40:43], v1 offset:26624
    buffer_load_dwordx4 a[184:187], v28, s[4:7], s26 offen
    v_add_f32 v80, 1.0, v80
    v_exp_f32_e64 v81, -v81
    v_cvt_pk_bf16_f32 v75, v70, v71
    v_mfma_f32_32x32x16_bf16 v[112:127], v[52:55], v[212:215], v[112:127]
    ds_read_b128 v[44:47], v1 offset:27648
    buffer_store_dwordx4 v[72:75], v1, s[4:7], s94 offen sc1
    v_add_f32 v81, 1.0, v81
    v_exp_f32_e64 v82, -v82
    s_waitcnt lgkmcnt(4)
    v_mfma_f32_32x32x16_bf16 v[112:127], v[56:59], v[216:219], v[112:127]
    ds_read_b128 v[48:51], v1 offset:28672
    buffer_load_dwordx4 a[188:191], v29, s[4:7], s26 offen
    v_add_f32 v82, 1.0, v82
    v_exp_f32_e64 v83, -v83
    v_mfma_f32_32x32x16_bf16 v[112:127], v[60:63], v[220:223], v[112:127]
    ds_read_b128 v[52:55], v1 offset:29696
    buffer_load_dwordx4 v1, s[4:7], s50 offen lds
    s_add_u32 s26, s30, 6144
    v_add_f32 v83, 1.0, v83
    v_exp_f32_e64 v84, -v84
    s_waitcnt lgkmcnt(4)
    v_mfma_f32_32x32x16_bf16 v[112:127], v[32:35], v[224:227], v[112:127]
    ds_read_b128 v[56:59], v1 offset:30720
    buffer_load_dwordx4 a[24:27], v28, s[4:7], s26 offen
    v_add_f32 v84, 1.0, v84
    v_exp_f32_e64 v85, -v85
    v_mfma_f32_32x32x16_bf16 v[112:127], v[36:39], v[228:231], v[112:127]
    ds_read_b128 v[60:63], v1 offset:31744
    s_waitcnt vmcnt(35)
    s_barrier
    v_add_f32 v85, 1.0, v85
    v_exp_f32_e64 v86, -v86
    s_waitcnt lgkmcnt(4)
    v_mfma_f32_32x32x16_bf16 v[112:127], v[40:43], v[232:235], v[112:127]
    ds_read_b128 v[32:35], v1 offset:32768
    buffer_load_dwordx4 v1, s[4:7], s50 offen offset:1024 lds
    v_add_f32 v86, 1.0, v86
    v_exp_f32_e64 v87, -v87
    v_mfma_f32_32x32x16_bf16 v[112:127], v[44:47], v[236:239], v[112:127]
    ds_read_b128 v[36:39], v1 offset:33792
    buffer_load_dwordx4 a[28:31], v29, s[4:7], s26 offen
    v_rcp_f32 v80, v80
    v_add_f32 v87, 1.0, v87
    s_waitcnt lgkmcnt(4)
    v_mfma_f32_32x32x16_bf16 v[112:127], v[48:51], v[240:243], v[112:127]
    ds_read_b128 v[40:43], v1 offset:34816
    buffer_load_dwordx4 v1, s[4:7], s50 offen offset:2048 lds
    s_add_u32 s26, s30, 20480
    v_mul_f32 v80, v80, v88
    v_rcp_f32 v81, v81
    v_mfma_f32_32x32x16_bf16 v[112:127], v[52:55], v[244:247], v[112:127]
    ds_read_b128 v[44:47], v1 offset:35840
    buffer_load_dwordx4 a[80:83], v28, s[4:7], s26 offen
    s_add_u32 s95, s36, 13635584
    v_mul_f32 v81, v81, v89
    v_rcp_f32 v82, v82
    s_waitcnt lgkmcnt(4)
    v_mfma_f32_32x32x16_bf16 v[112:127], v[56:59], v[248:251], v[112:127]
    ds_read_b128 v[48:51], v1 offset:36864
    v_mul_f32 v82, v82, v90
    v_rcp_f32 v83, v83
    v_cvt_pk_bf16_f32 v88, v80, v81
    v_mfma_f32_32x32x16_bf16 v[112:127], v[60:63], v[252:255], v[112:127]
    ds_read_b128 v[52:55], v1 offset:37888
    buffer_load_dwordx4 v1, s[4:7], s50 offen offset:3072 lds
    s_add_u32 m0, s23, 102400
    v_mul_f32 v83, v83, v91
    v_rcp_f32 v84, v84
    s_waitcnt lgkmcnt(4)
    v_mfma_f32_32x32x16_bf16 v[64:79], v[32:35], v[128:131], 0
    ds_read_b128 v[56:59], v1 offset:38912
    buffer_load_dwordx4 a[84:87], v29, s[4:7], s26 offen
    v_mul_f32 v84, v84, v92
    v_rcp_f32 v85, v85
    v_cvt_pk_bf16_f32 v89, v82, v83
    v_mfma_f32_32x32x16_bf16 v[64:79], v[36:39], v[132:135], v[64:79]
    ds_read_b128 v[60:63], v1 offset:39936
    s_add_u32 s50, s39, 200704
    s_add_u32 s26, s30, 34816
    v_mul_f32 v85, v85, v93
    v_rcp_f32 v86, v86
    s_waitcnt lgkmcnt(4)
    v_mfma_f32_32x32x16_bf16 v[64:79], v[40:43], v[136:139], v[64:79]
    ds_read_b128 v[32:35], v1 offset:40960
    buffer_load_dwordx4 a[136:139], v28, s[4:7], s26 offen
    v_mul_f32 v86, v86, v94
    v_rcp_f32 v87, v87
    v_cvt_pk_bf16_f32 v90, v84, v85
    v_mfma_f32_32x32x16_bf16 v[64:79], v[44:47], v[140:143], v[64:79]
    ds_read_b128 v[36:39], v1 offset:41984
    buffer_load_dwordx4 v1, s[4:7], s50 offen lds
    v_mul_f32 v87, v87, v95
    v_exp_f32_e64 v96, -v96
    s_waitcnt lgkmcnt(4)
    v_mfma_f32_32x32x16_bf16 v[64:79], v[48:51], v[144:147], v[64:79]
    ds_read_b128 v[40:43], v1 offset:43008
    buffer_load_dwordx4 a[140:143], v29, s[4:7], s26 offen
    v_add_f32 v96, 1.0, v96
    v_exp_f32_e64 v97, -v97
    v_cvt_pk_bf16_f32 v91, v86, v87
    v_mfma_f32_32x32x16_bf16 v[64:79], v[52:55], v[148:151], v[64:79]
    ds_read_b128 v[44:47], v1 offset:44032
    buffer_store_dwordx4 v[88:91], v1, s[4:7], s95 offen sc1
    s_add_u32 s26, s30, 49152
    v_add_f32 v97, 1.0, v97
    v_exp_f32_e64 v98, -v98
    s_waitcnt lgkmcnt(4)
    v_mfma_f32_32x32x16_bf16 v[64:79], v[56:59], v[152:155], v[64:79]
    ds_read_b128 v[48:51], v1 offset:45056
    buffer_load_dwordx4 a[192:195], v28, s[4:7], s26 offen
    v_add_f32 v98, 1.0, v98
    v_exp_f32_e64 v99, -v99
    v_mfma_f32_32x32x16_bf16 v[64:79], v[60:63], v[156:159], v[64:79]
    ds_read_b128 v[52:55], v1 offset:46080
    buffer_load_dwordx4 v1, s[4:7], s50 offen offset:1024 lds
    v_add_f32 v99, 1.0, v99
    v_exp_f32_e64 v100, -v100
    s_waitcnt lgkmcnt(4)
    v_mfma_f32_32x32x16_bf16 v[64:79], v[32:35], v[160:163], v[64:79]
    ds_read_b128 v[56:59], v1 offset:47104
    buffer_load_dwordx4 a[196:199], v29, s[4:7], s26 offen
    v_add_f32 v100, 1.0, v100
    v_exp_f32_e64 v101, -v101
    v_mfma_f32_32x32x16_bf16 v[64:79], v[36:39], v[164:167], v[64:79]
    ds_read_b128 v[60:63], v1 offset:48128
    buffer_load_dwordx4 v1, s[4:7], s50 offen offset:2048 lds
    s_add_u32 s26, s30, 8192
    v_add_f32 v101, 1.0, v101
    v_exp_f32_e64 v102, -v102
    s_waitcnt lgkmcnt(4)
    v_mfma_f32_32x32x16_bf16 v[64:79], v[40:43], v[168:171], v[64:79]
    ds_read_b128 v[32:35], v1 offset:49152
    buffer_load_dwordx4 a[32:35], v28, s[4:7], s26 offen
    v_add_f32 v102, 1.0, v102
    v_exp_f32_e64 v103, -v103
    v_mfma_f32_32x32x16_bf16 v[64:79], v[44:47], v[172:175], v[64:79]
    ds_read_b128 v[36:39], v1 offset:50176
    buffer_load_dwordx4 v1, s[4:7], s50 offen offset:3072 lds
    v_rcp_f32 v96, v96
    v_add_f32 v103, 1.0, v103
    s_waitcnt lgkmcnt(4)
    v_mfma_f32_32x32x16_bf16 v[64:79], v[48:51], v[176:179], v[64:79]
    ds_read_b128 v[40:43], v1 offset:51200
    buffer_load_dwordx4 a[36:39], v29, s[4:7], s26 offen
    v_mul_f32 v96, v96, v104
    v_rcp_f32 v97, v97
    v_mfma_f32_32x32x16_bf16 v[64:79], v[52:55], v[180:183], v[64:79]
    ds_read_b128 v[44:47], v1 offset:52224
    s_add_u32 s94, s36, 13639680
    s_add_u32 s26, s30, 22528
    v_mul_f32 v97, v97, v105
    v_rcp_f32 v98, v98
    s_waitcnt lgkmcnt(4)
    v_mfma_f32_32x32x16_bf16 v[64:79], v[56:59], v[184:187], v[64:79]
    ds_read_b128 v[48:51], v1 offset:53248
    buffer_load_dwordx4 a[88:91], v28, s[4:7], s26 offen
    v_mul_f32 v98, v98, v106
    v_rcp_f32 v99, v99
    v_cvt_pk_bf16_f32 v104, v96, v97
    v_mfma_f32_32x32x16_bf16 v[64:79], v[60:63], v[188:191], v[64:79]
    ds_read_b128 v[52:55], v1 offset:54272
    v_mul_f32 v99, v99, v107
    v_rcp_f32 v100, v100
    s_waitcnt lgkmcnt(4)
    v_mfma_f32_32x32x16_bf16 v[64:79], v[32:35], v[192:195], v[64:79]
    ds_read_b128 v[56:59], v1 offset:55296
    buffer_load_dwordx4 a[92:95], v29, s[4:7], s26 offen
    v_mul_f32 v100, v100, v108
    v_rcp_f32 v101, v101
    v_cvt_pk_bf16_f32 v105, v98, v99
    v_mfma_f32_32x32x16_bf16 v[64:79], v[36:39], v[196:199], v[64:79]
    ds_read_b128 v[60:63], v1 offset:56320
    s_add_u32 s26, s30, 36864
    v_mul_f32 v101, v101, v109
    v_rcp_f32 v102, v102
    s_waitcnt lgkmcnt(4)
    v_mfma_f32_32x32x16_bf16 v[64:79], v[40:43], v[200:203], v[64:79]
    ds_read_b128 v[32:35], v1 offset:57344
    buffer_load_dwordx4 a[144:147], v28, s[4:7], s26 offen
    v_mul_f32 v102, v102, v110
    v_rcp_f32 v103, v103
    v_cvt_pk_bf16_f32 v106, v100, v101
    v_mfma_f32_32x32x16_bf16 v[64:79], v[44:47], v[204:207], v[64:79]
    ds_read_b128 v[36:39], v1 offset:58368
    v_mul_f32 v103, v103, v111
    v_exp_f32_e64 v112, -v112
    s_waitcnt lgkmcnt(4)
    v_mfma_f32_32x32x16_bf16 v[64:79], v[48:51], v[208:211], v[64:79]
    ds_read_b128 v[40:43], v1 offset:59392
    buffer_load_dwordx4 a[148:151], v29, s[4:7], s26 offen
    v_add_f32 v112, 1.0, v112
    v_exp_f32_e64 v113, -v113
    v_cvt_pk_bf16_f32 v107, v102, v103
    v_mfma_f32_32x32x16_bf16 v[64:79], v[52:55], v[212:215], v[64:79]
    ds_read_b128 v[44:47], v1 offset:60416
    buffer_store_dwordx4 v[104:107], v1, s[4:7], s94 offen sc1
    s_add_u32 s26, s30, 51200
    v_add_f32 v113, 1.0, v113
    v_exp_f32_e64 v114, -v114
    s_waitcnt lgkmcnt(4)
    v_mfma_f32_32x32x16_bf16 v[64:79], v[56:59], v[216:219], v[64:79]
    ds_read_b128 v[48:51], v1 offset:61440
    buffer_load_dwordx4 a[200:203], v28, s[4:7], s26 offen
    v_add_f32 v114, 1.0, v114
    v_exp_f32_e64 v115, -v115
    v_mfma_f32_32x32x16_bf16 v[64:79], v[60:63], v[220:223], v[64:79]
    ds_read_b128 v[52:55], v1 offset:62464
    v_add_f32 v115, 1.0, v115
    v_exp_f32_e64 v116, -v116
    s_waitcnt lgkmcnt(4)
    v_mfma_f32_32x32x16_bf16 v[64:79], v[32:35], v[224:227], v[64:79]
    ds_read_b128 v[56:59], v1 offset:63488
    buffer_load_dwordx4 a[204:207], v29, s[4:7], s26 offen
    v_add_f32 v116, 1.0, v116
    v_exp_f32_e64 v117, -v117
    v_mfma_f32_32x32x16_bf16 v[64:79], v[36:39], v[228:231], v[64:79]
    ds_read_b128 v[60:63], v1 offset:64512
    s_waitcnt vmcnt(30)
    s_barrier
    s_add_u32 s26, s30, 10240
    v_add_f32 v117, 1.0, v117
    v_exp_f32_e64 v118, -v118
    s_waitcnt lgkmcnt(4)
    v_mfma_f32_32x32x16_bf16 v[64:79], v[40:43], v[232:235], v[64:79]
    ds_read_b128 v[32:35], v2 offset:0
    buffer_load_dwordx4 a[40:43], v28, s[4:7], s26 offen
    v_add_f32 v118, 1.0, v118
    v_exp_f32_e64 v119, -v119
    v_mfma_f32_32x32x16_bf16 v[64:79], v[44:47], v[236:239], v[64:79]
    ds_read_b128 v[36:39], v2 offset:1024
    v_rcp_f32 v112, v112
    v_add_f32 v119, 1.0, v119
    s_waitcnt lgkmcnt(4)
    v_mfma_f32_32x32x16_bf16 v[64:79], v[48:51], v[240:243], v[64:79]
    ds_read_b128 v[40:43], v2 offset:2048
    buffer_load_dwordx4 a[44:47], v29, s[4:7], s26 offen
    v_mul_f32 v112, v112, v120
    v_rcp_f32 v113, v113
    v_mfma_f32_32x32x16_bf16 v[64:79], v[52:55], v[244:247], v[64:79]
    ds_read_b128 v[44:47], v2 offset:3072
    s_add_u32 s95, s36, 13643776
    s_add_u32 s26, s30, 24576
    v_mul_f32 v113, v113, v121
    v_rcp_f32 v114, v114
    s_waitcnt lgkmcnt(4)
    v_mfma_f32_32x32x16_bf16 v[64:79], v[56:59], v[248:251], v[64:79]
    ds_read_b128 v[48:51], v2 offset:4096
    buffer_load_dwordx4 a[96:99], v28, s[4:7], s26 offen
    v_mul_f32 v114, v114, v122
    v_rcp_f32 v115, v115
    v_cvt_pk_bf16_f32 v120, v112, v113
    v_mfma_f32_32x32x16_bf16 v[64:79], v[60:63], v[252:255], v[64:79]
    ds_read_b128 v[52:55], v2 offset:5120
    v_mul_f32 v115, v115, v123
    v_rcp_f32 v116, v116
    s_waitcnt lgkmcnt(4)
    v_mfma_f32_32x32x16_bf16 v[80:95], v[32:35], v[128:131], 0
    ds_read_b128 v[56:59], v2 offset:6144
    buffer_load_dwordx4 a[100:103], v29, s[4:7], s26 offen
    v_mul_f32 v116, v116, v124
    v_rcp_f32 v117, v117
    v_cvt_pk_bf16_f32 v121, v114, v115
    v_mfma_f32_32x32x16_bf16 v[80:95], v[36:39], v[132:135], v[80:95]
    ds_read_b128 v[60:63], v2 offset:7168
    s_waitcnt vmcnt(6)
    s_add_u32 s26, s30, 38912
    v_mul_f32 v117, v117, v125
    v_rcp_f32 v118, v118
    s_waitcnt lgkmcnt(4)
    v_mfma_f32_32x32x16_bf16 v[80:95], v[40:43], v[136:139], v[80:95]
    ds_read_b128 v[32:35], v2 offset:8192
    buffer_load_dwordx4 a[152:155], v28, s[4:7], s26 offen
    v_mul_f32 v118, v118, v126
    v_rcp_f32 v119, v119
    v_cvt_pk_bf16_f32 v122, v116, v117
    v_mfma_f32_32x32x16_bf16 v[80:95], v[44:47], v[140:143], v[80:95]
    ds_read_b128 v[36:39], v2 offset:9216
    buffer_store_dword v18, v6, s[4:7], s42 offen
    v_mul_f32 v119, v119, v127
    v_exp_f32_e64 v64, -v64
    s_waitcnt lgkmcnt(4)
    v_mfma_f32_32x32x16_bf16 v[80:95], v[48:51], v[144:147], v[80:95]
    ds_read_b128 v[40:43], v2 offset:10240
    buffer_load_dwordx4 a[156:159], v29, s[4:7], s26 offen
    v_add_f32 v64, 1.0, v64
    v_exp_f32_e64 v65, -v65
    v_cvt_pk_bf16_f32 v123, v118, v119
    v_mfma_f32_32x32x16_bf16 v[80:95], v[52:55], v[148:151], v[80:95]
    ds_read_b128 v[44:47], v2 offset:11264
    buffer_store_dwordx4 v[120:123], v1, s[4:7], s95 offen sc1
    s_add_u32 s26, s30, 53248
    v_add_f32 v65, 1.0, v65
    v_exp_f32_e64 v66, -v66
    s_waitcnt lgkmcnt(4)
    v_mfma_f32_32x32x16_bf16 v[80:95], v[56:59], v[152:155], v[80:95]
    ds_read_b128 v[48:51], v2 offset:12288
    buffer_load_dwordx4 a[208:211], v28, s[4:7], s26 offen
    v_add_f32 v66, 1.0, v66
    v_exp_f32_e64 v67, -v67
    v_mfma_f32_32x32x16_bf16 v[80:95], v[60:63], v[156:159], v[80:95]
    ds_read_b128 v[52:55], v2 offset:13312
    v_add_f32 v67, 1.0, v67
    v_exp_f32_e64 v68, -v68
    s_waitcnt lgkmcnt(4)
    v_mfma_f32_32x32x16_bf16 v[80:95], v[32:35], v[160:163], v[80:95]
    ds_read_b128 v[56:59], v2 offset:14336
    buffer_load_dwordx4 a[212:215], v29, s[4:7], s26 offen
    v_add_f32 v68, 1.0, v68
    v_exp_f32_e64 v69, -v69
    v_mfma_f32_32x32x16_bf16 v[80:95], v[36:39], v[164:167], v[80:95]
    ds_read_b128 v[60:63], v2 offset:15360
    s_add_u32 s26, s30, 12288
    v_add_f32 v69, 1.0, v69
    v_exp_f32_e64 v70, -v70
    s_waitcnt lgkmcnt(4)
    v_mfma_f32_32x32x16_bf16 v[80:95], v[40:43], v[168:171], v[80:95]
    ds_read_b128 v[32:35], v2 offset:16384
    buffer_load_dwordx4 a[48:51], v28, s[4:7], s26 offen
    v_add_f32 v70, 1.0, v70
    v_exp_f32_e64 v71, -v71
    v_mfma_f32_32x32x16_bf16 v[80:95], v[44:47], v[172:175], v[80:95]
    ds_read_b128 v[36:39], v2 offset:17408
    buffer_load_dword v17, v4, s[4:7], s43 offen sc1
    v_rcp_f32 v64, v64
    v_add_f32 v71, 1.0, v71
    s_waitcnt lgkmcnt(4)
    v_mfma_f32_32x32x16_bf16 v[80:95], v[48:51], v[176:179], v[80:95]
    ds_read_b128 v[40:43], v2 offset:18432
    buffer_load_dwordx4 a[52:55], v29, s[4:7], s26 offen
    v_mul_f32 v64, v64, v72
    v_rcp_f32 v65, v65
    v_mfma_f32_32x32x16_bf16 v[80:95], v[52:55], v[180:183], v[80:95]
    ds_read_b128 v[44:47], v2 offset:19456
    s_add_u32 s94, s36, 13647872
    s_add_u32 s26, s30, 26624
    v_mul_f32 v65, v65, v73
    v_rcp_f32 v66, v66
    s_waitcnt lgkmcnt(4)
    v_mfma_f32_32x32x16_bf16 v[80:95], v[56:59], v[184:187], v[80:95]
    ds_read_b128 v[48:51], v2 offset:20480
    buffer_load_dwordx4 a[104:107], v28, s[4:7], s26 offen
    v_mul_f32 v66, v66, v74
    v_rcp_f32 v67, v67
    v_cvt_pk_bf16_f32 v72, v64, v65
    v_mfma_f32_32x32x16_bf16 v[80:95], v[60:63], v[188:191], v[80:95]
    ds_read_b128 v[52:55], v2 offset:21504
    v_mul_f32 v67, v67, v75
    v_rcp_f32 v68, v68
    s_waitcnt lgkmcnt(4)
    v_mfma_f32_32x32x16_bf16 v[80:95], v[32:35], v[192:195], v[80:95]
    ds_read_b128 v[56:59], v2 offset:22528
    buffer_load_dwordx4 a[108:111], v29, s[4:7], s26 offen
    v_mul_f32 v68, v68, v76
    v_rcp_f32 v69, v69
    v_cvt_pk_bf16_f32 v73, v66, v67
    v_mfma_f32_32x32x16_bf16 v[80:95], v[36:39], v[196:199], v[80:95]
    ds_read_b128 v[60:63], v2 offset:23552
    s_add_u32 s26, s30, 40960
    v_mul_f32 v69, v69, v77
    v_rcp_f32 v70, v70
    s_waitcnt lgkmcnt(4)
    v_mfma_f32_32x32x16_bf16 v[80:95], v[40:43], v[200:203], v[80:95]
    ds_read_b128 v[32:35], v2 offset:24576
    buffer_load_dwordx4 a[160:163], v28, s[4:7], s26 offen
    v_mul_f32 v70, v70, v78
    v_rcp_f32 v71, v71
    v_cvt_pk_bf16_f32 v74, v68, v69
    v_mfma_f32_32x32x16_bf16 v[80:95], v[44:47], v[204:207], v[80:95]
    ds_read_b128 v[36:39], v2 offset:25600
    s_lshr_b32 s48, s16, 1
    s_cmp_eq_u32 s48, s19
    s_cselect_b32 s48, 0, 2147483648
    v_mul_f32 v71, v71, v79
    v_add_u32 v30, s48, v7
    s_waitcnt lgkmcnt(4)
    v_mfma_f32_32x32x16_bf16 v[80:95], v[48:51], v[208:211], v[80:95]
    ds_read_b128 v[40:43], v2 offset:26624
    buffer_load_dwordx4 a[164:167], v29, s[4:7], s26 offen
    s_lshl_b32 s48, s16, 13
    s_sub_u32 s47, s34, s48
    s_and_b32 s48, s16, 1
    v_cvt_pk_bf16_f32 v75, v70, v71
    v_mfma_f32_32x32x16_bf16 v[80:95], v[52:55], v[212:215], v[80:95]
    ds_read_b128 v[44:47], v2 offset:27648
    buffer_store_dwordx4 v[72:75], v1, s[4:7], s94 offen sc1
    s_lshl_b32 s48, s48, 14
    s_add_u32 s47, s47, s48
    s_add_u32 s47, s47, 1048576
    s_add_u32 s26, s30, 55296
    v_accvgpr_write_b32 a232, -1
    s_waitcnt lgkmcnt(4)
    v_mfma_f32_32x32x16_bf16 v[80:95], v[56:59], v[216:219], v[80:95]
    ds_read_b128 v[48:51], v2 offset:28672
    buffer_load_dwordx4 a[216:219], v28, s[4:7], s26 offen
    s_add_u32 s96, s37, 13631488
    v_accvgpr_write_b32 a233, -1
    v_accvgpr_write_b32 a234, -1
    v_accvgpr_write_b32 a235, -1
    v_mfma_f32_32x32x16_bf16 v[80:95], v[60:63], v[220:223], v[80:95]
    ds_read_b128 v[52:55], v2 offset:29696
    s_waitcnt vmcnt(7)
    s_add_u32 s97, s37, 13635584
    v_cmp_ne_u32 vcc, s51, v17
    s_cbranch_vccnz L_polls_34
L_pollb_35:
    s_waitcnt lgkmcnt(4)
    v_mfma_f32_32x32x16_bf16 v[80:95], v[32:35], v[224:227], v[80:95]
    ds_read_b128 v[56:59], v2 offset:30720
    buffer_load_dwordx4 a[236:239], v1, s[4:7], s96 offen sc1
    v_mfma_f32_32x32x16_bf16 v[80:95], v[36:39], v[228:231], v[80:95]
    ds_read_b128 v[60:63], v2 offset:31744
    buffer_load_dwordx4 a[220:223], v29, s[4:7], s26 offen
    s_barrier
    s_waitcnt lgkmcnt(4)
    v_mfma_f32_32x32x16_bf16 v[80:95], v[40:43], v[232:235], v[80:95]
    ds_read_b128 v[32:35], v2 offset:32768
    buffer_load_dwordx4 a[240:243], v1, s[4:7], s96 offen offset:1024 sc1
    v_mfma_f32_32x32x16_bf16 v[80:95], v[44:47], v[236:239], v[80:95]
    ds_read_b128 v[36:39], v2 offset:33792
    s_waitcnt lgkmcnt(4)
    v_mfma_f32_32x32x16_bf16 v[80:95], v[48:51], v[240:243], v[80:95]
    ds_read_b128 v[40:43], v2 offset:34816
    buffer_store_dwordx4 a[232:235], v30, s[4:7], s47 offen
    s_add_u32 s47, s47, 4096
    v_mfma_f32_32x32x16_bf16 v[80:95], v[52:55], v[244:247], v[80:95]
    ds_read_b128 v[44:47], v2 offset:35840
    s_waitcnt lgkmcnt(4)
    v_mfma_f32_32x32x16_bf16 v[80:95], v[56:59], v[248:251], v[80:95]
    ds_read_b128 v[48:51], v2 offset:36864
    buffer_store_dwordx4 a[232:235], v30, s[4:7], s47 offen
    s_add_u32 s47, s47, 4096
    v_mfma_f32_32x32x16_bf16 v[80:95], v[60:63], v[252:255], v[80:95]
    ds_read_b128 v[52:55], v2 offset:37888
    s_waitcnt lgkmcnt(4)
    v_mfma_f32_32x32x16_bf16 v[96:111], v[32:35], v[128:131], 0
    ds_read_b128 v[56:59], v2 offset:38912
    buffer_store_dwordx4 a[232:235], v30, s[4:7], s47 offen
    s_add_u32 s47, s47, 4096
    v_mfma_f32_32x32x16_bf16 v[96:111], v[36:39], v[132:135], v[96:111]
    ds_read_b128 v[60:63], v2 offset:39936
    s_waitcnt lgkmcnt(4)
    v_mfma_f32_32x32x16_bf16 v[96:111], v[40:43], v[136:139], v[96:111]
    ds_read_b128 v[32:35], v2 offset:40960
    buffer_store_dwordx4 a[232:235], v30, s[4:7], s47 offen
    v_mfma_f32_32x32x16_bf16 v[96:111], v[44:47], v[140:143], v[96:111]
    ds_read_b128 v[36:39], v2 offset:41984
    s_waitcnt lgkmcnt(4)
    v_mfma_f32_32x32x16_bf16 v[96:111], v[48:51], v[144:147], v[96:111]
    ds_read_b128 v[40:43], v2 offset:43008
    buffer_load_dwordx4 a[244:247], v1, s[4:7], s96 offen offset:2048 sc1
    v_exp_f32_e64 v80, -v80
    v_mfma_f32_32x32x16_bf16 v[96:111], v[52:55], v[148:151], v[96:111]
    ds_read_b128 v[44:47], v2 offset:44032
    v_add_f32 v80, 1.0, v80
    v_exp_f32_e64 v81, -v81
    s_waitcnt lgkmcnt(4)
    v_mfma_f32_32x32x16_bf16 v[96:111], v[56:59], v[152:155], v[96:111]
    ds_read_b128 v[48:51], v2 offset:45056
    buffer_load_dwordx4 a[248:251], v1, s[4:7], s96 offen offset:3072 sc1
    v_add_f32 v81, 1.0, v81
    v_exp_f32_e64 v82, -v82
    v_mfma_f32_32x32x16_bf16 v[96:111], v[60:63], v[156:159], v[96:111]
    ds_read_b128 v[52:55], v2 offset:46080
    s_add_u32 s96, s37, 13639680
    v_add_f32 v82, 1.0, v82
    v_exp_f32_e64 v83, -v83
    s_waitcnt lgkmcnt(4)
    v_mfma_f32_32x32x16_bf16 v[96:111], v[32:35], v[160:163], v[96:111]
    ds_read_b128 v[56:59], v2 offset:47104
    buffer_load_dwordx4 a[252:255], v1, s[4:7], s97 offen sc1
    v_add_f32 v83, 1.0, v83
    v_exp_f32_e64 v84, -v84
    v_mfma_f32_32x32x16_bf16 v[96:111], v[36:39], v[164:167], v[96:111]
    ds_read_b128 v[60:63], v2 offset:48128
    v_add_f32 v84, 1.0, v84
    v_exp_f32_e64 v85, -v85
    s_waitcnt lgkmcnt(4)
    v_mfma_f32_32x32x16_bf16 v[96:111], v[40:43], v[168:171], v[96:111]
    ds_read_b128 v[32:35], v2 offset:49152
    buffer_load_dwordx4 v[128:131], v1, s[4:7], s97 offen offset:1024 sc1
    v_add_f32 v85, 1.0, v85
    v_exp_f32_e64 v86, -v86
    v_mfma_f32_32x32x16_bf16 v[96:111], v[44:47], v[172:175], v[96:111]
    ds_read_b128 v[36:39], v2 offset:50176
    v_add_f32 v86, 1.0, v86
    v_exp_f32_e64 v87, -v87
    s_waitcnt lgkmcnt(4)
    v_mfma_f32_32x32x16_bf16 v[96:111], v[48:51], v[176:179], v[96:111]
    ds_read_b128 v[40:43], v2 offset:51200
    buffer_load_dwordx4 v[132:135], v1, s[4:7], s97 offen offset:2048 sc1
    v_rcp_f32 v80, v80
    v_add_f32 v87, 1.0, v87
    v_mfma_f32_32x32x16_bf16 v[96:111], v[52:55], v[180:183], v[96:111]
    ds_read_b128 v[44:47], v2 offset:52224
    v_mul_f32 v80, v80, v88
    v_rcp_f32 v81, v81
    s_waitcnt lgkmcnt(4)
    v_mfma_f32_32x32x16_bf16 v[96:111], v[56:59], v[184:187], v[96:111]
    ds_read_b128 v[48:51], v2 offset:53248
    s_add_u32 s95, s36, 13651968
    v_mul_f32 v81, v81, v89
    v_rcp_f32 v82, v82
    v_mfma_f32_32x32x16_bf16 v[96:111], v[60:63], v[188:191], v[96:111]
    ds_read_b128 v[52:55], v2 offset:54272
    buffer_load_dwordx4 v[136:139], v1, s[4:7], s97 offen offset:3072 sc1
    v_mul_f32 v82, v82, v90
    v_rcp_f32 v83, v83
    v_cvt_pk_bf16_f32 v88, v80, v81
    s_waitcnt lgkmcnt(4)
    v_mfma_f32_32x32x16_bf16 v[96:111], v[32:35], v[192:195], v[96:111]
    ds_read_b128 v[56:59], v2 offset:55296
    s_add_u32 s97, s37, 13746176
    v_mul_f32 v83, v83, v91
    v_rcp_f32 v84, v84
    v_mfma_f32_32x32x16_bf16 v[96:111], v[36:39], v[196:199], v[96:111]
    ds_read_b128 v[60:63], v2 offset:56320
    buffer_load_dwordx4 v[140:143], v1, s[4:7], s96 offen sc1
    v_mul_f32 v84, v84, v92
    v_rcp_f32 v85, v85
    v_cvt_pk_bf16_f32 v89, v82, v83
    s_waitcnt lgkmcnt(4)
    v_mfma_f32_32x32x16_bf16 v[96:111], v[40:43], v[200:203], v[96:111]
    ds_read_b128 v[32:35], v2 offset:57344
    v_mul_f32 v85, v85, v93
    v_rcp_f32 v86, v86
    v_mfma_f32_32x32x16_bf16 v[96:111], v[44:47], v[204:207], v[96:111]
    ds_read_b128 v[36:39], v2 offset:58368
    buffer_load_dwordx4 v[144:147], v1, s[4:7], s96 offen offset:1024 sc1
    v_mul_f32 v86, v86, v94
    v_rcp_f32 v87, v87
    v_cvt_pk_bf16_f32 v90, v84, v85
    s_waitcnt lgkmcnt(4)
    v_mfma_f32_32x32x16_bf16 v[96:111], v[48:51], v[208:211], v[96:111]
    ds_read_b128 v[40:43], v2 offset:59392
    v_mul_f32 v87, v87, v95
    v_mfma_f32_32x32x16_bf16 v[96:111], v[52:55], v[212:215], v[96:111]
    ds_read_b128 v[44:47], v2 offset:60416
    v_cvt_pk_bf16_f32 v91, v86, v87
    s_waitcnt lgkmcnt(4)
    v_mfma_f32_32x32x16_bf16 v[96:111], v[56:59], v[216:219], v[96:111]
    ds_read_b128 v[48:51], v2 offset:61440
    buffer_store_dwordx4 v[88:91], v1, s[4:7], s95 offen sc1
    v_mfma_f32_32x32x16_bf16 v[96:111], v[60:63], v[220:223], v[96:111]
    ds_read_b128 v[52:55], v2 offset:62464
    s_waitcnt lgkmcnt(4)
    v_mfma_f32_32x32x16_bf16 v[96:111], v[32:35], v[224:227], v[96:111]
    ds_read_b128 v[56:59], v2 offset:63488
    buffer_load_dwordx4 v[148:151], v1, s[4:7], s96 offen offset:2048 sc1
    v_mfma_f32_32x32x16_bf16 v[96:111], v[36:39], v[228:231], v[96:111]
    ds_read_b128 v[60:63], v2 offset:64512
    s_waitcnt lgkmcnt(4)
    v_mfma_f32_32x32x16_bf16 v[96:111], v[40:43], v[232:235], v[96:111]
    buffer_load_dwordx4 v[152:155], v1, s[4:7], s96 offen offset:3072 sc1
    s_add_u32 s96, s37, 13750272
    v_mfma_f32_32x32x16_bf16 v[96:111], v[44:47], v[236:239], v[96:111]
    s_waitcnt lgkmcnt(2)
    v_mfma_f32_32x32x16_bf16 v[96:111], v[48:51], v[240:243], v[96:111]
    buffer_load_dwordx4 v[156:159], v1, s[4:7], s97 offen sc1
    v_mfma_f32_32x32x16_bf16 v[96:111], v[52:55], v[244:247], v[96:111]
    s_waitcnt lgkmcnt(0)
    v_mfma_f32_32x32x16_bf16 v[96:111], v[56:59], v[248:251], v[96:111]
    buffer_load_dwordx4 v[160:163], v1, s[4:7], s97 offen offset:1024 sc1
    v_mfma_f32_32x32x16_bf16 v[96:111], v[60:63], v[252:255], v[96:111]
    s_waitcnt vmcnt(19)
    v_mfma_f32_32x32x16_bf16 v[64:79], a[0:3], a[236:239], 0
    buffer_load_dwordx4 v[164:167], v1, s[4:7], s97 offen offset:2048 sc1
    v_mfma_f32_32x32x16_bf16 v[80:95], a[4:7], a[236:239], 0
    s_waitcnt vmcnt(18)
    v_mfma_f32_32x32x16_bf16 v[64:79], a[56:59], a[240:243], v[64:79]
    buffer_load_dwordx4 v[168:171], v1, s[4:7], s97 offen offset:3072 sc1
    s_waitcnt vmcnt(6)
    s_add_u32 s97, s37, 13754368
    v_mfma_f32_32x32x16_bf16 v[80:95], a[60:63], a[240:243], v[80:95]
    buffer_store_dword v18, v6, s[4:7], s42 offen offset:256
    v_mfma_f32_32x32x16_bf16 v[64:79], a[112:115], a[244:247], v[64:79]
    buffer_load_dwordx4 v[172:175], v1, s[4:7], s96 offen sc1
    v_exp_f32_e64 v96, -v96
    v_mfma_f32_32x32x16_bf16 v[80:95], a[116:119], a[244:247], v[80:95]
    v_add_f32 v96, 1.0, v96
    v_exp_f32_e64 v97, -v97
    v_mfma_f32_32x32x16_bf16 v[64:79], a[168:171], a[248:251], v[64:79]
    buffer_load_dwordx4 v[176:179], v1, s[4:7], s96 offen offset:1024 sc1
    v_add_f32 v97, 1.0, v97
    v_exp_f32_e64 v98, -v98
    v_mfma_f32_32x32x16_bf16 v[80:95], a[172:175], a[248:251], v[80:95]
    v_add_f32 v98, 1.0, v98
    v_exp_f32_e64 v99, -v99
    v_mfma_f32_32x32x16_bf16 v[64:79], a[8:11], a[252:255], v[64:79]
    buffer_load_dwordx4 v[180:183], v1, s[4:7], s96 offen offset:2048 sc1
    v_add_f32 v99, 1.0, v99
    v_exp_f32_e64 v100, -v100
    v_mfma_f32_32x32x16_bf16 v[80:95], a[12:15], a[252:255], v[80:95]
    v_add_f32 v100, 1.0, v100
    v_exp_f32_e64 v101, -v101
    v_mfma_f32_32x32x16_bf16 v[64:79], a[64:67], v[128:131], v[64:79]
    buffer_load_dwordx4 v[184:187], v1, s[4:7], s96 offen offset:3072 sc1
    v_add_f32 v101, 1.0, v101
    v_exp_f32_e64 v102, -v102
    v_mfma_f32_32x32x16_bf16 v[80:95], a[68:71], v[128:131], v[80:95]
    buffer_load_dword v17, v4, s[4:7], s43 offen offset:256 sc1
    v_add_f32 v102, 1.0, v102
    v_exp_f32_e64 v103, -v103
    v_mfma_f32_32x32x16_bf16 v[64:79], a[120:123], v[132:135], v[64:79]
    buffer_load_dwordx4 v[188:191], v1, s[4:7], s97 offen sc1
    v_rcp_f32 v96, v96
    v_add_f32 v103, 1.0, v103
    v_mfma_f32_32x32x16_bf16 v[80:95], a[124:127], v[132:135], v[80:95]
    v_mul_f32 v96, v96, v104
    v_rcp_f32 v97, v97
    v_mfma_f32_32x32x16_bf16 v[64:79], a[176:179], v[136:139], v[64:79]
    buffer_load_dwordx4 v[192:195], v1, s[4:7], s97 offen offset:1024 sc1
    s_add_u32 s94, s36, 13656064
    v_mul_f32 v97, v97, v105
    v_rcp_f32 v98, v98
    v_mfma_f32_32x32x16_bf16 v[80:95], a[180:183], v[136:139], v[80:95]
    v_mul_f32 v98, v98, v106
    v_rcp_f32 v99, v99
    v_cvt_pk_bf16_f32 v104, v96, v97
    v_mfma_f32_32x32x16_bf16 v[64:79], a[16:19], v[140:143], v[64:79]
    buffer_load_dwordx4 v[196:199], v1, s[4:7], s97 offen offset:2048 sc1
    v_mul_f32 v99, v99, v107
    v_rcp_f32 v100, v100
    v_mfma_f32_32x32x16_bf16 v[80:95], a[20:23], v[140:143], v[80:95]
    v_mul_f32 v100, v100, v108
    v_rcp_f32 v101, v101
    v_cvt_pk_bf16_f32 v105, v98, v99
    v_mfma_f32_32x32x16_bf16 v[64:79], a[72:75], v[144:147], v[64:79]
    buffer_load_dwordx4 v[200:203], v1, s[4:7], s97 offen offset:3072 sc1
    v_mul_f32 v101, v101, v109
    v_rcp_f32 v102, v102
    v_mfma_f32_32x32x16_bf16 v[80:95], a[76:79], v[144:147], v[80:95]
    v_mul_f32 v102, v102, v110
    v_rcp_f32 v103, v103
    v_cvt_pk_bf16_f32 v106, v100, v101
    s_waitcnt vmcnt(15)
    v_mfma_f32_32x32x16_bf16 v[64:79], a[128:131], v[148:151], v[64:79]
    v_mul_f32 v103, v103, v111
    v_mfma_f32_32x32x16_bf16 v[80:95], a[132:135], v[148:151], v[80:95]
    v_cvt_pk_bf16_f32 v107, v102, v103
    s_waitcnt vmcnt(14)
    v_mfma_f32_32x32x16_bf16 v[64:79], a[184:187], v[152:155], v[64:79]
    buffer_store_dwordx4 v[104:107], v1, s[4:7], s94 offen sc1
    v_mfma_f32_32x32x16_bf16 v[80:95], a[188:191], v[152:155], v[80:95]
    s_add_u32 s96, s37, 13643776
    s_add_u32 s97, s37, 13647872
    s_waitcnt vmcnt(14)
    v_mfma_f32_32x32x16_bf16 v[112:127], a[0:3], v[156:159], 0
    v_mfma_f32_32x32x16_bf16 v[96:111], a[4:7], v[156:159], 0
    s_waitcnt vmcnt(5)
    v_cmp_ne_u32 vcc, s51, v17
    s_cbranch_vccnz L_polls_37
L_pollb_38:
    v_mfma_f32_32x32x16_bf16 v[112:127], a[56:59], v[160:163], v[112:127]
    buffer_load_dwordx4 v[204:207], v1, s[4:7], s96 offen sc1
    v_mfma_f32_32x32x16_bf16 v[96:111], a[60:63], v[160:163], v[96:111]
    v_mfma_f32_32x32x16_bf16 v[112:127], a[112:115], v[164:167], v[112:127]
    buffer_load_dwordx4 v[208:211], v1, s[4:7], s96 offen offset:1024 sc1
    v_mfma_f32_32x32x16_bf16 v[96:111], a[116:119], v[164:167], v[96:111]
    v_mfma_f32_32x32x16_bf16 v[112:127], a[168:171], v[168:171], v[112:127]
    buffer_load_dwordx4 v[212:215], v1, s[4:7], s96 offen offset:2048 sc1
    v_mfma_f32_32x32x16_bf16 v[96:111], a[172:175], v[168:171], v[96:111]
    v_mfma_f32_32x32x16_bf16 v[112:127], a[8:11], v[172:175], v[112:127]
    buffer_load_dwordx4 v[216:219], v1, s[4:7], s96 offen offset:3072 sc1
    s_add_u32 s96, s37, 13651968
    v_mfma_f32_32x32x16_bf16 v[96:111], a[12:15], v[172:175], v[96:111]
    v_mfma_f32_32x32x16_bf16 v[112:127], a[64:67], v[176:179], v[112:127]
    buffer_load_dwordx4 v[220:223], v1, s[4:7], s97 offen sc1
    s_waitcnt vmcnt(5)
    v_mfma_f32_32x32x16_bf16 v[96:111], a[68:71], v[176:179], v[96:111]
    buffer_store_dword v18, v6, s[4:7], s42 offen offset:512
    v_mfma_f32_32x32x16_bf16 v[112:127], a[120:123], v[180:183], v[112:127]
    buffer_load_dwordx4 v[224:227], v1, s[4:7], s97 offen offset:1024 sc1
    v_mfma_f32_32x32x16_bf16 v[96:111], a[124:127], v[180:183], v[96:111]
    v_mfma_f32_32x32x16_bf16 v[112:127], a[176:179], v[184:187], v[112:127]
    buffer_load_dwordx4 v[228:231], v1, s[4:7], s97 offen offset:2048 sc1
    v_mfma_f32_32x32x16_bf16 v[96:111], a[180:183], v[184:187], v[96:111]
    v_mfma_f32_32x32x16_bf16 v[112:127], a[16:19], v[188:191], v[112:127]
    buffer_load_dwordx4 v[232:235], v1, s[4:7], s97 offen offset:3072 sc1
    s_add_u32 s97, s37, 13758464
    v_mfma_f32_32x32x16_bf16 v[96:111], a[20:23], v[188:191], v[96:111]
    v_mfma_f32_32x32x16_bf16 v[112:127], a[72:75], v[192:195], v[112:127]
    buffer_load_dwordx4 v[236:239], v1, s[4:7], s96 offen sc1
    v_mfma_f32_32x32x16_bf16 v[96:111], a[76:79], v[192:195], v[96:111]
    buffer_load_dword v17, v4, s[4:7], s43 offen offset:512 sc1
    v_mfma_f32_32x32x16_bf16 v[112:127], a[128:131], v[196:199], v[112:127]
    buffer_load_dwordx4 v[240:243], v1, s[4:7], s96 offen offset:1024 sc1
    v_mfma_f32_32x32x16_bf16 v[96:111], a[132:135], v[196:199], v[96:111]
    v_mfma_f32_32x32x16_bf16 v[112:127], a[184:187], v[200:203], v[112:127]
    buffer_load_dwordx4 v[244:247], v1, s[4:7], s96 offen offset:2048 sc1
    v_mfma_f32_32x32x16_bf16 v[96:111], a[188:191], v[200:203], v[96:111]
    s_waitcnt vmcnt(12)
    v_mfma_f32_32x32x16_bf16 v[64:79], a[24:27], v[204:207], v[64:79]
    buffer_load_dwordx4 v[248:251], v1, s[4:7], s96 offen offset:3072 sc1
    v_mfma_f32_32x32x16_bf16 v[80:95], a[28:31], v[204:207], v[80:95]
    s_waitcnt vmcnt(12)
    v_mfma_f32_32x32x16_bf16 v[64:79], a[80:83], v[208:211], v[64:79]
    buffer_load_dwordx4 v[252:255], v1, s[4:7], s97 offen sc1
    v_mfma_f32_32x32x16_bf16 v[80:95], a[84:87], v[208:211], v[80:95]
    s_waitcnt vmcnt(12)
    v_mfma_f32_32x32x16_bf16 v[64:79], a[136:139], v[212:215], v[64:79]
    buffer_load_dwordx4 a[236:239], v1, s[4:7], s97 offen offset:1024 sc1
    v_mfma_f32_32x32x16_bf16 v[80:95], a[140:143], v[212:215], v[80:95]
    s_waitcnt vmcnt(12)
    v_mfma_f32_32x32x16_bf16 v[64:79], a[192:195], v[216:219], v[64:79]
    buffer_load_dwordx4 a[240:243], v1, s[4:7], s97 offen offset:2048 sc1
    v_mfma_f32_32x32x16_bf16 v[80:95], a[196:199], v[216:219], v[80:95]
    s_add_u32 s96, s37, 13656064
    s_waitcnt vmcnt(12)
    v_mfma_f32_32x32x16_bf16 v[64:79], a[32:35], v[220:223], v[64:79]
    buffer_load_dwordx4 a[244:247], v1, s[4:7], s97 offen offset:3072 sc1
    s_add_u32 s97, s37, 13762560
    v_mfma_f32_32x32x16_bf16 v[80:95], a[36:39], v[220:223], v[80:95]
    s_waitcnt vmcnt(7)
    v_cmp_ne_u32 vcc, s51, v17
    s_cbranch_vccnz L_polls_40
L_pollb_41:
    v_mfma_f32_32x32x16_bf16 v[64:79], a[88:91], v[224:227], v[64:79]
    buffer_load_dwordx4 a[248:251], v1, s[4:7], s96 offen sc1
    v_mfma_f32_32x32x16_bf16 v[80:95], a[92:95], v[224:227], v[80:95]
    v_mfma_f32_32x32x16_bf16 v[64:79], a[144:147], v[228:231], v[64:79]
    buffer_load_dwordx4 a[252:255], v1, s[4:7], s96 offen offset:1024 sc1
    v_mfma_f32_32x32x16_bf16 v[80:95], a[148:151], v[228:231], v[80:95]
    v_mfma_f32_32x32x16_bf16 v[64:79], a[200:203], v[232:235], v[64:79]
    buffer_load_dwordx4 v[128:131], v1, s[4:7], s96 offen offset:2048 sc1
    v_mfma_f32_32x32x16_bf16 v[80:95], a[204:207], v[232:235], v[80:95]
    v_mfma_f32_32x32x16_bf16 v[64:79], a[40:43], v[236:239], v[64:79]
    buffer_load_dwordx4 v[132:135], v1, s[4:7], s96 offen offset:3072 sc1
    s_add_u32 s96, s37, 13766656
    v_mfma_f32_32x32x16_bf16 v[80:95], a[44:47], v[236:239], v[80:95]
    s_waitcnt vmcnt(10)
    v_mfma_f32_32x32x16_bf16 v[64:79], a[96:99], v[240:243], v[64:79]
    buffer_load_dwordx4 v[136:139], v1, s[4:7], s97 offen sc1
    v_mfma_f32_32x32x16_bf16 v[80:95], a[100:103], v[240:243], v[80:95]
    s_waitcnt vmcnt(10)
    v_mfma_f32_32x32x16_bf16 v[64:79], a[152:155], v[244:247], v[64:79]
    buffer_load_dwordx4 v[140:143], v1, s[4:7], s97 offen offset:1024 sc1
    v_mfma_f32_32x32x16_bf16 v[80:95], a[156:159], v[244:247], v[80:95]
    s_waitcnt vmcnt(10)
    v_mfma_f32_32x32x16_bf16 v[64:79], a[208:211], v[248:251], v[64:79]
    buffer_load_dwordx4 v[144:147], v1, s[4:7], s97 offen offset:2048 sc1
    v_mfma_f32_32x32x16_bf16 v[80:95], a[212:215], v[248:251], v[80:95]
    s_waitcnt vmcnt(10)
    v_mfma_f32_32x32x16_bf16 v[112:127], a[24:27], v[252:255], v[112:127]
    buffer_load_dwordx4 v[148:151], v1, s[4:7], s97 offen offset:3072 sc1
    s_add_u32 s97, s37, 13770752
    v_mfma_f32_32x32x16_bf16 v[96:111], a[28:31], v[252:255], v[96:111]
    s_waitcnt vmcnt(10)
    v_mfma_f32_32x32x16_bf16 v[112:127], a[80:83], a[236:239], v[112:127]
    buffer_load_dwordx4 v[152:155], v1, s[4:7], s96 offen sc1
    v_mfma_f32_32x32x16_bf16 v[96:111], a[84:87], a[236:239], v[96:111]
    s_waitcnt vmcnt(10)
    v_mfma_f32_32x32x16_bf16 v[112:127], a[136:139], a[240:243], v[112:127]
    buffer_load_dwordx4 v[156:159], v1, s[4:7], s96 offen offset:1024 sc1
    v_mfma_f32_32x32x16_bf16 v[96:111], a[140:143], a[240:243], v[96:111]
    s_waitcnt vmcnt(10)
    v_mfma_f32_32x32x16_bf16 v[112:127], a[192:195], a[244:247], v[112:127]
    buffer_load_dwordx4 v[160:163], v1, s[4:7], s96 offen offset:2048 sc1
    v_mfma_f32_32x32x16_bf16 v[96:111], a[196:199], a[244:247], v[96:111]
    s_waitcnt vmcnt(10)
    v_mfma_f32_32x32x16_bf16 v[64:79], a[48:51], a[248:251], v[64:79]
    buffer_load_dwordx4 v[164:167], v1, s[4:7], s96 offen offset:3072 sc1
    v_mfma_f32_32x32x16_bf16 v[80:95], a[52:55], a[248:251], v[80:95]
    s_waitcnt vmcnt(10)
    v_mfma_f32_32x32x16_bf16 v[64:79], a[104:107], a[252:255], v[64:79]
    buffer_load_dwordx4 v[168:171], v1, s[4:7], s97 offen sc1
    v_mfma_f32_32x32x16_bf16 v[80:95], a[108:111], a[252:255], v[80:95]
    s_waitcnt vmcnt(10)
    v_mfma_f32_32x32x16_bf16 v[64:79], a[160:163], v[128:131], v[64:79]
    buffer_load_dwordx4 v[172:175], v1, s[4:7], s97 offen offset:1024 sc1
    v_mfma_f32_32x32x16_bf16 v[80:95], a[164:167], v[128:131], v[80:95]
    s_waitcnt vmcnt(10)
    v_mfma_f32_32x32x16_bf16 v[80:95], a[220:223], v[132:135], v[80:95]
    buffer_load_dwordx4 v[176:179], v1, s[4:7], s97 offen offset:2048 sc1
    v_mfma_f32_32x32x16_bf16 v[64:79], a[216:219], v[132:135], v[64:79]
    s_waitcnt vmcnt(10)
    v_mfma_f32_32x32x16_bf16 v[112:127], a[32:35], v[136:139], v[112:127]
    buffer_load_dwordx4 v[180:183], v1, s[4:7], s97 offen offset:3072 sc1
    v_mfma_f32_32x32x16_bf16 v[96:111], a[36:39], v[136:139], v[96:111]
    s_waitcnt vmcnt(10)
    v_mfma_f32_32x32x16_bf16 v[112:127], a[88:91], v[140:143], v[112:127]
    v_mfma_f32_32x32x16_bf16 v[96:111], a[92:95], v[140:143], v[96:111]
    s_waitcnt vmcnt(9)
    v_mfma_f32_32x32x16_bf16 v[112:127], a[144:147], v[144:147], v[112:127]
    s_nop 0
    ds_write_b128 v13, v[80:83] offset:0
    ds_write_b128 v13, v[84:87] offset:1024
    v_mfma_f32_32x32x16_bf16 v[96:111], a[148:151], v[144:147], v[96:111]
    ds_write_b128 v15, v[88:91] offset:0
    ds_write_b128 v15, v[92:95] offset:1024
    ds_write_b128 v14, v[72:75] offset:0
    s_waitcnt vmcnt(8)
    v_mfma_f32_32x32x16_bf16 v[112:127], a[200:203], v[148:151], v[112:127]
    ds_write_b128 v14, v[76:79] offset:1024
    v_mfma_f32_32x32x16_bf16 v[96:111], a[204:207], v[148:151], v[96:111]
    s_waitcnt lgkmcnt(0)
    s_barrier
    s_waitcnt vmcnt(7)
    v_mfma_f32_32x32x16_bf16 v[112:127], a[40:43], v[152:155], v[112:127]
    ds_read_b128 v[32:35], v16 offset:0
    ds_read_b128 v[36:39], v16 offset:1024
    ds_read_b128 v[40:43], v16 offset:2048
    ds_read_b128 v[44:47], v16 offset:3072
    ds_read_b128 v[48:51], v16 offset:4096
    v_mfma_f32_32x32x16_bf16 v[96:111], a[44:47], v[152:155], v[96:111]
    ds_read_b128 v[52:55], v16 offset:5120
    s_waitcnt vmcnt(6)
    v_mfma_f32_32x32x16_bf16 v[112:127], a[96:99], v[156:159], v[112:127]
    v_mfma_f32_32x32x16_bf16 v[96:111], a[100:103], v[156:159], v[96:111]
    s_waitcnt vmcnt(5)
    v_mfma_f32_32x32x16_bf16 v[112:127], a[152:155], v[160:163], v[112:127]
    s_waitcnt lgkmcnt(0)
    v_add_f32 v32, v32, v40
    v_add_f32 v33, v33, v41
    v_add_f32 v34, v34, v42
    v_add_f32 v35, v35, v43
    v_mfma_f32_32x32x16_bf16 v[96:111], a[156:159], v[160:163], v[96:111]
    v_add_f32 v36, v36, v44
    v_add_f32 v37, v37, v45
    v_add_f32 v38, v38, v46
    v_add_f32 v39, v39, v47
    v_add_f32 v64, v64, v48
    v_add_f32 v65, v65, v49
    s_waitcnt vmcnt(4)
    v_mfma_f32_32x32x16_bf16 v[112:127], a[208:211], v[164:167], v[112:127]
    v_add_f32 v66, v66, v50
    v_add_f32 v67, v67, v51
    v_add_f32 v68, v68, v52
    v_add_f32 v69, v69, v53
    v_add_f32 v70, v70, v54
    v_mfma_f32_32x32x16_bf16 v[96:111], a[212:215], v[164:167], v[96:111]
    v_add_f32 v71, v71, v55
    v_add_f32 v64, v64, v32
    v_add_f32 v65, v65, v33
    v_add_f32 v66, v66, v34
    v_add_f32 v67, v67, v35
    v_add_f32 v68, v68, v36
    s_waitcnt vmcnt(3)
    v_mfma_f32_32x32x16_bf16 v[112:127], a[48:51], v[168:171], v[112:127]
    v_add_f32 v69, v69, v37
    v_add_f32 v70, v70, v38
    v_add_f32 v71, v71, v39
    v_mul_f32 v64, s98, v64
    v_mul_f32 v65, s98, v65
    v_mfma_f32_32x32x16_bf16 v[96:111], a[52:55], v[168:171], v[96:111]
    v_mul_f32 v66, s98, v66
    v_mul_f32 v67, s98, v67
    v_mul_f32 v68, s98, v68
    v_mul_f32 v69, s98, v69
    v_mul_f32 v70, s98, v70
    v_mul_f32 v71, s98, v71
    s_waitcnt vmcnt(2)
    v_mfma_f32_32x32x16_bf16 v[112:127], a[104:107], v[172:175], v[112:127]
    s_barrier
    v_cvt_pk_bf16_f32 v32, v64, v65
    v_cvt_pk_bf16_f32 v33, v66, v67
    v_cvt_pk_bf16_f32 v34, v68, v69
    v_cvt_pk_bf16_f32 v35, v70, v71
    v_mfma_f32_32x32x16_bf16 v[96:111], a[108:111], v[172:175], v[96:111]
    s_add_u32 s46, s38, 1048576
    buffer_store_dwordx4 v[32:35], v1, s[4:7], s46 offen
    s_waitcnt vmcnt(2)
    v_mfma_f32_32x32x16_bf16 v[112:127], a[160:163], v[176:179], v[112:127]
    v_mfma_f32_32x32x16_bf16 v[96:111], a[164:167], v[176:179], v[96:111]
    s_waitcnt vmcnt(1)
    v_mfma_f32_32x32x16_bf16 v[96:111], a[220:223], v[180:183], v[96:111]
    v_mfma_f32_32x32x16_bf16 v[112:127], a[216:219], v[180:183], v[112:127]
    s_nop 10
    ds_write_b128 v13, v[96:99] offset:0
    ds_write_b128 v13, v[100:103] offset:1024
    ds_write_b128 v15, v[104:107] offset:0
    ds_write_b128 v15, v[108:111] offset:1024
    ds_write_b128 v14, v[120:123] offset:0
    ds_write_b128 v14, v[124:127] offset:1024
    s_waitcnt lgkmcnt(0)
    s_barrier
    ds_read_b128 v[32:35], v16 offset:0
    ds_read_b128 v[36:39], v16 offset:1024
    ds_read_b128 v[40:43], v16 offset:2048
    ds_read_b128 v[44:47], v16 offset:3072
    ds_read_b128 v[48:51], v16 offset:4096
    ds_read_b128 v[52:55], v16 offset:5120
    s_waitcnt lgkmcnt(0)
    v_pk_add_f32 v[32:33], v[32:33], v[40:41]
    v_pk_add_f32 v[34:35], v[34:35], v[42:43]
    v_pk_add_f32 v[36:37], v[36:37], v[44:45]
    v_pk_add_f32 v[38:39], v[38:39], v[46:47]
    v_pk_add_f32 v[112:113], v[112:113], v[48:49]
    v_pk_add_f32 v[114:115], v[114:115], v[50:51]
    v_pk_add_f32 v[116:117], v[116:117], v[52:53]
    v_pk_add_f32 v[118:119], v[118:119], v[54:55]
    v_pk_add_f32 v[112:113], v[112:113], v[32:33]
    v_pk_add_f32 v[114:115], v[114:115], v[34:35]
    v_pk_add_f32 v[116:117], v[116:117], v[36:37]
    v_pk_add_f32 v[118:119], v[118:119], v[38:39]
    v_pk_mul_f32 v[112:113], v[112:113], s[98:99]
    v_pk_mul_f32 v[114:115], v[114:115], s[98:99]
    v_pk_mul_f32 v[116:117], v[116:117], s[98:99]
    v_pk_mul_f32 v[118:119], v[118:119], s[98:99]
    v_cvt_pk_bf16_f32 v32, v112, v113
    v_cvt_pk_bf16_f32 v33, v114, v115
    v_cvt_pk_bf16_f32 v34, v116, v117
    v_cvt_pk_bf16_f32 v35, v118, v119
    s_add_u32 s46, s38, 1081344
    buffer_store_dwordx4 v[32:35], v1, s[4:7], s46 offen
    s_add_u32 s46, s34, 1048576
    s_add_u32 s47, s34, 1052672
    buffer_load_dwordx4 v[128:131], v7, s[4:7], s46 offen sc1
    buffer_load_dwordx4 v[132:135], v7, s[4:7], s47 offen sc1
    v_lshlrev_b32 v176, 16, v20
    v_and_b32 v177, s31, v20
    v_lshlrev_b32 v178, 16, v21
    v_and_b32 v179, s31, v21
    v_lshlrev_b32 v180, 16, v22
    v_and_b32 v181, s31, v22
    v_lshlrev_b32 v182, 16, v23
    v_and_b32 v183, s31, v23
    v_lshlrev_b32 v184, 16, v24
    v_and_b32 v185, s31, v24
    v_lshlrev_b32 v186, 16, v25
    v_and_b32 v187, s31, v25
    v_lshlrev_b32 v188, 16, v26
    v_and_b32 v189, s31, v26
    v_lshlrev_b32 v190, 16, v27
    v_and_b32 v191, s31, v27
    s_lshr_b32 s24, s18, 3
    s_mul_i32 s24, s24, 917504
    s_and_b32 s25, s18, 7
    s_lshl_b32 s25, s25, 17
    s_sub_u32 s24, s24, s25
    s_add_u32 s64, s24, 5242880
    s_add_u32 s40, s40, 4096
    s_add_u32 s41, s41, 4096
    s_add_u32 s42, s42, 16384
    s_add_u32 s43, s43, 16384
    v_accvgpr_read_b32 v136, a224
    v_accvgpr_read_b32 v137, a225
    v_accvgpr_read_b32 v138, a226
    v_accvgpr_read_b32 v139, a227
    v_accvgpr_read_b32 v140, a228
    v_accvgpr_read_b32 v141, a229
    v_accvgpr_read_b32 v142, a230
    v_accvgpr_read_b32 v143, a231
    v_lshlrev_b32 v160, 16, v136
    v_and_b32 v161, s31, v136
    v_lshlrev_b32 v162, 16, v137
    v_and_b32 v163, s31, v137
    v_lshlrev_b32 v164, 16, v138
    v_and_b32 v165, s31, v138
    v_lshlrev_b32 v166, 16, v139
    v_and_b32 v167, s31, v139
    v_lshlrev_b32 v168, 16, v140
    v_and_b32 v169, s31, v140
    v_lshlrev_b32 v170, 16, v141
    v_and_b32 v171, s31, v141
    v_lshlrev_b32 v172, 16, v142
    v_and_b32 v173, s31, v142
    v_lshlrev_b32 v174, 16, v143
    v_and_b32 v175, s31, v143
    s_waitcnt vmcnt(0)
    v_max3_u32 v31, v128, v132, v132
    v_cmp_eq_u32 vcc, -1, v31
    s_cbranch_vccnz L_mks_43
L_mkb_44:
    v_lshlrev_b32 v144, 16, v128
    v_and_b32 v145, s31, v128
    v_lshlrev_b32 v146, 16, v129
    v_and_b32 v147, s31, v129
    v_lshlrev_b32 v148, 16, v130
    v_and_b32 v149, s31, v130
    v_lshlrev_b32 v150, 16, v131
    v_and_b32 v151, s31, v131
    v_lshlrev_b32 v152, 16, v132
    v_and_b32 v153, s31, v132
    v_lshlrev_b32 v154, 16, v133
    v_and_b32 v155, s31, v133
    v_lshlrev_b32 v156, 16, v134
    v_and_b32 v157, s31, v134
    v_lshlrev_b32 v158, 16, v135
    v_and_b32 v159, s31, v135
    v_pk_add_f32 v[144:145], v[144:145], v[176:177]
    v_pk_add_f32 v[146:147], v[146:147], v[178:179]
    v_pk_add_f32 v[148:149], v[148:149], v[180:181]
    v_pk_add_f32 v[150:151], v[150:151], v[182:183]
    v_pk_add_f32 v[152:153], v[152:153], v[184:185]
    v_pk_add_f32 v[154:155], v[154:155], v[186:187]
    v_pk_add_f32 v[156:157], v[156:157], v[188:189]
    v_pk_add_f32 v[158:159], v[158:159], v[190:191]
    v_cvt_pk_bf16_f32 v128, v144, v145
    v_cvt_pk_bf16_f32 v129, v146, v147
    v_cvt_pk_bf16_f32 v130, v148, v149
    v_cvt_pk_bf16_f32 v131, v150, v151
    v_cvt_pk_bf16_f32 v132, v152, v153
    v_cvt_pk_bf16_f32 v133, v154, v155
    v_cvt_pk_bf16_f32 v134, v156, v157
    v_cvt_pk_bf16_f32 v135, v158, v159
    v_lshlrev_b32 v144, 16, v128
    v_and_b32 v145, s31, v128
    v_lshlrev_b32 v146, 16, v129
    v_and_b32 v147, s31, v129
    v_lshlrev_b32 v148, 16, v130
    v_and_b32 v149, s31, v130
    v_lshlrev_b32 v150, 16, v131
    v_and_b32 v151, s31, v131
    v_lshlrev_b32 v152, 16, v132
    v_and_b32 v153, s31, v132
    v_lshlrev_b32 v154, 16, v133
    v_and_b32 v155, s31, v133
    v_lshlrev_b32 v156, 16, v134
    v_and_b32 v157, s31, v134
    v_lshlrev_b32 v158, 16, v135
    v_and_b32 v159, s31, v135
    v_pk_add_f32 v[192:193], v[144:145], v[146:147]
    v_pk_mul_f32 v[194:195], v[144:145], v[144:145]
    v_pk_fma_f32 v[194:195], v[146:147], v[146:147], v[194:195]
    v_pk_fma_f32 v[194:195], v[148:149], v[148:149], v[194:195]
    v_pk_add_f32 v[192:193], v[192:193], v[148:149]
    v_pk_fma_f32 v[194:195], v[150:151], v[150:151], v[194:195]
    v_pk_add_f32 v[192:193], v[192:193], v[150:151]
    v_pk_fma_f32 v[194:195], v[152:153], v[152:153], v[194:195]
    v_pk_add_f32 v[192:193], v[192:193], v[152:153]
    v_pk_fma_f32 v[194:195], v[154:155], v[154:155], v[194:195]
    v_pk_add_f32 v[192:193], v[192:193], v[154:155]
    v_pk_fma_f32 v[194:195], v[156:157], v[156:157], v[194:195]
    v_pk_add_f32 v[192:193], v[192:193], v[156:157]
    v_pk_fma_f32 v[194:195], v[158:159], v[158:159], v[194:195]
    v_pk_add_f32 v[192:193], v[192:193], v[158:159]
    v_add_f32 v192, v192, v193
    v_add_f32 v194, v194, v195
    s_nop 1
    v_permlane16_swap_b32 v192, v194
    v_add_f32 v192, v192, v194
    s_nop 1
    v_add_f32_dpp v192, v192, v192 row_ror:8 row_mask:0xf bank_mask:0xf
    v_mov_b32 v193, v192
    s_nop 1
    v_permlane32_swap_b32 v192, v193
    v_add_f32 v192, v192, v193
    s_mov_b64 exec, 0x00ff00ff
    ds_write_b32 v11, v192 offset:0
    s_mov_b64 exec, -1
    s_waitcnt lgkmcnt(0)
    s_barrier
    ds_read_b128 v[196:199], v12 offset:0
    ds_read_b128 v[200:203], v12 offset:16
    s_waitcnt lgkmcnt(0)
    v_pk_add_f32 v[196:197], v[196:197], v[198:199]
    v_pk_add_f32 v[200:201], v[200:201], v[202:203]
    v_pk_add_f32 v[196:197], v[196:197], v[200:201]
    v_mul_f32 v196, 0x3b000000, v196
    v_mul_f32 v197, 0x3b000000, v197
    v_fma_f32 v197, -v196, v196, v197
    v_max_f32 v197, 0, v197
    v_add_f32 v197, 0x3727c5ac, v197
    v_rsq_f32 v204, v197
    s_nop 0
    v_mul_f32_e64 v206, -v196, v204
    v_pk_fma_f32 v[176:177], v[144:145], v[204:205], v[206:207] op_sel_hi:[1,0,0]
    v_pk_fma_f32 v[178:179], v[146:147], v[204:205], v[206:207] op_sel_hi:[1,0,0]
    v_pk_fma_f32 v[180:181], v[148:149], v[204:205], v[206:207] op_sel_hi:[1,0,0]
    v_pk_fma_f32 v[182:183], v[150:151], v[204:205], v[206:207] op_sel_hi:[1,0,0]
    v_pk_fma_f32 v[184:185], v[152:153], v[204:205], v[206:207] op_sel_hi:[1,0,0]
    v_pk_fma_f32 v[186:187], v[154:155], v[204:205], v[206:207] op_sel_hi:[1,0,0]
    v_pk_fma_f32 v[188:189], v[156:157], v[204:205], v[206:207] op_sel_hi:[1,0,0]
    v_pk_fma_f32 v[190:191], v[158:159], v[204:205], v[206:207] op_sel_hi:[1,0,0]
    v_pk_fma_f32 v[144:145], v[176:177], v[160:161], v[144:145]
    v_pk_fma_f32 v[146:147], v[178:179], v[162:163], v[146:147]
    v_pk_fma_f32 v[148:149], v[180:181], v[164:165], v[148:149]
    v_pk_fma_f32 v[150:151], v[182:183], v[166:167], v[150:151]
    v_pk_fma_f32 v[152:153], v[184:185], v[168:169], v[152:153]
    v_pk_fma_f32 v[154:155], v[186:187], v[170:171], v[154:155]
    v_pk_fma_f32 v[156:157], v[188:189], v[172:173], v[156:157]
    v_pk_fma_f32 v[158:159], v[190:191], v[174:175], v[158:159]
    v_pk_add_f32 v[192:193], v[144:145], v[146:147]
    v_pk_mul_f32 v[194:195], v[144:145], v[144:145]
    v_pk_fma_f32 v[194:195], v[146:147], v[146:147], v[194:195]
    v_pk_fma_f32 v[194:195], v[148:149], v[148:149], v[194:195]
    v_pk_add_f32 v[192:193], v[192:193], v[148:149]
    v_pk_fma_f32 v[194:195], v[150:151], v[150:151], v[194:195]
    v_pk_add_f32 v[192:193], v[192:193], v[150:151]
    v_pk_fma_f32 v[194:195], v[152:153], v[152:153], v[194:195]
    v_pk_add_f32 v[192:193], v[192:193], v[152:153]
    v_pk_fma_f32 v[194:195], v[154:155], v[154:155], v[194:195]
    v_pk_add_f32 v[192:193], v[192:193], v[154:155]
    v_pk_fma_f32 v[194:195], v[156:157], v[156:157], v[194:195]
    v_pk_add_f32 v[192:193], v[192:193], v[156:157]
    v_pk_fma_f32 v[194:195], v[158:159], v[158:159], v[194:195]
    v_pk_add_f32 v[192:193], v[192:193], v[158:159]
    v_add_f32 v192, v192, v193
    v_add_f32 v194, v194, v195
    s_nop 1
    v_permlane16_swap_b32 v192, v194
    v_add_f32 v192, v192, v194
    s_nop 1
    v_add_f32_dpp v192, v192, v192 row_ror:8 row_mask:0xf bank_mask:0xf
    v_mov_b32 v193, v192
    s_nop 1
    v_permlane32_swap_b32 v192, v193
    v_add_f32 v192, v192, v193
    s_mov_b64 exec, 0x00ff00ff
    ds_write_b32 v11, v192 offset:256
    s_mov_b64 exec, -1
    s_waitcnt lgkmcnt(0)
    s_barrier
    ds_read_b128 v[196:199], v12 offset:256
    ds_read_b128 v[200:203], v12 offset:272
    s_waitcnt lgkmcnt(0)
    v_pk_add_f32 v[196:197], v[196:197], v[198:199]
    v_pk_add_f32 v[200:201], v[200:201], v[202:203]
    v_pk_add_f32 v[196:197], v[196:197], v[200:201]
    v_mul_f32 v196, 0x3b000000, v196
    v_mul_f32 v197, 0x3b000000, v197
    v_fma_f32 v197, -v196, v196, v197
    v_max_f32 v197, 0, v197
    v_add_f32 v197, 0x3727c5ac, v197
    v_rsq_f32 v204, v197
    s_nop 0
    v_mul_f32 v204, 0x3fb8aa3b, v204
    v_mul_f32_e64 v206, -v196, v204
    v_pk_fma_f32 v[176:177], v[144:145], v[204:205], v[206:207] op_sel_hi:[1,0,0]
    v_pk_fma_f32 v[178:179], v[146:147], v[204:205], v[206:207] op_sel_hi:[1,0,0]
    v_pk_fma_f32 v[180:181], v[148:149], v[204:205], v[206:207] op_sel_hi:[1,0,0]
    v_pk_fma_f32 v[182:183], v[150:151], v[204:205], v[206:207] op_sel_hi:[1,0,0]
    v_pk_fma_f32 v[184:185], v[152:153], v[204:205], v[206:207] op_sel_hi:[1,0,0]
    v_pk_fma_f32 v[186:187], v[154:155], v[204:205], v[206:207] op_sel_hi:[1,0,0]
    v_pk_fma_f32 v[188:189], v[156:157], v[204:205], v[206:207] op_sel_hi:[1,0,0]
    v_pk_fma_f32 v[190:191], v[158:159], v[204:205], v[206:207] op_sel_hi:[1,0,0]
    v_cvt_pk_bf16_f32 v216, v176, v177
    v_cvt_pk_bf16_f32 v217, v178, v179
    v_cvt_pk_bf16_f32 v218, v180, v181
    v_cvt_pk_bf16_f32 v219, v182, v183
    v_cvt_pk_bf16_f32 v220, v184, v185
    v_cvt_pk_bf16_f32 v221, v186, v187
    v_cvt_pk_bf16_f32 v222, v188, v189
    v_cvt_pk_bf16_f32 v223, v190, v191
    s_add_u32 s46, s34, 1048576
    s_add_u32 s47, s34, 1052672
    buffer_store_dwordx4 v[216:219], v7, s[4:7], s46 offen
    buffer_store_dwordx4 v[220:223], v7, s[4:7], s47 offen
    v_cvt_pk_bf16_f32 v208, v144, v145
    v_cvt_pk_bf16_f32 v209, v146, v147
    v_cvt_pk_bf16_f32 v210, v148, v149
    v_cvt_pk_bf16_f32 v211, v150, v151
    v_cvt_pk_bf16_f32 v212, v152, v153
    v_cvt_pk_bf16_f32 v213, v154, v155
    v_cvt_pk_bf16_f32 v214, v156, v157
    v_cvt_pk_bf16_f32 v215, v158, v159
    v_accvgpr_write_b32 a224, v208
    v_accvgpr_write_b32 a225, v209
    v_accvgpr_write_b32 a226, v210
    v_accvgpr_write_b32 a227, v211
    v_accvgpr_write_b32 a228, v212
    v_accvgpr_write_b32 a229, v213
    v_accvgpr_write_b32 a230, v214
    v_accvgpr_write_b32 a231, v215
    s_waitcnt vmcnt(0)
    buffer_store_dword v18, v6, s[4:7], s40 offen
    s_barrier
    buffer_load_dword v17, v5, s[4:7], s41 offen sc1
    s_waitcnt vmcnt(0)
    v_cmp_ne_u32 vcc, s51, v17
    s_cbranch_vccnz L_polls_48
L_pollb_49:
    s_add_u32 s3, s35, 1048576
    buffer_load_dwordx4 v[128:131], v1, s[4:7], s3 offen sc1
    buffer_load_dwordx4 v[132:135], v1, s[4:7], s3 offen offset:1024 sc1
    buffer_load_dwordx4 v[136:139], v1, s[4:7], s3 offen offset:2048 sc1
    buffer_load_dwordx4 v[140:143], v1, s[4:7], s3 offen offset:3072 sc1
    s_add_u32 s3, s35, 1052672
    buffer_load_dwordx4 v[144:147], v1, s[4:7], s3 offen sc1
    s_waitcnt vmcnt(4)
    ds_read_b128 v[32:35], v2 offset:0
    ds_read_b128 v[36:39], v2 offset:32768
    ds_read_b128 v[40:43], v3 offset:0
    ds_read_b128 v[44:47], v2 offset:1024
    ds_read_b128 v[48:51], v2 offset:33792
    ds_read_b128 v[52:55], v3 offset:1024
    s_waitcnt lgkmcnt(4)
    v_mfma_f32_32x32x16_bf16 v[64:79], v[32:35], v[128:131], 0
    ds_read_b128 v[56:59], v2 offset:2048
    buffer_load_dwordx4 v[148:151], v1, s[4:7], s3 offen offset:1024 sc1
    v_mfma_f32_32x32x16_bf16 v[80:95], v[36:39], v[128:131], 0
    ds_read_b128 v[60:63], v2 offset:34816
    s_waitcnt lgkmcnt(4)
    v_mfma_f32_32x32x16_bf16 v[96:111], v[40:43], v[128:131], 0
    ds_read_b128 v[32:35], v3 offset:2048
    buffer_load_dwordx4 v[152:155], v1, s[4:7], s3 offen offset:2048 sc1
    s_waitcnt vmcnt(5)
    v_mfma_f32_32x32x16_bf16 v[64:79], v[44:47], v[132:135], v[64:79]
    ds_read_b128 v[36:39], v2 offset:3072
    s_waitcnt lgkmcnt(4)
    v_mfma_f32_32x32x16_bf16 v[80:95], v[48:51], v[132:135], v[80:95]
    ds_read_b128 v[40:43], v2 offset:35840
    buffer_load_dwordx4 v[156:159], v1, s[4:7], s3 offen offset:3072 sc1
    v_mfma_f32_32x32x16_bf16 v[96:111], v[52:55], v[132:135], v[96:111]
    ds_read_b128 v[44:47], v3 offset:3072
    s_waitcnt vmcnt(5)
    s_waitcnt lgkmcnt(4)
    v_mfma_f32_32x32x16_bf16 v[64:79], v[56:59], v[136:139], v[64:79]
    ds_read_b128 v[48:51], v2 offset:4096
    s_add_u32 s3, s35, 1056768
    v_mfma_f32_32x32x16_bf16 v[80:95], v[60:63], v[136:139], v[80:95]
    ds_read_b128 v[52:55], v2 offset:36864
    buffer_load_dwordx4 v[160:163], v1, s[4:7], s3 offen sc1
    s_waitcnt lgkmcnt(4)
    v_mfma_f32_32x32x16_bf16 v[96:111], v[32:35], v[136:139], v[96:111]
    ds_read_b128 v[56:59], v3 offset:4096
    s_waitcnt vmcnt(5)
    v_mfma_f32_32x32x16_bf16 v[64:79], v[36:39], v[140:143], v[64:79]
    ds_read_b128 v[60:63], v2 offset:5120
    buffer_load_dwordx4 v[164:167], v1, s[4:7], s3 offen offset:1024 sc1
    s_waitcnt lgkmcnt(4)
    v_mfma_f32_32x32x16_bf16 v[80:95], v[40:43], v[140:143], v[80:95]
    ds_read_b128 v[32:35], v2 offset:37888
    v_mfma_f32_32x32x16_bf16 v[96:111], v[44:47], v[140:143], v[96:111]
    ds_read_b128 v[36:39], v3 offset:5120
    buffer_load_dwordx4 v[168:171], v1, s[4:7], s3 offen offset:2048 sc1
    s_waitcnt vmcnt(6)
    s_waitcnt lgkmcnt(4)
    v_mfma_f32_32x32x16_bf16 v[64:79], v[48:51], v[144:147], v[64:79]
    ds_read_b128 v[40:43], v2 offset:6144
    v_mfma_f32_32x32x16_bf16 v[80:95], v[52:55], v[144:147], v[80:95]
    ds_read_b128 v[44:47], v2 offset:38912
    buffer_load_dwordx4 v[172:175], v1, s[4:7], s3 offen offset:3072 sc1
    s_waitcnt lgkmcnt(4)
    v_mfma_f32_32x32x16_bf16 v[96:111], v[56:59], v[144:147], v[96:111]
    ds_read_b128 v[48:51], v3 offset:6144
    s_add_u32 s3, s35, 1060864
    s_waitcnt vmcnt(6)
    v_mfma_f32_32x32x16_bf16 v[64:79], v[60:63], v[148:151], v[64:79]
    ds_read_b128 v[52:55], v2 offset:7168
    buffer_load_dwordx4 v[176:179], v1, s[4:7], s3 offen sc1
    s_waitcnt lgkmcnt(4)
    v_mfma_f32_32x32x16_bf16 v[80:95], v[32:35], v[148:151], v[80:95]
    ds_read_b128 v[56:59], v2 offset:39936
    v_mfma_f32_32x32x16_bf16 v[96:111], v[36:39], v[148:151], v[96:111]
    ds_read_b128 v[60:63], v3 offset:7168
    buffer_load_dwordx4 v[180:183], v1, s[4:7], s3 offen offset:1024 sc1
    s_waitcnt vmcnt(7)
    s_waitcnt lgkmcnt(4)
    v_mfma_f32_32x32x16_bf16 v[64:79], v[40:43], v[152:155], v[64:79]
    ds_read_b128 v[32:35], v2 offset:8192
    v_mfma_f32_32x32x16_bf16 v[80:95], v[44:47], v[152:155], v[80:95]
    ds_read_b128 v[36:39], v2 offset:40960
    buffer_load_dwordx4 v[184:187], v1, s[4:7], s3 offen offset:2048 sc1
    s_waitcnt lgkmcnt(4)
    v_mfma_f32_32x32x16_bf16 v[96:111], v[48:51], v[152:155], v[96:111]
    ds_read_b128 v[40:43], v3 offset:8192
    s_waitcnt vmcnt(7)
    v_mfma_f32_32x32x16_bf16 v[64:79], v[52:55], v[156:159], v[64:79]
    ds_read_b128 v[44:47], v2 offset:9216
    buffer_load_dwordx4 v[188:191], v1, s[4:7], s3 offen offset:3072 sc1
    s_waitcnt lgkmcnt(4)
    v_mfma_f32_32x32x16_bf16 v[80:95], v[56:59], v[156:159], v[80:95]
    ds_read_b128 v[48:51], v2 offset:41984
    s_add_u32 s3, s35, 1064960
    v_mfma_f32_32x32x16_bf16 v[96:111], v[60:63], v[156:159], v[96:111]
    ds_read_b128 v[52:55], v3 offset:9216
    buffer_load_dwordx4 v[192:195], v1, s[4:7], s3 offen sc1
    s_waitcnt vmcnt(8)
    s_waitcnt lgkmcnt(4)
    v_mfma_f32_32x32x16_bf16 v[64:79], v[32:35], v[160:163], v[64:79]
    ds_read_b128 v[56:59], v2 offset:10240
    v_mfma_f32_32x32x16_bf16 v[80:95], v[36:39], v[160:163], v[80:95]
    ds_read_b128 v[60:63], v2 offset:43008
    buffer_load_dwordx4 v[196:199], v1, s[4:7], s3 offen offset:1024 sc1
    s_waitcnt lgkmcnt(4)
    v_mfma_f32_32x32x16_bf16 v[96:111], v[40:43], v[160:163], v[96:111]
    ds_read_b128 v[32:35], v3 offset:10240
    s_waitcnt vmcnt(8)
    v_mfma_f32_32x32x16_bf16 v[64:79], v[44:47], v[164:167], v[64:79]
    ds_read_b128 v[36:39], v2 offset:11264
    buffer_load_dwordx4 v[200:203], v1, s[4:7], s3 offen offset:2048 sc1
    s_waitcnt lgkmcnt(4)
    v_mfma_f32_32x32x16_bf16 v[80:95], v[48:51], v[164:167], v[80:95]
    ds_read_b128 v[40:43], v2 offset:44032
    v_mfma_f32_32x32x16_bf16 v[96:111], v[52:55], v[164:167], v[96:111]
    ds_read_b128 v[44:47], v3 offset:11264
    buffer_load_dwordx4 v[204:207], v1, s[4:7], s3 offen offset:3072 sc1
    s_waitcnt vmcnt(9)
    s_waitcnt lgkmcnt(4)
    v_mfma_f32_32x32x16_bf16 v[64:79], v[56:59], v[168:171], v[64:79]
    ds_read_b128 v[48:51], v2 offset:12288
    s_add_u32 s3, s35, 1069056
    v_mfma_f32_32x32x16_bf16 v[80:95], v[60:63], v[168:171], v[80:95]
    ds_read_b128 v[52:55], v2 offset:45056
    buffer_load_dwordx4 v[208:211], v1, s[4:7], s3 offen sc1
    s_waitcnt lgkmcnt(4)
    v_mfma_f32_32x32x16_bf16 v[96:111], v[32:35], v[168:171], v[96:111]
    ds_read_b128 v[56:59], v3 offset:12288
    s_waitcnt vmcnt(9)
    v_mfma_f32_32x32x16_bf16 v[64:79], v[36:39], v[172:175], v[64:79]
    ds_read_b128 v[60:63], v2 offset:13312
    buffer_load_dwordx4 v[212:215], v1, s[4:7], s3 offen offset:1024 sc1
    s_waitcnt lgkmcnt(4)
    v_mfma_f32_32x32x16_bf16 v[80:95], v[40:43], v[172:175], v[80:95]
    ds_read_b128 v[32:35], v2 offset:46080
    v_mfma_f32_32x32x16_bf16 v[96:111], v[44:47], v[172:175], v[96:111]
    ds_read_b128 v[36:39], v3 offset:13312
    buffer_load_dwordx4 v[216:219], v1, s[4:7], s3 offen offset:2048 sc1
    s_waitcnt vmcnt(10)
    s_waitcnt lgkmcnt(4)
    v_mfma_f32_32x32x16_bf16 v[64:79], v[48:51], v[176:179], v[64:79]
    ds_read_b128 v[40:43], v2 offset:14336
    v_mfma_f32_32x32x16_bf16 v[80:95], v[52:55], v[176:179], v[80:95]
    ds_read_b128 v[44:47], v2 offset:47104
    buffer_load_dwordx4 v[220:223], v1, s[4:7], s3 offen offset:3072 sc1
    s_waitcnt lgkmcnt(4)
    v_mfma_f32_32x32x16_bf16 v[96:111], v[56:59], v[176:179], v[96:111]
    ds_read_b128 v[48:51], v3 offset:14336
    s_add_u32 s3, s35, 1073152
    s_waitcnt vmcnt(10)
    v_mfma_f32_32x32x16_bf16 v[64:79], v[60:63], v[180:183], v[64:79]
    ds_read_b128 v[52:55], v2 offset:15360
    buffer_load_dwordx4 v[224:227], v1, s[4:7], s3 offen sc1
    s_waitcnt lgkmcnt(4)
    v_mfma_f32_32x32x16_bf16 v[80:95], v[32:35], v[180:183], v[80:95]
    ds_read_b128 v[56:59], v2 offset:48128
    v_mfma_f32_32x32x16_bf16 v[96:111], v[36:39], v[180:183], v[96:111]
    ds_read_b128 v[60:63], v3 offset:15360
    buffer_load_dwordx4 v[228:231], v1, s[4:7], s3 offen offset:1024 sc1
    s_waitcnt vmcnt(11)
    s_waitcnt lgkmcnt(4)
    v_mfma_f32_32x32x16_bf16 v[64:79], v[40:43], v[184:187], v[64:79]
    ds_read_b128 v[32:35], v2 offset:16384
    v_mfma_f32_32x32x16_bf16 v[80:95], v[44:47], v[184:187], v[80:95]
    ds_read_b128 v[36:39], v2 offset:49152
    buffer_load_dwordx4 v[232:235], v1, s[4:7], s3 offen offset:2048 sc1
    s_waitcnt lgkmcnt(4)
    v_mfma_f32_32x32x16_bf16 v[96:111], v[48:51], v[184:187], v[96:111]
    ds_read_b128 v[40:43], v3 offset:16384
    s_waitcnt vmcnt(11)
    v_mfma_f32_32x32x16_bf16 v[64:79], v[52:55], v[188:191], v[64:79]
    ds_read_b128 v[44:47], v2 offset:17408
    buffer_load_dwordx4 v[236:239], v1, s[4:7], s3 offen offset:3072 sc1
    s_waitcnt lgkmcnt(4)
    v_mfma_f32_32x32x16_bf16 v[80:95], v[56:59], v[188:191], v[80:95]
    ds_read_b128 v[48:51], v2 offset:50176
    s_add_u32 s3, s35, 1077248
    v_mfma_f32_32x32x16_bf16 v[96:111], v[60:63], v[188:191], v[96:111]
    ds_read_b128 v[52:55], v3 offset:17408
    buffer_load_dwordx4 v[240:243], v1, s[4:7], s3 offen sc1
    s_waitcnt vmcnt(12)
    s_waitcnt lgkmcnt(4)
    v_mfma_f32_32x32x16_bf16 v[64:79], v[32:35], v[192:195], v[64:79]
    ds_read_b128 v[56:59], v2 offset:18432
    v_mfma_f32_32x32x16_bf16 v[80:95], v[36:39], v[192:195], v[80:95]
    ds_read_b128 v[60:63], v2 offset:51200
    buffer_load_dwordx4 v[244:247], v1, s[4:7], s3 offen offset:1024 sc1
    s_waitcnt lgkmcnt(4)
    v_mfma_f32_32x32x16_bf16 v[96:111], v[40:43], v[192:195], v[96:111]
    ds_read_b128 v[32:35], v3 offset:18432
    s_waitcnt vmcnt(12)
    v_mfma_f32_32x32x16_bf16 v[64:79], v[44:47], v[196:199], v[64:79]
    ds_read_b128 v[36:39], v2 offset:19456
    buffer_load_dwordx4 v[248:251], v1, s[4:7], s3 offen offset:2048 sc1
    s_waitcnt lgkmcnt(4)
    v_mfma_f32_32x32x16_bf16 v[80:95], v[48:51], v[196:199], v[80:95]
    ds_read_b128 v[40:43], v2 offset:52224
    v_mfma_f32_32x32x16_bf16 v[96:111], v[52:55], v[196:199], v[96:111]
    ds_read_b128 v[44:47], v3 offset:19456
    buffer_load_dwordx4 v[252:255], v1, s[4:7], s3 offen offset:3072 sc1
    s_waitcnt vmcnt(13)
    s_waitcnt lgkmcnt(4)
    v_mfma_f32_32x32x16_bf16 v[64:79], v[56:59], v[200:203], v[64:79]
    ds_read_b128 v[48:51], v2 offset:20480
    s_add_u32 s3, s34, s64
    v_mfma_f32_32x32x16_bf16 v[80:95], v[60:63], v[200:203], v[80:95]
    ds_read_b128 v[52:55], v2 offset:53248
    buffer_store_dwordx4 a[224:227], v7, s[4:7], s3 offen sc1
    s_add_u32 s3, s3, 4096
    s_waitcnt lgkmcnt(4)
    v_mfma_f32_32x32x16_bf16 v[96:111], v[32:35], v[200:203], v[96:111]
    ds_read_b128 v[56:59], v3 offset:20480
    s_waitcnt vmcnt(13)
    v_mfma_f32_32x32x16_bf16 v[64:79], v[36:39], v[204:207], v[64:79]
    ds_read_b128 v[60:63], v2 offset:21504
    buffer_store_dwordx4 a[228:231], v7, s[4:7], s3 offen sc1
    s_waitcnt lgkmcnt(4)
    v_mfma_f32_32x32x16_bf16 v[80:95], v[40:43], v[204:207], v[80:95]
    ds_read_b128 v[32:35], v2 offset:54272
    s_add_u32 m0, s23, 32768
    s_add_u32 s50, s39, 131072
    v_mfma_f32_32x32x16_bf16 v[96:111], v[44:47], v[204:207], v[96:111]
    ds_read_b128 v[36:39], v3 offset:21504
    buffer_load_dwordx4 v1, s[4:7], s50 offen lds
    s_waitcnt vmcnt(14)
    s_waitcnt lgkmcnt(4)
    v_mfma_f32_32x32x16_bf16 v[64:79], v[48:51], v[208:211], v[64:79]
    ds_read_b128 v[40:43], v2 offset:22528
    v_mfma_f32_32x32x16_bf16 v[80:95], v[52:55], v[208:211], v[80:95]
    ds_read_b128 v[44:47], v2 offset:55296
    buffer_load_dwordx4 v1, s[4:7], s50 offen offset:1024 lds
    s_waitcnt lgkmcnt(4)
    v_mfma_f32_32x32x16_bf16 v[96:111], v[56:59], v[208:211], v[96:111]
    ds_read_b128 v[48:51], v3 offset:22528
    s_waitcnt vmcnt(14)
    v_mfma_f32_32x32x16_bf16 v[64:79], v[60:63], v[212:215], v[64:79]
    ds_read_b128 v[52:55], v2 offset:23552
    buffer_load_dwordx4 v1, s[4:7], s50 offen offset:2048 lds
    s_waitcnt lgkmcnt(4)
    v_mfma_f32_32x32x16_bf16 v[80:95], v[32:35], v[212:215], v[80:95]
    ds_read_b128 v[56:59], v2 offset:56320
    v_mfma_f32_32x32x16_bf16 v[96:111], v[36:39], v[212:215], v[96:111]
    ds_read_b128 v[60:63], v3 offset:23552
    buffer_load_dwordx4 v1, s[4:7], s50 offen offset:3072 lds
    s_add_u32 m0, s23, 36864
    s_add_u32 s50, s39, 135168
    s_waitcnt vmcnt(15)
    s_waitcnt lgkmcnt(4)
    v_mfma_f32_32x32x16_bf16 v[64:79], v[40:43], v[216:219], v[64:79]
    ds_read_b128 v[32:35], v2 offset:24576
    v_mfma_f32_32x32x16_bf16 v[80:95], v[44:47], v[216:219], v[80:95]
    ds_read_b128 v[36:39], v2 offset:57344
    buffer_load_dwordx4 v1, s[4:7], s50 offen lds
    s_waitcnt lgkmcnt(4)
    v_mfma_f32_32x32x16_bf16 v[96:111], v[48:51], v[216:219], v[96:111]
    ds_read_b128 v[40:43], v3 offset:24576
    s_waitcnt vmcnt(15)
    v_mfma_f32_32x32x16_bf16 v[64:79], v[52:55], v[220:223], v[64:79]
    ds_read_b128 v[44:47], v2 offset:25600
    buffer_load_dwordx4 v1, s[4:7], s50 offen offset:1024 lds
    s_waitcnt lgkmcnt(4)
    v_mfma_f32_32x32x16_bf16 v[80:95], v[56:59], v[220:223], v[80:95]
    ds_read_b128 v[48:51], v2 offset:58368
    v_mfma_f32_32x32x16_bf16 v[96:111], v[60:63], v[220:223], v[96:111]
    ds_read_b128 v[52:55], v3 offset:25600
    buffer_load_dwordx4 v1, s[4:7], s50 offen offset:2048 lds
    s_waitcnt vmcnt(16)
    s_waitcnt lgkmcnt(4)
    v_mfma_f32_32x32x16_bf16 v[64:79], v[32:35], v[224:227], v[64:79]
    ds_read_b128 v[56:59], v2 offset:26624
    v_mfma_f32_32x32x16_bf16 v[80:95], v[36:39], v[224:227], v[80:95]
    ds_read_b128 v[60:63], v2 offset:59392
    buffer_load_dwordx4 v1, s[4:7], s50 offen offset:3072 lds
    s_waitcnt lgkmcnt(4)
    v_mfma_f32_32x32x16_bf16 v[96:111], v[40:43], v[224:227], v[96:111]
    ds_read_b128 v[32:35], v3 offset:26624
    s_waitcnt vmcnt(16)
    v_mfma_f32_32x32x16_bf16 v[64:79], v[44:47], v[228:231], v[64:79]
    ds_read_b128 v[36:39], v2 offset:27648
    s_waitcnt lgkmcnt(4)
    v_mfma_f32_32x32x16_bf16 v[80:95], v[48:51], v[228:231], v[80:95]
    ds_read_b128 v[40:43], v2 offset:60416
    v_mfma_f32_32x32x16_bf16 v[96:111], v[52:55], v[228:231], v[96:111]
    ds_read_b128 v[44:47], v3 offset:27648
    s_waitcnt vmcnt(15)
    s_waitcnt lgkmcnt(4)
    v_mfma_f32_32x32x16_bf16 v[64:79], v[56:59], v[232:235], v[64:79]
    ds_read_b128 v[48:51], v2 offset:28672
    v_mfma_f32_32x32x16_bf16 v[80:95], v[60:63], v[232:235], v[80:95]
    ds_read_b128 v[52:55], v2 offset:61440
    s_waitcnt lgkmcnt(4)
    v_mfma_f32_32x32x16_bf16 v[96:111], v[32:35], v[232:235], v[96:111]
    ds_read_b128 v[56:59], v3 offset:28672
    s_waitcnt vmcnt(14)
    v_mfma_f32_32x32x16_bf16 v[64:79], v[36:39], v[236:239], v[64:79]
    ds_read_b128 v[60:63], v2 offset:29696
    s_waitcnt lgkmcnt(4)
    v_mfma_f32_32x32x16_bf16 v[80:95], v[40:43], v[236:239], v[80:95]
    ds_read_b128 v[32:35], v2 offset:62464
    v_mfma_f32_32x32x16_bf16 v[96:111], v[44:47], v[236:239], v[96:111]
    ds_read_b128 v[36:39], v3 offset:29696
    s_waitcnt vmcnt(13)
    s_waitcnt lgkmcnt(4)
    v_mfma_f32_32x32x16_bf16 v[64:79], v[48:51], v[240:243], v[64:79]
    ds_read_b128 v[40:43], v2 offset:30720
    v_mfma_f32_32x32x16_bf16 v[80:95], v[52:55], v[240:243], v[80:95]
    ds_read_b128 v[44:47], v2 offset:63488
    s_waitcnt lgkmcnt(4)
    v_mfma_f32_32x32x16_bf16 v[96:111], v[56:59], v[240:243], v[96:111]
    ds_read_b128 v[48:51], v3 offset:30720
    s_waitcnt vmcnt(12)
    v_mfma_f32_32x32x16_bf16 v[64:79], v[60:63], v[244:247], v[64:79]
    ds_read_b128 v[52:55], v2 offset:31744
    s_waitcnt lgkmcnt(4)
    v_mfma_f32_32x32x16_bf16 v[80:95], v[32:35], v[244:247], v[80:95]
    ds_read_b128 v[56:59], v2 offset:64512
    v_mfma_f32_32x32x16_bf16 v[96:111], v[36:39], v[244:247], v[96:111]
    ds_read_b128 v[60:63], v3 offset:31744
    s_waitcnt vmcnt(11)
    s_waitcnt lgkmcnt(4)
    v_mfma_f32_32x32x16_bf16 v[64:79], v[40:43], v[248:251], v[64:79]
    ds_read_b128 v[32:35], v1 offset:0
    v_mfma_f32_32x32x16_bf16 v[80:95], v[44:47], v[248:251], v[80:95]
    ds_read_b128 v[36:39], v1 offset:1024
    s_waitcnt lgkmcnt(4)
    v_mfma_f32_32x32x16_bf16 v[96:111], v[48:51], v[248:251], v[96:111]
    ds_read_b128 v[40:43], v1 offset:2048
    s_waitcnt vmcnt(10)
    v_mfma_f32_32x32x16_bf16 v[64:79], v[52:55], v[252:255], v[64:79]
    ds_read_b128 v[44:47], v1 offset:3072
    s_waitcnt lgkmcnt(4)
    v_mfma_f32_32x32x16_bf16 v[80:95], v[56:59], v[252:255], v[80:95]
    ds_read_b128 v[48:51], v1 offset:4096
    v_mfma_f32_32x32x16_bf16 v[96:111], v[60:63], v[252:255], v[96:111]
    ds_read_b128 v[52:55], v1 offset:5120
    s_waitcnt lgkmcnt(4)
    v_mfma_f32_32x32x16_bf16 v[112:127], v[32:35], v[128:131], 0
    ds_read_b128 v[56:59], v1 offset:6144
    s_barrier
    v_mfma_f32_32x32x16_bf16 v[112:127], v[36:39], v[132:135], v[112:127]
    ds_read_b128 v[60:63], v1 offset:7168
    s_add_u32 m0, s23, 65536
    s_mov_b32 s50, s39
    s_waitcnt lgkmcnt(4)
    v_mfma_f32_32x32x16_bf16 v[112:127], v[40:43], v[136:139], v[112:127]
    ds_read_b128 v[32:35], v1 offset:8192
    buffer_load_dwordx4 v1, s[4:7], s50 offen lds
    v_mfma_f32_32x32x16_bf16 v[112:127], v[44:47], v[140:143], v[112:127]
    ds_read_b128 v[36:39], v1 offset:9216
    v_exp_f32_e64 v64, -v64
    s_waitcnt lgkmcnt(4)
    v_mfma_f32_32x32x16_bf16 v[112:127], v[48:51], v[144:147], v[112:127]
    ds_read_b128 v[40:43], v1 offset:10240
    buffer_load_dwordx4 v1, s[4:7], s50 offen offset:1024 lds
    v_add_f32 v64, 1.0, v64
    v_exp_f32_e64 v65, -v65
    v_mfma_f32_32x32x16_bf16 v[112:127], v[52:55], v[148:151], v[112:127]
    ds_read_b128 v[44:47], v1 offset:11264
    v_add_f32 v65, 1.0, v65
    v_exp_f32_e64 v66, -v66
    s_waitcnt lgkmcnt(4)
    v_mfma_f32_32x32x16_bf16 v[112:127], v[56:59], v[152:155], v[112:127]
    ds_read_b128 v[48:51], v1 offset:12288
    buffer_load_dwordx4 v1, s[4:7], s50 offen offset:2048 lds
    v_add_f32 v66, 1.0, v66
    v_exp_f32_e64 v67, -v67
    v_mfma_f32_32x32x16_bf16 v[112:127], v[60:63], v[156:159], v[112:127]
    ds_read_b128 v[52:55], v1 offset:13312
    v_add_f32 v67, 1.0, v67
    v_exp_f32_e64 v68, -v68
    s_waitcnt lgkmcnt(4)
    v_mfma_f32_32x32x16_bf16 v[112:127], v[32:35], v[160:163], v[112:127]
    ds_read_b128 v[56:59], v1 offset:14336
    buffer_load_dwordx4 v1, s[4:7], s50 offen offset:3072 lds
    v_add_f32 v68, 1.0, v68
    v_exp_f32_e64 v69, -v69
    v_mfma_f32_32x32x16_bf16 v[112:127], v[36:39], v[164:167], v[112:127]
    ds_read_b128 v[60:63], v1 offset:15360
    s_add_u32 m0, s23, 69632
    s_add_u32 s50, s39, 4096
    v_add_f32 v69, 1.0, v69
    v_exp_f32_e64 v70, -v70
    s_waitcnt lgkmcnt(4)
    v_mfma_f32_32x32x16_bf16 v[112:127], v[40:43], v[168:171], v[112:127]
    ds_read_b128 v[32:35], v1 offset:16384
    buffer_load_dwordx4 v1, s[4:7], s50 offen lds
    v_add_f32 v70, 1.0, v70
    v_exp_f32_e64 v71, -v71
    v_mfma_f32_32x32x16_bf16 v[112:127], v[44:47], v[172:175], v[112:127]
    ds_read_b128 v[36:39], v1 offset:17408
    v_rcp_f32 v64, v64
    v_add_f32 v71, 1.0, v71
    s_waitcnt lgkmcnt(4)
    v_mfma_f32_32x32x16_bf16 v[112:127], v[48:51], v[176:179], v[112:127]
    ds_read_b128 v[40:43], v1 offset:18432
    buffer_load_dwordx4 v1, s[4:7], s50 offen offset:1024 lds
    v_mul_f32 v64, v64, v72
    v_rcp_f32 v65, v65
    v_mfma_f32_32x32x16_bf16 v[112:127], v[52:55], v[180:183], v[112:127]
    ds_read_b128 v[44:47], v1 offset:19456
    s_add_u32 s94, s36, 13651968
    v_mul_f32 v65, v65, v73
    v_rcp_f32 v66, v66
    s_waitcnt lgkmcnt(4)
    v_mfma_f32_32x32x16_bf16 v[112:127], v[56:59], v[184:187], v[112:127]
    ds_read_b128 v[48:51], v1 offset:20480
    v_mul_f32 v66, v66, v74
    v_rcp_f32 v67, v67
    v_cvt_pk_bf16_f32 v72, v64, v65
    v_mfma_f32_32x32x16_bf16 v[112:127], v[60:63], v[188:191], v[112:127]
    ds_read_b128 v[52:55], v1 offset:21504
    buffer_load_dwordx4 v1, s[4:7], s50 offen offset:2048 lds
    v_mul_f32 v67, v67, v75
    v_rcp_f32 v68, v68
    s_waitcnt lgkmcnt(4)
    v_mfma_f32_32x32x16_bf16 v[112:127], v[32:35], v[192:195], v[112:127]
    ds_read_b128 v[56:59], v1 offset:22528
    v_mul_f32 v68, v68, v76
    v_rcp_f32 v69, v69
    v_cvt_pk_bf16_f32 v73, v66, v67
    v_mfma_f32_32x32x16_bf16 v[112:127], v[36:39], v[196:199], v[112:127]
    ds_read_b128 v[60:63], v1 offset:23552
    buffer_load_dwordx4 v1, s[4:7], s50 offen offset:3072 lds
    v_mul_f32 v69, v69, v77
    v_rcp_f32 v70, v70
    s_waitcnt lgkmcnt(4)
    v_mfma_f32_32x32x16_bf16 v[112:127], v[40:43], v[200:203], v[112:127]
    ds_read_b128 v[32:35], v1 offset:24576
    v_mul_f32 v70, v70, v78
    v_rcp_f32 v71, v71
    v_cvt_pk_bf16_f32 v74, v68, v69
    v_mfma_f32_32x32x16_bf16 v[112:127], v[44:47], v[204:207], v[112:127]
    ds_read_b128 v[36:39], v1 offset:25600
    s_add_u32 m0, s23, 98304
    s_add_u32 s50, s39, 32768
    v_mul_f32 v71, v71, v79
    v_exp_f32_e64 v80, -v80
    s_waitcnt lgkmcnt(4)
    v_mfma_f32_32x32x16_bf16 v[112:127], v[48:51], v[208:211], v[112:127]
    ds_read_b128 v[40:43], v1 offset:26624
    v_add_f32 v80, 1.0, v80
    v_exp_f32_e64 v81, -v81
    v_cvt_pk_bf16_f32 v75, v70, v71
    v_mfma_f32_32x32x16_bf16 v[112:127], v[52:55], v[212:215], v[112:127]
    ds_read_b128 v[44:47], v1 offset:27648
    buffer_store_dwordx4 v[72:75], v1, s[4:7], s94 offen nt sc0
    v_add_f32 v81, 1.0, v81
    v_exp_f32_e64 v82, -v82
    s_waitcnt lgkmcnt(4)
    v_mfma_f32_32x32x16_bf16 v[112:127], v[56:59], v[216:219], v[112:127]
    ds_read_b128 v[48:51], v1 offset:28672
    v_add_f32 v82, 1.0, v82
    v_exp_f32_e64 v83, -v83
    v_mfma_f32_32x32x16_bf16 v[112:127], v[60:63], v[220:223], v[112:127]
    ds_read_b128 v[52:55], v1 offset:29696
    buffer_load_dwordx4 v1, s[4:7], s50 offen lds
    v_add_f32 v83, 1.0, v83
    v_exp_f32_e64 v84, -v84
    s_waitcnt lgkmcnt(4)
    v_mfma_f32_32x32x16_bf16 v[112:127], v[32:35], v[224:227], v[112:127]
    ds_read_b128 v[56:59], v1 offset:30720
    v_add_f32 v84, 1.0, v84
    v_exp_f32_e64 v85, -v85
    v_mfma_f32_32x32x16_bf16 v[112:127], v[36:39], v[228:231], v[112:127]
    ds_read_b128 v[60:63], v1 offset:31744
    s_waitcnt vmcnt(10)
    s_barrier
    v_add_f32 v85, 1.0, v85
    v_exp_f32_e64 v86, -v86
    s_waitcnt lgkmcnt(4)
    v_mfma_f32_32x32x16_bf16 v[112:127], v[40:43], v[232:235], v[112:127]
    ds_read_b128 v[32:35], v1 offset:32768
    buffer_load_dwordx4 v1, s[4:7], s50 offen offset:1024 lds
    v_add_f32 v86, 1.0, v86
    v_exp_f32_e64 v87, -v87
    v_mfma_f32_32x32x16_bf16 v[112:127], v[44:47], v[236:239], v[112:127]
    ds_read_b128 v[36:39], v1 offset:33792
    v_rcp_f32 v80, v80
    v_add_f32 v87, 1.0, v87
    s_waitcnt lgkmcnt(4)
    v_mfma_f32_32x32x16_bf16 v[112:127], v[48:51], v[240:243], v[112:127]
    ds_read_b128 v[40:43], v1 offset:34816
    buffer_load_dwordx4 v1, s[4:7], s50 offen offset:2048 lds
    v_mul_f32 v80, v80, v88
    v_rcp_f32 v81, v81
    v_mfma_f32_32x32x16_bf16 v[112:127], v[52:55], v[244:247], v[112:127]
    ds_read_b128 v[44:47], v1 offset:35840
    s_add_u32 s95, s36, 13656064
    v_mul_f32 v81, v81, v89
    v_rcp_f32 v82, v82
    s_waitcnt lgkmcnt(4)
    v_mfma_f32_32x32x16_bf16 v[112:127], v[56:59], v[248:251], v[112:127]
    ds_read_b128 v[48:51], v1 offset:36864
    v_mul_f32 v82, v82, v90
    v_rcp_f32 v83, v83
    v_cvt_pk_bf16_f32 v88, v80, v81
    v_mfma_f32_32x32x16_bf16 v[112:127], v[60:63], v[252:255], v[112:127]
    ds_read_b128 v[52:55], v1 offset:37888
    buffer_load_dwordx4 v1, s[4:7], s50 offen offset:3072 lds
    s_add_u32 m0, s23, 102400
    v_mul_f32 v83, v83, v91
    v_rcp_f32 v84, v84
    s_waitcnt lgkmcnt(4)
    v_mfma_f32_32x32x16_bf16 v[64:79], v[32:35], v[128:131], 0
    ds_read_b128 v[56:59], v1 offset:38912
    v_mul_f32 v84, v84, v92
    v_rcp_f32 v85, v85
    v_cvt_pk_bf16_f32 v89, v82, v83
    v_mfma_f32_32x32x16_bf16 v[64:79], v[36:39], v[132:135], v[64:79]
    ds_read_b128 v[60:63], v1 offset:39936
    s_add_u32 s50, s39, 36864
    v_mul_f32 v85, v85, v93
    v_rcp_f32 v86, v86
    s_waitcnt lgkmcnt(4)
    v_mfma_f32_32x32x16_bf16 v[64:79], v[40:43], v[136:139], v[64:79]
    ds_read_b128 v[32:35], v1 offset:40960
    v_mul_f32 v86, v86, v94
    v_rcp_f32 v87, v87
    v_cvt_pk_bf16_f32 v90, v84, v85
    v_mfma_f32_32x32x16_bf16 v[64:79], v[44:47], v[140:143], v[64:79]
    ds_read_b128 v[36:39], v1 offset:41984
    buffer_load_dwordx4 v1, s[4:7], s50 offen lds
    v_mul_f32 v87, v87, v95
    v_exp_f32_e64 v96, -v96
    s_waitcnt lgkmcnt(4)
    v_mfma_f32_32x32x16_bf16 v[64:79], v[48:51], v[144:147], v[64:79]
    ds_read_b128 v[40:43], v1 offset:43008
    v_add_f32 v96, 1.0, v96
    v_exp_f32_e64 v97, -v97
    v_cvt_pk_bf16_f32 v91, v86, v87
    v_mfma_f32_32x32x16_bf16 v[64:79], v[52:55], v[148:151], v[64:79]
    ds_read_b128 v[44:47], v1 offset:44032
    buffer_store_dwordx4 v[88:91], v1, s[4:7], s95 offen nt sc0
    v_add_f32 v97, 1.0, v97
    v_exp_f32_e64 v98, -v98
    s_waitcnt lgkmcnt(4)
    v_mfma_f32_32x32x16_bf16 v[64:79], v[56:59], v[152:155], v[64:79]
    ds_read_b128 v[48:51], v1 offset:45056
    v_add_f32 v98, 1.0, v98
    v_exp_f32_e64 v99, -v99
    v_mfma_f32_32x32x16_bf16 v[64:79], v[60:63], v[156:159], v[64:79]
    ds_read_b128 v[52:55], v1 offset:46080
    buffer_load_dwordx4 v1, s[4:7], s50 offen offset:1024 lds
    v_add_f32 v99, 1.0, v99
    v_exp_f32_e64 v100, -v100
    s_waitcnt lgkmcnt(4)
    v_mfma_f32_32x32x16_bf16 v[64:79], v[32:35], v[160:163], v[64:79]
    ds_read_b128 v[56:59], v1 offset:47104
    v_add_f32 v100, 1.0, v100
    v_exp_f32_e64 v101, -v101
    v_mfma_f32_32x32x16_bf16 v[64:79], v[36:39], v[164:167], v[64:79]
    ds_read_b128 v[60:63], v1 offset:48128
    buffer_load_dwordx4 v1, s[4:7], s50 offen offset:2048 lds
    v_add_f32 v101, 1.0, v101
    v_exp_f32_e64 v102, -v102
    s_waitcnt lgkmcnt(4)
    v_mfma_f32_32x32x16_bf16 v[64:79], v[40:43], v[168:171], v[64:79]
    ds_read_b128 v[32:35], v1 offset:49152
    v_add_f32 v102, 1.0, v102
    v_exp_f32_e64 v103, -v103
    v_mfma_f32_32x32x16_bf16 v[64:79], v[44:47], v[172:175], v[64:79]
    ds_read_b128 v[36:39], v1 offset:50176
    buffer_load_dwordx4 v1, s[4:7], s50 offen offset:3072 lds
    v_rcp_f32 v96, v96
    v_add_f32 v103, 1.0, v103
    s_waitcnt lgkmcnt(4)
    v_mfma_f32_32x32x16_bf16 v[64:79], v[48:51], v[176:179], v[64:79]
    ds_read_b128 v[40:43], v1 offset:51200
    v_mul_f32 v96, v96, v104
    v_rcp_f32 v97, v97
    v_mfma_f32_32x32x16_bf16 v[64:79], v[52:55], v[180:183], v[64:79]
    ds_read_b128 v[44:47], v1 offset:52224
    s_add_u32 s94, s36, 13639680
    v_mul_f32 v97, v97, v105
    v_rcp_f32 v98, v98
    s_waitcnt lgkmcnt(4)
    v_mfma_f32_32x32x16_bf16 v[64:79], v[56:59], v[184:187], v[64:79]
    ds_read_b128 v[48:51], v1 offset:53248
    v_mul_f32 v98, v98, v106
    v_rcp_f32 v99, v99
    v_cvt_pk_bf16_f32 v104, v96, v97
    v_mfma_f32_32x32x16_bf16 v[64:79], v[60:63], v[188:191], v[64:79]
    ds_read_b128 v[52:55], v1 offset:54272
    v_mul_f32 v99, v99, v107
    v_rcp_f32 v100, v100
    s_waitcnt lgkmcnt(4)
    v_mfma_f32_32x32x16_bf16 v[64:79], v[32:35], v[192:195], v[64:79]
    ds_read_b128 v[56:59], v1 offset:55296
    v_mul_f32 v100, v100, v108
    v_rcp_f32 v101, v101
    v_cvt_pk_bf16_f32 v105, v98, v99
    v_mfma_f32_32x32x16_bf16 v[64:79], v[36:39], v[196:199], v[64:79]
    ds_read_b128 v[60:63], v1 offset:56320
    v_mul_f32 v101, v101, v109
    v_rcp_f32 v102, v102
    s_waitcnt lgkmcnt(4)
    v_mfma_f32_32x32x16_bf16 v[64:79], v[40:43], v[200:203], v[64:79]
    ds_read_b128 v[32:35], v1 offset:57344
    v_mul_f32 v102, v102, v110
    v_rcp_f32 v103, v103
    v_cvt_pk_bf16_f32 v106, v100, v101
    v_mfma_f32_32x32x16_bf16 v[64:79], v[44:47], v[204:207], v[64:79]
    ds_read_b128 v[36:39], v1 offset:58368
    v_mul_f32 v103, v103, v111
    v_exp_f32_e64 v112, -v112
    s_waitcnt lgkmcnt(4)
    v_mfma_f32_32x32x16_bf16 v[64:79], v[48:51], v[208:211], v[64:79]
    ds_read_b128 v[40:43], v1 offset:59392
    v_add_f32 v112, 1.0, v112
    v_exp_f32_e64 v113, -v113
    v_cvt_pk_bf16_f32 v107, v102, v103
    v_mfma_f32_32x32x16_bf16 v[64:79], v[52:55], v[212:215], v[64:79]
    ds_read_b128 v[44:47], v1 offset:60416
    buffer_store_dwordx4 v[104:107], v1, s[4:7], s94 offen nt sc0
    v_add_f32 v113, 1.0, v113
    v_exp_f32_e64 v114, -v114
    s_waitcnt lgkmcnt(4)
    v_mfma_f32_32x32x16_bf16 v[64:79], v[56:59], v[216:219], v[64:79]
    ds_read_b128 v[48:51], v1 offset:61440
    v_add_f32 v114, 1.0, v114
    v_exp_f32_e64 v115, -v115
    v_mfma_f32_32x32x16_bf16 v[64:79], v[60:63], v[220:223], v[64:79]
    ds_read_b128 v[52:55], v1 offset:62464
    v_add_f32 v115, 1.0, v115
    v_exp_f32_e64 v116, -v116
    s_waitcnt lgkmcnt(4)
    v_mfma_f32_32x32x16_bf16 v[64:79], v[32:35], v[224:227], v[64:79]
    ds_read_b128 v[56:59], v1 offset:63488
    v_add_f32 v116, 1.0, v116
    v_exp_f32_e64 v117, -v117
    v_mfma_f32_32x32x16_bf16 v[64:79], v[36:39], v[228:231], v[64:79]
    ds_read_b128 v[60:63], v1 offset:64512
    s_waitcnt vmcnt(11)
    s_barrier
    v_add_f32 v117, 1.0, v117
    v_exp_f32_e64 v118, -v118
    s_waitcnt lgkmcnt(4)
    v_mfma_f32_32x32x16_bf16 v[64:79], v[40:43], v[232:235], v[64:79]
    ds_read_b128 v[32:35], v2 offset:0
    v_add_f32 v118, 1.0, v118
    v_exp_f32_e64 v119, -v119
    v_mfma_f32_32x32x16_bf16 v[64:79], v[44:47], v[236:239], v[64:79]
    ds_read_b128 v[36:39], v2 offset:1024
    v_rcp_f32 v112, v112
    v_add_f32 v119, 1.0, v119
    s_waitcnt lgkmcnt(4)
    v_mfma_f32_32x32x16_bf16 v[64:79], v[48:51], v[240:243], v[64:79]
    ds_read_b128 v[40:43], v2 offset:2048
    v_mul_f32 v112, v112, v120
    v_rcp_f32 v113, v113
    v_mfma_f32_32x32x16_bf16 v[64:79], v[52:55], v[244:247], v[64:79]
    ds_read_b128 v[44:47], v2 offset:3072
    s_add_u32 s95, s36, 13643776
    v_mul_f32 v113, v113, v121
    v_rcp_f32 v114, v114
    s_waitcnt lgkmcnt(4)
    v_mfma_f32_32x32x16_bf16 v[64:79], v[56:59], v[248:251], v[64:79]
    ds_read_b128 v[48:51], v2 offset:4096
    v_mul_f32 v114, v114, v122
    v_rcp_f32 v115, v115
    v_cvt_pk_bf16_f32 v120, v112, v113
    v_mfma_f32_32x32x16_bf16 v[64:79], v[60:63], v[252:255], v[64:79]
    ds_read_b128 v[52:55], v2 offset:5120
    v_mul_f32 v115, v115, v123
    v_rcp_f32 v116, v116
    s_waitcnt lgkmcnt(4)
    v_mfma_f32_32x32x16_bf16 v[80:95], v[32:35], v[128:131], 0
    ds_read_b128 v[56:59], v2 offset:6144
    v_mul_f32 v116, v116, v124
    v_rcp_f32 v117, v117
    v_cvt_pk_bf16_f32 v121, v114, v115
    v_mfma_f32_32x32x16_bf16 v[80:95], v[36:39], v[132:135], v[80:95]
    ds_read_b128 v[60:63], v2 offset:7168
    s_waitcnt vmcnt(0)
    v_mul_f32 v117, v117, v125
    v_rcp_f32 v118, v118
    s_waitcnt lgkmcnt(4)
    v_mfma_f32_32x32x16_bf16 v[80:95], v[40:43], v[136:139], v[80:95]
    ds_read_b128 v[32:35], v2 offset:8192
    v_mul_f32 v118, v118, v126
    v_rcp_f32 v119, v119
    v_cvt_pk_bf16_f32 v122, v116, v117
    v_mfma_f32_32x32x16_bf16 v[80:95], v[44:47], v[140:143], v[80:95]
    ds_read_b128 v[36:39], v2 offset:9216
    buffer_store_dword v18, v6, s[4:7], s42 offen
    v_mul_f32 v119, v119, v127
    v_exp_f32_e64 v64, -v64
    s_waitcnt lgkmcnt(4)
    v_mfma_f32_32x32x16_bf16 v[80:95], v[48:51], v[144:147], v[80:95]
    ds_read_b128 v[40:43], v2 offset:10240
    v_add_f32 v64, 1.0, v64
    v_exp_f32_e64 v65, -v65
    v_cvt_pk_bf16_f32 v123, v118, v119
    v_mfma_f32_32x32x16_bf16 v[80:95], v[52:55], v[148:151], v[80:95]
    ds_read_b128 v[44:47], v2 offset:11264
    buffer_store_dwordx4 v[120:123], v1, s[4:7], s95 offen nt sc0
    v_add_f32 v65, 1.0, v65
    v_exp_f32_e64 v66, -v66
    s_waitcnt lgkmcnt(4)
    v_mfma_f32_32x32x16_bf16 v[80:95], v[56:59], v[152:155], v[80:95]
    ds_read_b128 v[48:51], v2 offset:12288
    v_add_f32 v66, 1.0, v66
    v_exp_f32_e64 v67, -v67
    v_mfma_f32_32x32x16_bf16 v[80:95], v[60:63], v[156:159], v[80:95]
    ds_read_b128 v[52:55], v2 offset:13312
    v_add_f32 v67, 1.0, v67
    v_exp_f32_e64 v68, -v68
    s_waitcnt lgkmcnt(4)
    v_mfma_f32_32x32x16_bf16 v[80:95], v[32:35], v[160:163], v[80:95]
    ds_read_b128 v[56:59], v2 offset:14336
    v_add_f32 v68, 1.0, v68
    v_exp_f32_e64 v69, -v69
    v_mfma_f32_32x32x16_bf16 v[80:95], v[36:39], v[164:167], v[80:95]
    ds_read_b128 v[60:63], v2 offset:15360
    v_add_f32 v69, 1.0, v69
    v_exp_f32_e64 v70, -v70
    s_waitcnt lgkmcnt(4)
    v_mfma_f32_32x32x16_bf16 v[80:95], v[40:43], v[168:171], v[80:95]
    ds_read_b128 v[32:35], v2 offset:16384
    v_add_f32 v70, 1.0, v70
    v_exp_f32_e64 v71, -v71
    v_mfma_f32_32x32x16_bf16 v[80:95], v[44:47], v[172:175], v[80:95]
    ds_read_b128 v[36:39], v2 offset:17408
    buffer_load_dword v17, v4, s[4:7], s43 offen sc1
    v_rcp_f32 v64, v64
    v_add_f32 v71, 1.0, v71
    s_waitcnt lgkmcnt(4)
    v_mfma_f32_32x32x16_bf16 v[80:95], v[48:51], v[176:179], v[80:95]
    ds_read_b128 v[40:43], v2 offset:18432
    v_mul_f32 v64, v64, v72
    v_rcp_f32 v65, v65
    v_mfma_f32_32x32x16_bf16 v[80:95], v[52:55], v[180:183], v[80:95]
    ds_read_b128 v[44:47], v2 offset:19456
    s_add_u32 s94, s36, 13647872
    v_mul_f32 v65, v65, v73
    v_rcp_f32 v66, v66
    s_waitcnt lgkmcnt(4)
    v_mfma_f32_32x32x16_bf16 v[80:95], v[56:59], v[184:187], v[80:95]
    ds_read_b128 v[48:51], v2 offset:20480
    v_mul_f32 v66, v66, v74
    v_rcp_f32 v67, v67
    v_cvt_pk_bf16_f32 v72, v64, v65
    v_mfma_f32_32x32x16_bf16 v[80:95], v[60:63], v[188:191], v[80:95]
    ds_read_b128 v[52:55], v2 offset:21504
    v_mul_f32 v67, v67, v75
    v_rcp_f32 v68, v68
    s_waitcnt lgkmcnt(4)
    v_mfma_f32_32x32x16_bf16 v[80:95], v[32:35], v[192:195], v[80:95]
    ds_read_b128 v[56:59], v2 offset:22528
    v_mul_f32 v68, v68, v76
    v_rcp_f32 v69, v69
    v_cvt_pk_bf16_f32 v73, v66, v67
    v_mfma_f32_32x32x16_bf16 v[80:95], v[36:39], v[196:199], v[80:95]
    ds_read_b128 v[60:63], v2 offset:23552
    v_mul_f32 v69, v69, v77
    v_rcp_f32 v70, v70
    s_waitcnt lgkmcnt(4)
    v_mfma_f32_32x32x16_bf16 v[80:95], v[40:43], v[200:203], v[80:95]
    ds_read_b128 v[32:35], v2 offset:24576
    v_mul_f32 v70, v70, v78
    v_rcp_f32 v71, v71
    v_cvt_pk_bf16_f32 v74, v68, v69
    v_mfma_f32_32x32x16_bf16 v[80:95], v[44:47], v[204:207], v[80:95]
    ds_read_b128 v[36:39], v2 offset:25600
    v_mul_f32 v71, v71, v79
    s_waitcnt lgkmcnt(4)
    v_mfma_f32_32x32x16_bf16 v[80:95], v[48:51], v[208:211], v[80:95]
    ds_read_b128 v[40:43], v2 offset:26624
    v_cvt_pk_bf16_f32 v75, v70, v71
    v_mfma_f32_32x32x16_bf16 v[80:95], v[52:55], v[212:215], v[80:95]
    ds_read_b128 v[44:47], v2 offset:27648
    buffer_store_dwordx4 v[72:75], v1, s[4:7], s94 offen nt sc0
    s_add_u32 s96, s37, 13651968
    s_add_u32 s97, s37, 13656064
    s_waitcnt lgkmcnt(4)
    v_mfma_f32_32x32x16_bf16 v[80:95], v[56:59], v[216:219], v[80:95]
    ds_read_b128 v[48:51], v2 offset:28672
    v_mfma_f32_32x32x16_bf16 v[80:95], v[60:63], v[220:223], v[80:95]
    ds_read_b128 v[52:55], v2 offset:29696
    s_waitcnt vmcnt(1)
    v_cmp_ne_u32 vcc, s51, v17
    s_cbranch_vccnz L_polls_51
L_pollb_52:
    s_waitcnt lgkmcnt(4)
    v_mfma_f32_32x32x16_bf16 v[80:95], v[32:35], v[224:227], v[80:95]
    ds_read_b128 v[56:59], v2 offset:30720
    buffer_load_dwordx4 a[236:239], v1, s[4:7], s96 offen sc1
    v_mfma_f32_32x32x16_bf16 v[80:95], v[36:39], v[228:231], v[80:95]
    ds_read_b128 v[60:63], v2 offset:31744
    s_barrier
    s_waitcnt lgkmcnt(4)
    v_mfma_f32_32x32x16_bf16 v[80:95], v[40:43], v[232:235], v[80:95]
    ds_read_b128 v[32:35], v2 offset:32768
    s_add_u32 s3, s38, s64
    v_mfma_f32_32x32x16_bf16 v[80:95], v[44:47], v[236:239], v[80:95]
    ds_read_b128 v[36:39], v2 offset:33792
    buffer_load_dwordx4 v[20:23], v1, s[4:7], s3 offen sc1
    s_waitcnt lgkmcnt(4)
    v_mfma_f32_32x32x16_bf16 v[80:95], v[48:51], v[240:243], v[80:95]
    ds_read_b128 v[40:43], v2 offset:34816
    s_add_u32 s3, s3, 32768
    v_mfma_f32_32x32x16_bf16 v[80:95], v[52:55], v[244:247], v[80:95]
    ds_read_b128 v[44:47], v2 offset:35840
    buffer_load_dwordx4 v[24:27], v1, s[4:7], s3 offen sc1
    s_waitcnt lgkmcnt(4)
    v_mfma_f32_32x32x16_bf16 v[80:95], v[56:59], v[248:251], v[80:95]
    ds_read_b128 v[48:51], v2 offset:36864
    v_mfma_f32_32x32x16_bf16 v[80:95], v[60:63], v[252:255], v[80:95]
    ds_read_b128 v[52:55], v2 offset:37888
    buffer_load_dwordx4 a[240:243], v1, s[4:7], s96 offen offset:1024 sc1
    s_waitcnt lgkmcnt(4)
    v_mfma_f32_32x32x16_bf16 v[96:111], v[32:35], v[128:131], 0
    ds_read_b128 v[56:59], v2 offset:38912
    v_mfma_f32_32x32x16_bf16 v[96:111], v[36:39], v[132:135], v[96:111]
    ds_read_b128 v[60:63], v2 offset:39936
    buffer_load_dwordx4 a[244:247], v1, s[4:7], s96 offen offset:2048 sc1
    s_waitcnt lgkmcnt(4)
    v_mfma_f32_32x32x16_bf16 v[96:111], v[40:43], v[136:139], v[96:111]
    ds_read_b128 v[32:35], v2 offset:40960
    v_mfma_f32_32x32x16_bf16 v[96:111], v[44:47], v[140:143], v[96:111]
    ds_read_b128 v[36:39], v2 offset:41984
    buffer_load_dwordx4 a[248:251], v1, s[4:7], s96 offen offset:3072 sc1
    s_add_u32 s96, s37, 13639680
    s_waitcnt lgkmcnt(4)
    v_mfma_f32_32x32x16_bf16 v[96:111], v[48:51], v[144:147], v[96:111]
    ds_read_b128 v[40:43], v2 offset:43008
    v_exp_f32_e64 v80, -v80
    v_mfma_f32_32x32x16_bf16 v[96:111], v[52:55], v[148:151], v[96:111]
    ds_read_b128 v[44:47], v2 offset:44032
    buffer_load_dwordx4 a[252:255], v1, s[4:7], s97 offen sc1
    v_add_f32 v80, 1.0, v80
    v_exp_f32_e64 v81, -v81
    s_waitcnt lgkmcnt(4)
    v_mfma_f32_32x32x16_bf16 v[96:111], v[56:59], v[152:155], v[96:111]
    ds_read_b128 v[48:51], v2 offset:45056
    v_add_f32 v81, 1.0, v81
    v_exp_f32_e64 v82, -v82
    v_mfma_f32_32x32x16_bf16 v[96:111], v[60:63], v[156:159], v[96:111]
    ds_read_b128 v[52:55], v2 offset:46080
    buffer_load_dwordx4 v[128:131], v1, s[4:7], s97 offen offset:1024 sc1
    v_add_f32 v82, 1.0, v82
    v_exp_f32_e64 v83, -v83
    s_waitcnt lgkmcnt(4)
    v_mfma_f32_32x32x16_bf16 v[96:111], v[32:35], v[160:163], v[96:111]
    ds_read_b128 v[56:59], v2 offset:47104
    v_add_f32 v83, 1.0, v83
    v_exp_f32_e64 v84, -v84
    v_mfma_f32_32x32x16_bf16 v[96:111], v[36:39], v[164:167], v[96:111]
    ds_read_b128 v[60:63], v2 offset:48128
    buffer_load_dwordx4 v[132:135], v1, s[4:7], s97 offen offset:2048 sc1
    v_add_f32 v84, 1.0, v84
    v_exp_f32_e64 v85, -v85
    s_waitcnt lgkmcnt(4)
    v_mfma_f32_32x32x16_bf16 v[96:111], v[40:43], v[168:171], v[96:111]
    ds_read_b128 v[32:35], v2 offset:49152
    v_add_f32 v85, 1.0, v85
    v_exp_f32_e64 v86, -v86
    v_mfma_f32_32x32x16_bf16 v[96:111], v[44:47], v[172:175], v[96:111]
    ds_read_b128 v[36:39], v2 offset:50176
    buffer_load_dwordx4 v[136:139], v1, s[4:7], s97 offen offset:3072 sc1
    s_add_u32 s97, s37, 13766656
    v_add_f32 v86, 1.0, v86
    v_exp_f32_e64 v87, -v87
    s_waitcnt lgkmcnt(4)
    v_mfma_f32_32x32x16_bf16 v[96:111], v[48:51], v[176:179], v[96:111]
    ds_read_b128 v[40:43], v2 offset:51200
    v_rcp_f32 v80, v80
    v_add_f32 v87, 1.0, v87
    v_mfma_f32_32x32x16_bf16 v[96:111], v[52:55], v[180:183], v[96:111]
    ds_read_b128 v[44:47], v2 offset:52224
    buffer_load_dwordx4 v[140:143], v1, s[4:7], s96 offen sc1
    v_mul_f32 v80, v80, v88
    v_rcp_f32 v81, v81
    s_waitcnt lgkmcnt(4)
    v_mfma_f32_32x32x16_bf16 v[96:111], v[56:59], v[184:187], v[96:111]
    ds_read_b128 v[48:51], v2 offset:53248
    s_add_u32 s95, s36, 13631488
    v_mul_f32 v81, v81, v89
    v_rcp_f32 v82, v82
    v_mfma_f32_32x32x16_bf16 v[96:111], v[60:63], v[188:191], v[96:111]
    ds_read_b128 v[52:55], v2 offset:54272
    buffer_load_dwordx4 v[144:147], v1, s[4:7], s96 offen offset:1024 sc1
    v_mul_f32 v82, v82, v90
    v_rcp_f32 v83, v83
    v_cvt_pk_bf16_f32 v88, v80, v81
    s_waitcnt lgkmcnt(4)
    v_mfma_f32_32x32x16_bf16 v[96:111], v[32:35], v[192:195], v[96:111]
    ds_read_b128 v[56:59], v2 offset:55296
    v_mul_f32 v83, v83, v91
    v_rcp_f32 v84, v84
    v_mfma_f32_32x32x16_bf16 v[96:111], v[36:39], v[196:199], v[96:111]
    ds_read_b128 v[60:63], v2 offset:56320
    buffer_load_dwordx4 v[148:151], v1, s[4:7], s96 offen offset:2048 sc1
    v_mul_f32 v84, v84, v92
    v_rcp_f32 v85, v85
    v_cvt_pk_bf16_f32 v89, v82, v83
    s_waitcnt lgkmcnt(4)
    v_mfma_f32_32x32x16_bf16 v[96:111], v[40:43], v[200:203], v[96:111]
    ds_read_b128 v[32:35], v2 offset:57344
    v_mul_f32 v85, v85, v93
    v_rcp_f32 v86, v86
    v_mfma_f32_32x32x16_bf16 v[96:111], v[44:47], v[204:207], v[96:111]
    ds_read_b128 v[36:39], v2 offset:58368
    buffer_load_dwordx4 v[152:155], v1, s[4:7], s96 offen offset:3072 sc1
    v_mul_f32 v86, v86, v94
    v_rcp_f32 v87, v87
    v_cvt_pk_bf16_f32 v90, v84, v85
    s_waitcnt lgkmcnt(4)
    v_mfma_f32_32x32x16_bf16 v[96:111], v[48:51], v[208:211], v[96:111]
    ds_read_b128 v[40:43], v2 offset:59392
    s_add_u32 s96, s37, 13770752
    v_mul_f32 v87, v87, v95
    v_mfma_f32_32x32x16_bf16 v[96:111], v[52:55], v[212:215], v[96:111]
    ds_read_b128 v[44:47], v2 offset:60416
    v_cvt_pk_bf16_f32 v91, v86, v87
    s_waitcnt lgkmcnt(4)
    v_mfma_f32_32x32x16_bf16 v[96:111], v[56:59], v[216:219], v[96:111]
    ds_read_b128 v[48:51], v2 offset:61440
    buffer_store_dwordx4 v[88:91], v1, s[4:7], s95 offen nt sc0
    v_mfma_f32_32x32x16_bf16 v[96:111], v[60:63], v[220:223], v[96:111]
    ds_read_b128 v[52:55], v2 offset:62464
    s_waitcnt lgkmcnt(4)
    v_mfma_f32_32x32x16_bf16 v[96:111], v[32:35], v[224:227], v[96:111]
    ds_read_b128 v[56:59], v2 offset:63488
    buffer_load_dwordx4 v[156:159], v1, s[4:7], s97 offen sc1
    v_mfma_f32_32x32x16_bf16 v[96:111], v[36:39], v[228:231], v[96:111]
    ds_read_b128 v[60:63], v2 offset:64512
    s_waitcnt lgkmcnt(4)
    v_mfma_f32_32x32x16_bf16 v[96:111], v[40:43], v[232:235], v[96:111]
    buffer_load_dwordx4 v[160:163], v1, s[4:7], s97 offen offset:1024 sc1
    v_mfma_f32_32x32x16_bf16 v[96:111], v[44:47], v[236:239], v[96:111]
    s_waitcnt lgkmcnt(2)
    v_mfma_f32_32x32x16_bf16 v[96:111], v[48:51], v[240:243], v[96:111]
    buffer_load_dwordx4 v[164:167], v1, s[4:7], s97 offen offset:2048 sc1
    v_mfma_f32_32x32x16_bf16 v[96:111], v[52:55], v[244:247], v[96:111]
    s_waitcnt lgkmcnt(0)
    v_mfma_f32_32x32x16_bf16 v[96:111], v[56:59], v[248:251], v[96:111]
    buffer_load_dwordx4 v[168:171], v1, s[4:7], s97 offen offset:3072 sc1
    s_add_u32 s97, s37, 13754368
    v_mfma_f32_32x32x16_bf16 v[96:111], v[60:63], v[252:255], v[96:111]
    s_waitcnt vmcnt(18)
    v_mfma_f32_32x32x16_bf16 v[64:79], a[40:43], a[236:239], 0
    buffer_load_dwordx4 v[172:175], v1, s[4:7], s96 offen sc1
    v_mfma_f32_32x32x16_bf16 v[80:95], a[44:47], a[236:239], 0
    s_waitcnt vmcnt(16)
    v_mfma_f32_32x32x16_bf16 v[64:79], a[96:99], a[240:243], v[64:79]
    buffer_load_dwordx4 v[176:179], v1, s[4:7], s96 offen offset:1024 sc1
    s_waitcnt vmcnt(6)
    v_mfma_f32_32x32x16_bf16 v[80:95], a[100:103], a[240:243], v[80:95]
    buffer_store_dword v18, v6, s[4:7], s42 offen offset:256
    v_mfma_f32_32x32x16_bf16 v[64:79], a[152:155], a[244:247], v[64:79]
    buffer_load_dwordx4 v[180:183], v1, s[4:7], s96 offen offset:2048 sc1
    v_exp_f32_e64 v96, -v96
    v_mfma_f32_32x32x16_bf16 v[80:95], a[156:159], a[244:247], v[80:95]
    v_add_f32 v96, 1.0, v96
    v_exp_f32_e64 v97, -v97
    v_mfma_f32_32x32x16_bf16 v[64:79], a[208:211], a[248:251], v[64:79]
    buffer_load_dwordx4 v[184:187], v1, s[4:7], s96 offen offset:3072 sc1
    v_add_f32 v97, 1.0, v97
    v_exp_f32_e64 v98, -v98
    v_mfma_f32_32x32x16_bf16 v[80:95], a[212:215], a[248:251], v[80:95]
    v_add_f32 v98, 1.0, v98
    v_exp_f32_e64 v99, -v99
    v_mfma_f32_32x32x16_bf16 v[64:79], a[48:51], a[252:255], v[64:79]
    buffer_load_dwordx4 v[188:191], v1, s[4:7], s97 offen sc1
    v_add_f32 v99, 1.0, v99
    v_exp_f32_e64 v100, -v100
    v_mfma_f32_32x32x16_bf16 v[80:95], a[52:55], a[252:255], v[80:95]
    v_add_f32 v100, 1.0, v100
    v_exp_f32_e64 v101, -v101
    v_mfma_f32_32x32x16_bf16 v[64:79], a[104:107], v[128:131], v[64:79]
    buffer_load_dwordx4 v[192:195], v1, s[4:7], s97 offen offset:1024 sc1
    v_add_f32 v101, 1.0, v101
    v_exp_f32_e64 v102, -v102
    v_mfma_f32_32x32x16_bf16 v[80:95], a[108:111], v[128:131], v[80:95]
    buffer_load_dword v17, v4, s[4:7], s43 offen offset:256 sc1
    v_add_f32 v102, 1.0, v102
    v_exp_f32_e64 v103, -v103
    v_mfma_f32_32x32x16_bf16 v[64:79], a[160:163], v[132:135], v[64:79]
    buffer_load_dwordx4 v[196:199], v1, s[4:7], s97 offen offset:2048 sc1
    v_rcp_f32 v96, v96
    v_add_f32 v103, 1.0, v103
    v_mfma_f32_32x32x16_bf16 v[80:95], a[164:167], v[132:135], v[80:95]
    v_mul_f32 v96, v96, v104
    v_rcp_f32 v97, v97
    v_mfma_f32_32x32x16_bf16 v[64:79], a[216:219], v[136:139], v[64:79]
    buffer_load_dwordx4 v[200:203], v1, s[4:7], s97 offen offset:3072 sc1
    s_add_u32 s94, s36, 13635584
    v_mul_f32 v97, v97, v105
    v_rcp_f32 v98, v98
    v_mfma_f32_32x32x16_bf16 v[80:95], a[220:223], v[136:139], v[80:95]
    v_mul_f32 v98, v98, v106
    v_rcp_f32 v99, v99
    v_cvt_pk_bf16_f32 v104, v96, v97
    v_mfma_f32_32x32x16_bf16 v[64:79], a[16:19], v[140:143], v[64:79]
    v_mul_f32 v99, v99, v107
    v_rcp_f32 v100, v100
    v_mfma_f32_32x32x16_bf16 v[80:95], a[20:23], v[140:143], v[80:95]
    v_mul_f32 v100, v100, v108
    v_rcp_f32 v101, v101
    v_cvt_pk_bf16_f32 v105, v98, v99
    v_mfma_f32_32x32x16_bf16 v[64:79], a[72:75], v[144:147], v[64:79]
    v_mul_f32 v101, v101, v109
    v_rcp_f32 v102, v102
    v_mfma_f32_32x32x16_bf16 v[80:95], a[76:79], v[144:147], v[80:95]
    v_mul_f32 v102, v102, v110
    v_rcp_f32 v103, v103
    v_cvt_pk_bf16_f32 v106, v100, v101
    v_mfma_f32_32x32x16_bf16 v[64:79], a[128:131], v[148:151], v[64:79]
    v_mul_f32 v103, v103, v111
    v_mfma_f32_32x32x16_bf16 v[80:95], a[132:135], v[148:151], v[80:95]
    v_cvt_pk_bf16_f32 v107, v102, v103
    v_mfma_f32_32x32x16_bf16 v[64:79], a[184:187], v[152:155], v[64:79]
    buffer_store_dwordx4 v[104:107], v1, s[4:7], s94 offen nt sc0
    v_mfma_f32_32x32x16_bf16 v[80:95], a[188:191], v[152:155], v[80:95]
    s_add_u32 s96, s37, 13643776
    s_add_u32 s97, s37, 13647872
    s_waitcnt vmcnt(14)
    v_mfma_f32_32x32x16_bf16 v[112:127], a[40:43], v[156:159], 0
    v_mfma_f32_32x32x16_bf16 v[96:111], a[44:47], v[156:159], 0
    s_waitcnt vmcnt(3)
    v_cmp_ne_u32 vcc, s51, v17
    s_cbranch_vccnz L_polls_54
L_pollb_55:
    v_mfma_f32_32x32x16_bf16 v[112:127], a[96:99], v[160:163], v[112:127]
    buffer_load_dwordx4 v[204:207], v1, s[4:7], s96 offen sc1
    v_mfma_f32_32x32x16_bf16 v[96:111], a[100:103], v[160:163], v[96:111]
    v_mfma_f32_32x32x16_bf16 v[112:127], a[152:155], v[164:167], v[112:127]
    buffer_load_dwordx4 v[208:211], v1, s[4:7], s96 offen offset:1024 sc1
    v_mfma_f32_32x32x16_bf16 v[96:111], a[156:159], v[164:167], v[96:111]
    v_mfma_f32_32x32x16_bf16 v[112:127], a[208:211], v[168:171], v[112:127]
    buffer_load_dwordx4 v[212:215], v1, s[4:7], s96 offen offset:2048 sc1
    v_mfma_f32_32x32x16_bf16 v[96:111], a[212:215], v[168:171], v[96:111]
    v_mfma_f32_32x32x16_bf16 v[112:127], a[48:51], v[172:175], v[112:127]
    buffer_load_dwordx4 v[216:219], v1, s[4:7], s96 offen offset:3072 sc1
    s_add_u32 s96, s37, 13631488
    v_mfma_f32_32x32x16_bf16 v[96:111], a[52:55], v[172:175], v[96:111]
    v_mfma_f32_32x32x16_bf16 v[112:127], a[104:107], v[176:179], v[112:127]
    buffer_load_dwordx4 v[220:223], v1, s[4:7], s97 offen sc1
    s_waitcnt vmcnt(5)
    v_mfma_f32_32x32x16_bf16 v[96:111], a[108:111], v[176:179], v[96:111]
    buffer_store_dword v18, v6, s[4:7], s42 offen offset:512
    v_mfma_f32_32x32x16_bf16 v[112:127], a[160:163], v[180:183], v[112:127]
    buffer_load_dwordx4 v[224:227], v1, s[4:7], s97 offen offset:1024 sc1
    v_mfma_f32_32x32x16_bf16 v[96:111], a[164:167], v[180:183], v[96:111]
    v_mfma_f32_32x32x16_bf16 v[112:127], a[216:219], v[184:187], v[112:127]
    buffer_load_dwordx4 v[228:231], v1, s[4:7], s97 offen offset:2048 sc1
    v_mfma_f32_32x32x16_bf16 v[96:111], a[220:223], v[184:187], v[96:111]
    v_mfma_f32_32x32x16_bf16 v[112:127], a[16:19], v[188:191], v[112:127]
    buffer_load_dwordx4 v[232:235], v1, s[4:7], s97 offen offset:3072 sc1
    s_add_u32 s97, s37, 13758464
    v_lshlrev_b32 v56, 16, v24
    v_and_b32 v57, s31, v24
    v_mfma_f32_32x32x16_bf16 v[96:111], a[20:23], v[188:191], v[96:111]
    v_lshlrev_b32 v58, 16, v25
    v_and_b32 v59, s31, v25
    v_lshlrev_b32 v60, 16, v26
    v_and_b32 v61, s31, v26
    v_lshlrev_b32 v62, 16, v27
    v_and_b32 v63, s31, v27
    v_mfma_f32_32x32x16_bf16 v[112:127], a[72:75], v[192:195], v[112:127]
    buffer_load_dwordx4 v[236:239], v1, s[4:7], s96 offen sc1
    v_mfma_f32_32x32x16_bf16 v[96:111], a[76:79], v[192:195], v[96:111]
    buffer_load_dword v17, v4, s[4:7], s43 offen offset:512 sc1
    v_mfma_f32_32x32x16_bf16 v[112:127], a[128:131], v[196:199], v[112:127]
    buffer_load_dwordx4 v[240:243], v1, s[4:7], s96 offen offset:1024 sc1
    v_mfma_f32_32x32x16_bf16 v[96:111], a[132:135], v[196:199], v[96:111]
    v_mfma_f32_32x32x16_bf16 v[112:127], a[184:187], v[200:203], v[112:127]
    buffer_load_dwordx4 v[244:247], v1, s[4:7], s96 offen offset:2048 sc1
    v_mfma_f32_32x32x16_bf16 v[96:111], a[188:191], v[200:203], v[96:111]
    s_waitcnt vmcnt(12)
    v_mfma_f32_32x32x16_bf16 v[64:79], a[24:27], v[204:207], v[64:79]
    buffer_load_dwordx4 v[248:251], v1, s[4:7], s96 offen offset:3072 sc1
    v_mfma_f32_32x32x16_bf16 v[80:95], a[28:31], v[204:207], v[80:95]
    s_waitcnt vmcnt(12)
    v_mfma_f32_32x32x16_bf16 v[64:79], a[80:83], v[208:211], v[64:79]
    buffer_load_dwordx4 v[252:255], v1, s[4:7], s97 offen sc1
    v_mfma_f32_32x32x16_bf16 v[80:95], a[84:87], v[208:211], v[80:95]
    s_waitcnt vmcnt(12)
    v_mfma_f32_32x32x16_bf16 v[64:79], a[136:139], v[212:215], v[64:79]
    buffer_load_dwordx4 a[236:239], v1, s[4:7], s97 offen offset:1024 sc1
    v_mfma_f32_32x32x16_bf16 v[80:95], a[140:143], v[212:215], v[80:95]
    s_waitcnt vmcnt(12)
    v_mfma_f32_32x32x16_bf16 v[64:79], a[192:195], v[216:219], v[64:79]
    buffer_load_dwordx4 a[240:243], v1, s[4:7], s97 offen offset:2048 sc1
    v_mfma_f32_32x32x16_bf16 v[80:95], a[196:199], v[216:219], v[80:95]
    s_add_u32 s96, s37, 13635584
    s_waitcnt vmcnt(12)
    v_mfma_f32_32x32x16_bf16 v[64:79], a[32:35], v[220:223], v[64:79]
    buffer_load_dwordx4 a[244:247], v1, s[4:7], s97 offen offset:3072 sc1
    s_add_u32 s97, s37, 13762560
    v_mfma_f32_32x32x16_bf16 v[80:95], a[36:39], v[220:223], v[80:95]
    s_waitcnt vmcnt(7)
    v_cmp_ne_u32 vcc, s51, v17
    s_cbranch_vccnz L_polls_57
L_pollb_58:
    v_mfma_f32_32x32x16_bf16 v[64:79], a[88:91], v[224:227], v[64:79]
    buffer_load_dwordx4 a[248:251], v1, s[4:7], s96 offen sc1
    v_mfma_f32_32x32x16_bf16 v[80:95], a[92:95], v[224:227], v[80:95]
    v_mfma_f32_32x32x16_bf16 v[64:79], a[144:147], v[228:231], v[64:79]
    buffer_load_dwordx4 a[252:255], v1, s[4:7], s96 offen offset:1024 sc1
    v_mfma_f32_32x32x16_bf16 v[80:95], a[148:151], v[228:231], v[80:95]
    v_mfma_f32_32x32x16_bf16 v[64:79], a[200:203], v[232:235], v[64:79]
    buffer_load_dwordx4 v[128:131], v1, s[4:7], s96 offen offset:2048 sc1
    v_mfma_f32_32x32x16_bf16 v[80:95], a[204:207], v[232:235], v[80:95]
    v_mfma_f32_32x32x16_bf16 v[64:79], a[0:3], v[236:239], v[64:79]
    buffer_load_dwordx4 v[132:135], v1, s[4:7], s96 offen offset:3072 sc1
    s_add_u32 s96, s37, 13746176
    v_mfma_f32_32x32x16_bf16 v[80:95], a[4:7], v[236:239], v[80:95]
    s_waitcnt vmcnt(10)
    v_mfma_f32_32x32x16_bf16 v[64:79], a[56:59], v[240:243], v[64:79]
    buffer_load_dwordx4 v[136:139], v1, s[4:7], s97 offen sc1
    v_mfma_f32_32x32x16_bf16 v[80:95], a[60:63], v[240:243], v[80:95]
    s_waitcnt vmcnt(10)
    v_mfma_f32_32x32x16_bf16 v[64:79], a[112:115], v[244:247], v[64:79]
    buffer_load_dwordx4 v[140:143], v1, s[4:7], s97 offen offset:1024 sc1
    v_mfma_f32_32x32x16_bf16 v[80:95], a[116:119], v[244:247], v[80:95]
    s_waitcnt vmcnt(10)
    v_mfma_f32_32x32x16_bf16 v[64:79], a[168:171], v[248:251], v[64:79]
    buffer_load_dwordx4 v[144:147], v1, s[4:7], s97 offen offset:2048 sc1
    v_mfma_f32_32x32x16_bf16 v[80:95], a[172:175], v[248:251], v[80:95]
    s_waitcnt vmcnt(10)
    v_mfma_f32_32x32x16_bf16 v[112:127], a[24:27], v[252:255], v[112:127]
    buffer_load_dwordx4 v[148:151], v1, s[4:7], s97 offen offset:3072 sc1
    s_add_u32 s97, s37, 13750272
    v_mfma_f32_32x32x16_bf16 v[96:111], a[28:31], v[252:255], v[96:111]
    s_waitcnt vmcnt(10)
    v_mfma_f32_32x32x16_bf16 v[112:127], a[80:83], a[236:239], v[112:127]
    buffer_load_dwordx4 v[152:155], v1, s[4:7], s96 offen sc1
    v_mfma_f32_32x32x16_bf16 v[96:111], a[84:87], a[236:239], v[96:111]
    s_waitcnt vmcnt(10)
    v_mfma_f32_32x32x16_bf16 v[112:127], a[136:139], a[240:243], v[112:127]
    buffer_load_dwordx4 v[156:159], v1, s[4:7], s96 offen offset:1024 sc1
    v_mfma_f32_32x32x16_bf16 v[96:111], a[140:143], a[240:243], v[96:111]
    s_waitcnt vmcnt(10)
    v_mfma_f32_32x32x16_bf16 v[112:127], a[192:195], a[244:247], v[112:127]
    buffer_load_dwordx4 v[160:163], v1, s[4:7], s96 offen offset:2048 sc1
    v_mfma_f32_32x32x16_bf16 v[96:111], a[196:199], a[244:247], v[96:111]
    s_waitcnt vmcnt(10)
    v_mfma_f32_32x32x16_bf16 v[64:79], a[8:11], a[248:251], v[64:79]
    buffer_load_dwordx4 v[164:167], v1, s[4:7], s96 offen offset:3072 sc1
    v_mfma_f32_32x32x16_bf16 v[80:95], a[12:15], a[248:251], v[80:95]
    s_waitcnt vmcnt(10)
    v_mfma_f32_32x32x16_bf16 v[64:79], a[64:67], a[252:255], v[64:79]
    buffer_load_dwordx4 v[168:171], v1, s[4:7], s97 offen sc1
    v_mfma_f32_32x32x16_bf16 v[80:95], a[68:71], a[252:255], v[80:95]
    s_waitcnt vmcnt(10)
    v_mfma_f32_32x32x16_bf16 v[64:79], a[120:123], v[128:131], v[64:79]
    buffer_load_dwordx4 v[172:175], v1, s[4:7], s97 offen offset:1024 sc1
    v_mfma_f32_32x32x16_bf16 v[80:95], a[124:127], v[128:131], v[80:95]
    s_waitcnt vmcnt(10)
    v_mfma_f32_32x32x16_bf16 v[80:95], a[180:183], v[132:135], v[80:95]
    buffer_load_dwordx4 v[176:179], v1, s[4:7], s97 offen offset:2048 sc1
    v_mfma_f32_32x32x16_bf16 v[64:79], a[176:179], v[132:135], v[64:79]
    s_waitcnt vmcnt(10)
    v_mfma_f32_32x32x16_bf16 v[112:127], a[32:35], v[136:139], v[112:127]
    buffer_load_dwordx4 v[180:183], v1, s[4:7], s97 offen offset:3072 sc1
    v_and_b32 v28, 31, v0
    v_lshlrev_b32 v28, 10, v28
    v_bfe_u32 v29, v0, 5, 1
    v_lshl_add_u32 v28, v29, 4, v28
    v_mfma_f32_32x32x16_bf16 v[96:111], a[36:39], v[136:139], v[96:111]
    s_lshl_b32 s30, s18, 17
    s_lshl_b32 s25, s19, 16
    s_add_u32 s30, s30, s25
    s_and_b32 s25, s16, 1
    s_lshl_b32 s25, s25, 1
    s_lshr_b32 s26, s16, 1
    s_waitcnt vmcnt(10)
    v_mfma_f32_32x32x16_bf16 v[112:127], a[88:91], v[140:143], v[112:127]
    s_add_u32 s25, s25, s26
    s_lshl_b32 s26, s20, 2
    s_add_u32 s25, s25, s26
    s_lshl_b32 s25, s25, 5
    s_add_u32 s30, s30, s25
    v_mfma_f32_32x32x16_bf16 v[96:111], a[92:95], v[140:143], v[96:111]
    s_waitcnt vmcnt(9)
    v_mfma_f32_32x32x16_bf16 v[112:127], a[144:147], v[144:147], v[112:127]
    ds_write_b128 v13, v[80:83] offset:0
    ds_write_b128 v13, v[84:87] offset:1024
    v_mfma_f32_32x32x16_bf16 v[96:111], a[148:151], v[144:147], v[96:111]
    ds_write_b128 v15, v[88:91] offset:0
    ds_write_b128 v15, v[92:95] offset:1024
    ds_write_b128 v14, v[72:75] offset:0
    s_waitcnt vmcnt(8)
    v_mfma_f32_32x32x16_bf16 v[112:127], a[200:203], v[148:151], v[112:127]
    ds_write_b128 v14, v[76:79] offset:1024
    v_mfma_f32_32x32x16_bf16 v[96:111], a[204:207], v[148:151], v[96:111]
    s_waitcnt lgkmcnt(0)
    s_barrier
    s_waitcnt vmcnt(7)
    v_mfma_f32_32x32x16_bf16 v[112:127], a[0:3], v[152:155], v[112:127]
    ds_read_b128 v[32:35], v16 offset:0
    ds_read_b128 v[36:39], v16 offset:1024
    ds_read_b128 v[40:43], v16 offset:2048
    ds_read_b128 v[44:47], v16 offset:3072
    ds_read_b128 v[48:51], v16 offset:4096
    v_mfma_f32_32x32x16_bf16 v[96:111], a[4:7], v[152:155], v[96:111]
    ds_read_b128 v[52:55], v16 offset:5120
    s_waitcnt vmcnt(6)
    v_mfma_f32_32x32x16_bf16 v[112:127], a[56:59], v[156:159], v[112:127]
    v_mfma_f32_32x32x16_bf16 v[96:111], a[60:63], v[156:159], v[96:111]
    s_waitcnt vmcnt(5)
    v_mfma_f32_32x32x16_bf16 v[112:127], a[112:115], v[160:163], v[112:127]
    s_waitcnt lgkmcnt(0)
    v_add_f32 v32, v32, v40
    v_add_f32 v33, v33, v41
    v_add_f32 v34, v34, v42
    v_add_f32 v35, v35, v43
    v_mfma_f32_32x32x16_bf16 v[96:111], a[116:119], v[160:163], v[96:111]
    v_add_f32 v36, v36, v44
    v_add_f32 v37, v37, v45
    v_add_f32 v38, v38, v46
    v_add_f32 v39, v39, v47
    v_add_f32 v64, v64, v48
    v_add_f32 v65, v65, v49
    s_waitcnt vmcnt(4)
    v_mfma_f32_32x32x16_bf16 v[112:127], a[168:171], v[164:167], v[112:127]
    v_add_f32 v66, v66, v50
    v_add_f32 v67, v67, v51
    v_add_f32 v68, v68, v52
    v_add_f32 v69, v69, v53
    v_add_f32 v70, v70, v54
    v_mfma_f32_32x32x16_bf16 v[96:111], a[172:175], v[164:167], v[96:111]
    v_add_f32 v71, v71, v55
    v_lshlrev_b32 v40, 16, v20
    v_and_b32 v41, s31, v20
    v_lshlrev_b32 v42, 16, v21
    v_and_b32 v43, s31, v21
    v_lshlrev_b32 v44, 16, v22
    s_waitcnt vmcnt(3)
    v_mfma_f32_32x32x16_bf16 v[112:127], a[8:11], v[168:171], v[112:127]
    v_and_b32 v45, s31, v22
    v_lshlrev_b32 v46, 16, v23
    v_and_b32 v47, s31, v23
    v_add_f32 v64, v64, v32
    v_add_f32 v65, v65, v33
    v_mfma_f32_32x32x16_bf16 v[96:111], a[12:15], v[168:171], v[96:111]
    v_add_f32 v66, v66, v34
    v_add_f32 v67, v67, v35
    v_add_f32 v68, v68, v36
    v_add_f32 v69, v69, v37
    v_add_f32 v70, v70, v38
    v_add_f32 v71, v71, v39
    s_waitcnt vmcnt(2)
    v_mfma_f32_32x32x16_bf16 v[112:127], a[64:67], v[172:175], v[112:127]
    v_fma_f32 v64, v64, s98, v40
    v_fma_f32 v65, v65, s98, v41
    v_fma_f32 v66, v66, s98, v42
    v_fma_f32 v67, v67, s98, v43
    v_fma_f32 v68, v68, s98, v44
    v_mfma_f32_32x32x16_bf16 v[96:111], a[68:71], v[172:175], v[96:111]
    v_fma_f32 v69, v69, s98, v45
    v_fma_f32 v70, v70, s98, v46
    v_fma_f32 v71, v71, s98, v47
    v_cvt_pk_bf16_f32 v32, v64, v65
    v_cvt_pk_bf16_f32 v33, v66, v67
    v_cvt_pk_bf16_f32 v34, v68, v69
    s_waitcnt vmcnt(1)
    v_mfma_f32_32x32x16_bf16 v[112:127], a[120:123], v[176:179], v[112:127]
    s_barrier
    v_cvt_pk_bf16_f32 v35, v70, v71
    v_mfma_f32_32x32x16_bf16 v[96:111], a[124:127], v[176:179], v[96:111]
    s_mov_b32 s46, s30
    buffer_store_dwordx4 v[32:35], v28, s[12:15], s46 offen
    s_waitcnt vmcnt(1)
    v_mfma_f32_32x32x16_bf16 v[96:111], a[180:183], v[180:183], v[96:111]
    v_mfma_f32_32x32x16_bf16 v[112:127], a[176:179], v[180:183], v[112:127]
    s_nop 10
    ds_write_b128 v13, v[96:99] offset:0
    ds_write_b128 v13, v[100:103] offset:1024
    ds_write_b128 v15, v[104:107] offset:0
    ds_write_b128 v15, v[108:111] offset:1024
    ds_write_b128 v14, v[120:123] offset:0
    ds_write_b128 v14, v[124:127] offset:1024
    s_waitcnt lgkmcnt(0)
    s_barrier
    ds_read_b128 v[32:35], v16 offset:0
    ds_read_b128 v[36:39], v16 offset:1024
    ds_read_b128 v[40:43], v16 offset:2048
    ds_read_b128 v[44:47], v16 offset:3072
    ds_read_b128 v[48:51], v16 offset:4096
    ds_read_b128 v[52:55], v16 offset:5120
    s_waitcnt lgkmcnt(0)
    v_pk_add_f32 v[32:33], v[32:33], v[40:41]
    v_pk_add_f32 v[34:35], v[34:35], v[42:43]
    v_pk_add_f32 v[36:37], v[36:37], v[44:45]
    v_pk_add_f32 v[38:39], v[38:39], v[46:47]
    v_pk_add_f32 v[112:113], v[112:113], v[48:49]
    v_pk_add_f32 v[114:115], v[114:115], v[50:51]
    v_pk_add_f32 v[116:117], v[116:117], v[52:53]
    v_pk_add_f32 v[118:119], v[118:119], v[54:55]
    v_pk_add_f32 v[112:113], v[112:113], v[32:33]
    v_pk_add_f32 v[114:115], v[114:115], v[34:35]
    v_pk_add_f32 v[116:117], v[116:117], v[36:37]
    v_pk_add_f32 v[118:119], v[118:119], v[38:39]
    v_pk_fma_f32 v[112:113], v[112:113], s[98:99], v[56:57]
    v_pk_fma_f32 v[114:115], v[114:115], s[98:99], v[58:59]
    v_pk_fma_f32 v[116:117], v[116:117], s[98:99], v[60:61]
    v_pk_fma_f32 v[118:119], v[118:119], s[98:99], v[62:63]
    v_cvt_pk_bf16_f32 v32, v112, v113
    v_cvt_pk_bf16_f32 v33, v114, v115
    v_cvt_pk_bf16_f32 v34, v116, v117
    v_cvt_pk_bf16_f32 v35, v118, v119
    s_add_u32 s46, s30, 32768
    buffer_store_dwordx4 v[32:35], v28, s[12:15], s46 offen
    s_waitcnt vmcnt(0)
L_fin:
L_end:
    s_endpgm
L_s0s:
    s_mov_b32 s49, 0
L_s0l:
    v_cmp_lt_u32 vcc, 7, v24
    s_cmp_gt_u32 s49, 0x2000
    s_cbranch_vccz L_slow
    s_cbranch_scc1 L_s0b
    buffer_load_dwordx4 v[24:27], v30, s[4:7], 0 offen sc1
    s_add_u32 s49, s49, 1
    s_waitcnt vmcnt(0)
    v_xor_b32 v24, s22, v24
    v_xor_b32 v25, s22, v25
    v_xor_b32 v26, s22, v26
    v_xor_b32 v27, s22, v27
    v_or3_b32 v24, v24, v25, v26
    v_or_b32 v24, v24, v27
    v_cmp_ne_u32 vcc, 0, v24
    s_cbranch_vccnz L_s0l
    s_branch L_s0b
L_mks_4:
    s_mov_b32 s49, 0
L_mkl_6:
    v_cmp_eq_u32 vcc, -1, v64
    s_cbranch_vccz L_mkn_7
    buffer_load_dwordx4 v[64:67], v1, s[4:7], s72 offen sc1
L_mkn_7:
    v_cmp_eq_u32 vcc, -1, v68
    s_cbranch_vccz L_mkn_8
    buffer_load_dwordx4 v[68:71], v1, s[4:7], s72 offen offset:1024 sc1
L_mkn_8:
    v_cmp_eq_u32 vcc, -1, v72
    s_cbranch_vccz L_mkn_9
    buffer_load_dwordx4 v[72:75], v1, s[4:7], s72 offen offset:2048 sc1
L_mkn_9:
    v_cmp_eq_u32 vcc, -1, v76
    s_cbranch_vccz L_mkn_10
    buffer_load_dwordx4 v[76:79], v1, s[4:7], s72 offen offset:3072 sc1
L_mkn_10:
    s_add_u32 s49, s49, 1
    s_waitcnt vmcnt(0)
    v_max3_u32 v31, v64, v68, v72
    v_max_u32 v31, v31, v76
    v_cmp_eq_u32 vcc, -1, v31
    s_cmp_gt_u32 s49, 0x2000
    s_cbranch_vccz L_mkb_5
    s_cbranch_scc0 L_mkl_6
    s_branch L_mkb_5
L_afs_11:
    s_mov_b32 s49, 0
L_afl_13:
    buffer_load_dwordx4 v[24:27], v253, s[4:7], 0 offen sc1
    s_add_u32 s49, s49, 1
    s_waitcnt vmcnt(0)
    v_xor_b32 v24, s51, v24
    v_xor_b32 v25, s51, v25
    v_xor_b32 v26, s51, v26
    v_xor_b32 v27, s51, v27
    v_or3_b32 v24, v24, v25, v26
    v_or_b32 v24, v24, v27
    v_cmp_ne_u32 vcc, 0, v24
    s_nop 4
    s_cbranch_vccz L_afb_12
    s_cmp_lt_u32 s49, 8192
    s_cbranch_scc1 L_afl_13
    s_branch L_afb_12
L_qs_14:
    s_mov_b32 s49, 0
    s_mov_b32 s25, 24576
L_ql_16:
    buffer_load_dword v17, v30, s[4:7], s25 offen sc1
    s_add_u32 s49, s49, 1
    s_waitcnt vmcnt(0)
    v_cmp_ne_u32 vcc, s51, v17
    s_nop 4
    s_cbranch_vccz L_qb_15
    s_cmp_lt_u32 s49, 0x2000
    s_cbranch_scc1 L_ql_16
    s_branch L_qb_15
L_mks_17:
    s_mov_b32 s49, 0
L_mkl_19:
    v_cmp_eq_u32 vcc, -1, v136
    s_cbranch_vccz L_mkn_20
    buffer_load_dword v136, v10, s[4:7], s59 offen sc1
L_mkn_20:
    v_cmp_eq_u32 vcc, -1, v137
    s_cbranch_vccz L_mkn_21
    buffer_load_dword v137, v10, s[4:7], s59 offen offset:512 sc1
L_mkn_21:
    v_cmp_eq_u32 vcc, -1, v138
    s_cbranch_vccz L_mkn_22
    buffer_load_dword v138, v10, s[4:7], s59 offen offset:1024 sc1
L_mkn_22:
    v_cmp_eq_u32 vcc, -1, v139
    s_cbranch_vccz L_mkn_23
    buffer_load_dword v139, v10, s[4:7], s59 offen offset:1536 sc1
L_mkn_23:
    v_cmp_eq_u32 vcc, -1, v140
    s_cbranch_vccz L_mkn_24
    buffer_load_dword v140, v10, s[4:7], s24 offen sc1
L_mkn_24:
    v_cmp_eq_u32 vcc, -1, v141
    s_cbranch_vccz L_mkn_25
    buffer_load_dword v141, v10, s[4:7], s24 offen offset:512 sc1
L_mkn_25:
    v_cmp_eq_u32 vcc, -1, v142
    s_cbranch_vccz L_mkn_26
    buffer_load_dword v142, v10, s[4:7], s24 offen offset:1024 sc1
L_mkn_26:
    v_cmp_eq_u32 vcc, -1, v143
    s_cbranch_vccz L_mkn_27
    buffer_load_dword v143, v10, s[4:7], s24 offen offset:1536 sc1
L_mkn_27:
    s_add_u32 s49, s49, 1
    s_waitcnt vmcnt(0)
    v_max3_u32 v31, v136, v137, v138
    v_max3_u32 v31, v31, v139, v140
    v_max3_u32 v31, v31, v141, v142
    v_max_u32 v31, v31, v143
    v_cmp_eq_u32 vcc, -1, v31
    s_cmp_gt_u32 s49, 0x2000
    s_cbranch_vccz L_mkb_18
    s_cbranch_scc0 L_mkl_19
    s_branch L_mkb_18
L_qs_28:
    s_mov_b32 s49, 0
    s_mov_b32 s25, 98304
L_ql_30:
    buffer_load_dword v17, v30, s[4:7], s25 offen sc1
    s_add_u32 s49, s49, 1
    s_waitcnt vmcnt(0)
    v_cmp_ne_u32 vcc, s51, v17
    s_nop 4
    s_cbranch_vccz L_qb_29
    s_cmp_lt_u32 s49, 0x2000
    s_cbranch_scc1 L_ql_30
    s_branch L_qb_29
L_polls_31:
    s_mov_b32 s49, 0
L_polll_33:
    buffer_load_dword v17, v5, s[4:7], s41 offen sc1
    s_add_u32 s49, s49, 1
    s_waitcnt vmcnt(0)
    v_cmp_ne_u32 vcc, s51, v17
    s_nop 4
    s_cbranch_vccz L_pollb_32
    s_cmp_lt_u32 s49, 0x2000
    s_cbranch_scc1 L_polll_33
    s_branch L_pollb_32
L_polls_34:
    s_mov_b32 s49, 0
L_polll_36:
    buffer_load_dword v17, v4, s[4:7], s43 offen sc1
    s_add_u32 s49, s49, 1
    s_waitcnt vmcnt(0)
    v_cmp_ne_u32 vcc, s51, v17
    s_nop 4
    s_cbranch_vccz L_pollb_35
    s_cmp_lt_u32 s49, 0x2000
    s_cbranch_scc1 L_polll_36
    s_branch L_pollb_35
L_polls_37:
    s_mov_b32 s49, 0
L_polll_39:
    buffer_load_dword v17, v4, s[4:7], s43 offen offset:256 sc1
    s_add_u32 s49, s49, 1
    s_waitcnt vmcnt(0)
    v_cmp_ne_u32 vcc, s51, v17
    s_nop 4
    s_cbranch_vccz L_pollb_38
    s_cmp_lt_u32 s49, 0x2000
    s_cbranch_scc1 L_polll_39
    s_branch L_pollb_38
L_polls_40:
    s_mov_b32 s49, 0
L_polll_42:
    buffer_load_dword v17, v4, s[4:7], s43 offen offset:512 sc1
    s_add_u32 s49, s49, 1
    s_waitcnt vmcnt(0)
    v_cmp_ne_u32 vcc, s51, v17
    s_nop 4
    s_cbranch_vccz L_pollb_41
    s_cmp_lt_u32 s49, 0x2000
    s_cbranch_scc1 L_polll_42
    s_branch L_pollb_41
L_mks_43:
    s_mov_b32 s49, 0
L_mkl_45:
    v_cmp_eq_u32 vcc, -1, v128
    s_cbranch_vccz L_mkn_46
    buffer_load_dwordx4 v[128:131], v7, s[4:7], s46 offen sc1
L_mkn_46:
    v_cmp_eq_u32 vcc, -1, v132
    s_cbranch_vccz L_mkn_47
    buffer_load_dwordx4 v[132:135], v7, s[4:7], s47 offen sc1
L_mkn_47:
    s_add_u32 s49, s49, 1
    s_waitcnt vmcnt(0)
    v_max3_u32 v31, v128, v132, v132
    v_cmp_eq_u32 vcc, -1, v31
    s_cmp_gt_u32 s49, 0x2000
    s_cbranch_vccz L_mkb_44
    s_cbranch_scc0 L_mkl_45
    s_branch L_mkb_44
L_polls_48:
    s_mov_b32 s49, 0
L_polll_50:
    buffer_load_dword v17, v5, s[4:7], s41 offen sc1
    s_add_u32 s49, s49, 1
    s_waitcnt vmcnt(0)
    v_cmp_ne_u32 vcc, s51, v17
    s_nop 4
    s_cbranch_vccz L_pollb_49
    s_cmp_lt_u32 s49, 0x2000
    s_cbranch_scc1 L_polll_50
    s_branch L_pollb_49
L_polls_51:
    s_mov_b32 s49, 0
L_polll_53:
    buffer_load_dword v17, v4, s[4:7], s43 offen sc1
    s_add_u32 s49, s49, 1
    s_waitcnt vmcnt(0)
    v_cmp_ne_u32 vcc, s51, v17
    s_nop 4
    s_cbranch_vccz L_pollb_52
    s_cmp_lt_u32 s49, 0x2000
    s_cbranch_scc1 L_polll_53
    s_branch L_pollb_52
L_polls_54:
    s_mov_b32 s49, 0
L_polll_56:
    buffer_load_dword v17, v4, s[4:7], s43 offen offset:256 sc1
    s_add_u32 s49, s49, 1
    s_waitcnt vmcnt(0)
    v_cmp_ne_u32 vcc, s51, v17
    s_nop 4
    s_cbranch_vccz L_pollb_55
    s_cmp_lt_u32 s49, 0x2000
    s_cbranch_scc1 L_polll_56
    s_branch L_pollb_55
L_polls_57:
    s_mov_b32 s49, 0
L_polll_59:
    buffer_load_dword v17, v4, s[4:7], s43 offen offset:512 sc1
    s_add_u32 s49, s49, 1
    s_waitcnt vmcnt(0)
    v_cmp_ne_u32 vcc, s51, v17
    s_nop 4
    s_cbranch_vccz L_pollb_58
    s_cmp_lt_u32 s49, 0x2000
    s_cbranch_scc1 L_polll_59
    s_branch L_pollb_58
L_codeend:
L_slow:
    s_mov_b32 s21, 2
    s_waitcnt vmcnt(0)
    buffer_wbl2 sc1
    s_waitcnt vmcnt(0)
    s_barrier
    s_add_u32 s24, s86, 16384
    buffer_store_dword v18, v250, s[4:7], s24 offen sc1
    s_mov_b32 s25, 8192
    s_mov_b32 s49, 0
L_s0bl:
    buffer_load_dwordx4 v[24:27], v30, s[4:7], s25 offen sc1
    s_add_u32 s49, s49, 1
    s_waitcnt vmcnt(0)
    v_xor_b32 v24, s51, v24
    v_xor_b32 v25, s51, v25
    v_xor_b32 v26, s51, v26
    v_xor_b32 v27, s51, v27
    v_or3_b32 v24, v24, v25, v26
    v_or_b32 v24, v24, v27
    v_cmp_ne_u32 vcc, 0, v24
    s_cmp_gt_u32 s49, 0x2000
    s_cbranch_scc1 L_s0bx
    s_cbranch_vccnz L_s0bl
L_s0bx:
    buffer_inv sc1
    s_waitcnt vmcnt(0)
    ds_write_b16 v61, v60
    s_cmp_ge_u32 s16, 2
    s_cbranch_scc1 L_xp_100001
    buffer_load_dwordx4 v[64:67], v1, s[4:7], s72 offen sc1
    buffer_load_dwordx4 v[68:71], v1, s[4:7], s72 offen offset:1024 sc1
    buffer_load_dwordx4 v[72:75], v1, s[4:7], s72 offen offset:2048 sc1
    buffer_load_dwordx4 v[76:79], v1, s[4:7], s72 offen offset:3072 sc1
    v_mov_b32 v192, 0
    v_mov_b32 v193, 0
    v_mov_b32 v194, 0
    v_mov_b32 v195, 0
    v_mov_b32 v196, 0
    v_mov_b32 v197, 0
    v_mov_b32 v198, 0
    v_mov_b32 v199, 0
    v_mov_b32 v200, 0
    v_mov_b32 v201, 0
    v_mov_b32 v202, 0
    v_mov_b32 v203, 0
    v_mov_b32 v204, 0
    v_mov_b32 v205, 0
    v_mov_b32 v206, 0
    v_mov_b32 v207, 0
    v_mov_b32 v208, 0
    v_mov_b32 v209, 0
    v_mov_b32 v210, 0
    v_mov_b32 v211, 0
    v_mov_b32 v212, 0
    v_mov_b32 v213, 0
    v_mov_b32 v214, 0
    v_mov_b32 v215, 0
    v_mov_b32 v216, 0
    v_mov_b32 v217, 0
    v_mov_b32 v218, 0
    v_mov_b32 v219, 0
    v_mov_b32 v220, 0
    v_mov_b32 v221, 0
    v_mov_b32 v222, 0
    v_mov_b32 v223, 0
    s_waitcnt vmcnt(0)
    v_max3_u32 v31, v64, v68, v72
    v_max_u32 v31, v31, v76
    v_cmp_eq_u32 vcc, -1, v31
    s_cbranch_vccnz L_mks_100003
L_mkb_100004:
    ds_write_b128 v22, v[64:67] offset:0
    ds_write_b128 v22, v[68:71] offset:1024
    ds_write_b128 v22, v[72:75] offset:2048
    ds_write_b128 v22, v[76:79] offset:3072
    v_mov_b32_dpp v96, v68 wave_rol:1 row_mask:0xf bank_mask:0xf
    v_mov_b32_dpp v97, v72 wave_rol:1 row_mask:0xf bank_mask:0xf
    v_mov_b32_dpp v98, v76 wave_rol:1 row_mask:0xf bank_mask:0xf
    v_mov_b32 v99, 0
    v_alignbit_b32 v80, v65, v64, 16
    v_alignbit_b32 v81, v66, v65, 16
    v_alignbit_b32 v82, v67, v66, 16
    v_alignbit_b32 v84, v69, v68, 16
    v_alignbit_b32 v85, v70, v69, 16
    v_alignbit_b32 v86, v71, v70, 16
    v_alignbit_b32 v88, v73, v72, 16
    v_alignbit_b32 v89, v74, v73, 16
    v_alignbit_b32 v90, v75, v74, 16
    v_alignbit_b32 v92, v77, v76, 16
    v_alignbit_b32 v93, v78, v77, 16
    v_alignbit_b32 v94, v79, v78, 16
    v_mov_b32_dpp v96, v64 wave_shl:1 row_mask:0xf bank_mask:0xf
    v_mov_b32_dpp v97, v68 wave_shl:1 row_mask:0xf bank_mask:0xf
    v_mov_b32_dpp v98, v72 wave_shl:1 row_mask:0xf bank_mask:0xf
    v_mov_b32_dpp v99, v76 wave_shl:1 row_mask:0xf bank_mask:0xf
    v_alignbit_b32 v83, v96, v67, 16
    v_alignbit_b32 v87, v97, v71, 16
    v_alignbit_b32 v91, v98, v75, 16
    v_alignbit_b32 v95, v99, v79, 16
    ds_write_b128 v22, v[80:83] offset:4640
    ds_write_b128 v22, v[84:87] offset:5664
    ds_write_b128 v22, v[88:91] offset:6688
    ds_write_b128 v22, v[92:95] offset:7712
    s_branch L_bx_100002
L_xp_100001:
    v_mov_b32 v192, 0
    v_mov_b32 v193, 0
    v_mov_b32 v194, 0
    v_mov_b32 v195, 0
    v_mov_b32 v196, 0
    v_mov_b32 v197, 0
    v_mov_b32 v198, 0
    v_mov_b32 v199, 0
    v_mov_b32 v200, 0
    v_mov_b32 v201, 0
    v_mov_b32 v202, 0
    v_mov_b32 v203, 0
    v_mov_b32 v204, 0
    v_mov_b32 v205, 0
    v_mov_b32 v206, 0
    v_mov_b32 v207, 0
    v_mov_b32 v208, 0
    v_mov_b32 v209, 0
    v_mov_b32 v210, 0
    v_mov_b32 v211, 0
    v_mov_b32 v212, 0
    v_mov_b32 v213, 0
    v_mov_b32 v214, 0
    v_mov_b32 v215, 0
    v_mov_b32 v216, 0
    v_mov_b32 v217, 0
    v_mov_b32 v218, 0
    v_mov_b32 v219, 0
    v_mov_b32 v220, 0
    v_mov_b32 v221, 0
    v_mov_b32 v222, 0
    v_mov_b32 v223, 0
    s_waitcnt vmcnt(7)
    s_waitcnt vmcnt(0)
    buffer_store_dword v18, v230, s[4:7], s67 offen sc1
L_bx_100002:
    s_waitcnt lgkmcnt(0)
    s_barrier
    ds_read_b128 v[128:131], v63 offset:3584
    ds_read_b128 v[64:67], v62 offset:0
    ds_read_b128 v[132:135], v63 offset:3072
    ds_read_b128 v[68:71], v62 offset:512
    ds_read_b128 v[136:139], v63 offset:2560
    ds_read_b128 v[72:75], v62 offset:1024
    ds_read_b128 v[140:143], v63 offset:2048
    ds_read_b128 v[76:79], v62 offset:1536
    ds_read_b128 v[144:147], v63 offset:1536
    ds_read_b128 v[80:83], v62 offset:2048
    ds_read_b128 v[148:151], v63 offset:1024
    ds_read_b128 v[84:87], v62 offset:2560
    ds_read_b128 v[152:155], v63 offset:512
    ds_read_b128 v[88:91], v62 offset:3072
    s_waitcnt lgkmcnt(12)
    v_mfma_f32_16x16x32_bf16 v[192:195], v[64:67], v[128:131], v[192:195]
    ds_read_b128 v[156:159], v63 offset:0
    s_waitcnt lgkmcnt(11)
    v_mfma_f32_16x16x32_bf16 v[196:199], v[64:67], v[132:135], v[196:199]
    ds_read_b128 v[92:95], v62 offset:3584
    v_mfma_f32_16x16x32_bf16 v[196:199], v[68:71], v[128:131], v[196:199]
    ds_read_b128 v[160:163], v63 offset:3648
    s_waitcnt lgkmcnt(11)
    v_mfma_f32_16x16x32_bf16 v[200:203], v[64:67], v[136:139], v[200:203]
    ds_read_b128 v[96:99], v62 offset:64
    v_mfma_f32_16x16x32_bf16 v[200:203], v[68:71], v[132:135], v[200:203]
    ds_read_b128 v[164:167], v63 offset:3136
    v_mfma_f32_16x16x32_bf16 v[200:203], v[72:75], v[128:131], v[200:203]
    ds_read_b128 v[100:103], v62 offset:576
    s_waitcnt lgkmcnt(12)
    v_mfma_f32_16x16x32_bf16 v[204:207], v[64:67], v[140:143], v[204:207]
    ds_read_b128 v[168:171], v63 offset:2624
    v_mfma_f32_16x16x32_bf16 v[204:207], v[68:71], v[136:139], v[204:207]
    ds_read_b128 v[104:107], v62 offset:1088
    v_mfma_f32_16x16x32_bf16 v[204:207], v[72:75], v[132:135], v[204:207]
    v_mfma_f32_16x16x32_bf16 v[204:207], v[76:79], v[128:131], v[204:207]
    s_waitcnt lgkmcnt(12)
    v_mfma_f32_16x16x32_bf16 v[208:211], v[64:67], v[144:147], v[208:211]
    ds_read_b128 v[172:175], v63 offset:2112
    v_mfma_f32_16x16x32_bf16 v[208:211], v[68:71], v[140:143], v[208:211]
    v_mov_b32 v24, -1
    v_mov_b32 v25, -1
    v_mov_b32 v26, -1
    v_mov_b32 v27, -1
    s_add_u32 s24, s58, 262144
    ds_read_b128 v[108:111], v62 offset:1600
    v_mfma_f32_16x16x32_bf16 v[208:211], v[72:75], v[136:139], v[208:211]
    buffer_store_dwordx4 v[24:27], v249, s[4:7], s58 offen sc1
    v_mfma_f32_16x16x32_bf16 v[208:211], v[76:79], v[132:135], v[208:211]
    v_mfma_f32_16x16x32_bf16 v[208:211], v[80:83], v[128:131], v[208:211]
    buffer_store_dwordx4 v[24:27], v249, s[4:7], s24 offen sc1
    s_waitcnt lgkmcnt(12)
    v_mfma_f32_16x16x32_bf16 v[212:215], v[64:67], v[148:151], v[212:215]
    ds_read_b128 v[176:179], v63 offset:1600
    v_mfma_f32_16x16x32_bf16 v[212:215], v[68:71], v[144:147], v[212:215]
    ds_read_b128 v[112:115], v62 offset:2112
    v_mfma_f32_16x16x32_bf16 v[212:215], v[72:75], v[140:143], v[212:215]
    v_mfma_f32_16x16x32_bf16 v[212:215], v[76:79], v[136:139], v[212:215]
    v_mfma_f32_16x16x32_bf16 v[212:215], v[80:83], v[132:135], v[212:215]
    v_mfma_f32_16x16x32_bf16 v[212:215], v[84:87], v[128:131], v[212:215]
    s_waitcnt lgkmcnt(12)
    v_mfma_f32_16x16x32_bf16 v[216:219], v[64:67], v[152:155], v[216:219]
    ds_read_b128 v[180:183], v63 offset:1088
    v_mfma_f32_16x16x32_bf16 v[216:219], v[68:71], v[148:151], v[216:219]
    ds_read_b128 v[116:119], v62 offset:2624
    v_mfma_f32_16x16x32_bf16 v[216:219], v[72:75], v[144:147], v[216:219]
    v_mfma_f32_16x16x32_bf16 v[216:219], v[76:79], v[140:143], v[216:219]
    v_mfma_f32_16x16x32_bf16 v[216:219], v[80:83], v[136:139], v[216:219]
    v_mfma_f32_16x16x32_bf16 v[216:219], v[84:87], v[132:135], v[216:219]
    v_mfma_f32_16x16x32_bf16 v[216:219], v[88:91], v[128:131], v[216:219]
    s_waitcnt lgkmcnt(12)
    v_mfma_f32_16x16x32_bf16 v[220:223], v[64:67], v[156:159], v[220:223]
    ds_read_b128 v[184:187], v63 offset:576
    v_mfma_f32_16x16x32_bf16 v[220:223], v[68:71], v[152:155], v[220:223]
    ds_read_b128 v[120:123], v62 offset:3136
    v_mfma_f32_16x16x32_bf16 v[220:223], v[72:75], v[148:151], v[220:223]
    v_mfma_f32_16x16x32_bf16 v[220:223], v[76:79], v[144:147], v[220:223]
    v_mfma_f32_16x16x32_bf16 v[220:223], v[80:83], v[140:143], v[220:223]
    s_waitcnt lgkmcnt(8)
    ds_read_b128 v[188:191], v63 offset:64
    v_mfma_f32_16x16x32_bf16 v[220:223], v[84:87], v[136:139], v[220:223]
    ds_read_b128 v[124:127], v62 offset:3648
    v_mfma_f32_16x16x32_bf16 v[220:223], v[88:91], v[132:135], v[220:223]
    v_mfma_f32_16x16x32_bf16 v[220:223], v[92:95], v[128:131], v[220:223]
    s_waitcnt lgkmcnt(0)
    v_mfma_f32_16x16x32_bf16 v[192:195], v[96:99], v[160:163], v[192:195]
    ds_read_b128 v[128:131], v63 offset:3712
    v_mfma_f32_16x16x32_bf16 v[196:199], v[96:99], v[164:167], v[196:199]
    v_mfma_f32_16x16x32_bf16 v[196:199], v[100:103], v[160:163], v[196:199]
    ds_read_b128 v[64:67], v62 offset:128
    v_mfma_f32_16x16x32_bf16 v[200:203], v[96:99], v[168:171], v[200:203]
    v_mfma_f32_16x16x32_bf16 v[200:203], v[100:103], v[164:167], v[200:203]
    buffer_load_dwordx4 a[232:235], v9, s[8:11], s87 offen nt
    buffer_load_dwordx4 a[236:239], v9, s[8:11], s87 offen offset:128 nt
    ds_read_b128 v[132:135], v63 offset:3200
    v_mfma_f32_16x16x32_bf16 v[200:203], v[104:107], v[160:163], v[200:203]
    v_mfma_f32_16x16x32_bf16 v[204:207], v[96:99], v[172:175], v[204:207]
    ds_read_b128 v[68:71], v62 offset:640
    v_mfma_f32_16x16x32_bf16 v[204:207], v[100:103], v[168:171], v[204:207]
    v_mfma_f32_16x16x32_bf16 v[204:207], v[104:107], v[164:167], v[204:207]
    ds_read_b128 v[136:139], v63 offset:2688
    v_mfma_f32_16x16x32_bf16 v[204:207], v[108:111], v[160:163], v[204:207]
    v_mfma_f32_16x16x32_bf16 v[208:211], v[96:99], v[176:179], v[208:211]
    ds_read_b128 v[72:75], v62 offset:1152
    v_mfma_f32_16x16x32_bf16 v[208:211], v[100:103], v[172:175], v[208:211]
    v_mfma_f32_16x16x32_bf16 v[208:211], v[104:107], v[168:171], v[208:211]
    ds_read_b128 v[140:143], v63 offset:2176
    v_mfma_f32_16x16x32_bf16 v[208:211], v[108:111], v[164:167], v[208:211]
    v_mfma_f32_16x16x32_bf16 v[208:211], v[112:115], v[160:163], v[208:211]
    ds_read_b128 v[76:79], v62 offset:1664
    v_mfma_f32_16x16x32_bf16 v[212:215], v[96:99], v[180:183], v[212:215]
    v_mfma_f32_16x16x32_bf16 v[212:215], v[100:103], v[176:179], v[212:215]
    ds_read_b128 v[144:147], v63 offset:1664
    v_mfma_f32_16x16x32_bf16 v[212:215], v[104:107], v[172:175], v[212:215]
    v_mfma_f32_16x16x32_bf16 v[212:215], v[108:111], v[168:171], v[212:215]
    ds_read_b128 v[80:83], v62 offset:2176
    v_mfma_f32_16x16x32_bf16 v[212:215], v[112:115], v[164:167], v[212:215]
    v_mfma_f32_16x16x32_bf16 v[212:215], v[116:119], v[160:163], v[212:215]
    ds_read_b128 v[148:151], v63 offset:1152
    v_mfma_f32_16x16x32_bf16 v[216:219], v[96:99], v[184:187], v[216:219]
    v_mfma_f32_16x16x32_bf16 v[216:219], v[100:103], v[180:183], v[216:219]
    ds_read_b128 v[84:87], v62 offset:2688
    v_mfma_f32_16x16x32_bf16 v[216:219], v[104:107], v[176:179], v[216:219]
    v_mfma_f32_16x16x32_bf16 v[216:219], v[108:111], v[172:175], v[216:219]
    ds_read_b128 v[152:155], v63 offset:640
    v_mfma_f32_16x16x32_bf16 v[216:219], v[112:115], v[168:171], v[216:219]
    v_mfma_f32_16x16x32_bf16 v[216:219], v[116:119], v[164:167], v[216:219]
    ds_read_b128 v[88:91], v62 offset:3200
    v_mfma_f32_16x16x32_bf16 v[216:219], v[120:123], v[160:163], v[216:219]
    v_mfma_f32_16x16x32_bf16 v[220:223], v[96:99], v[188:191], v[220:223]
    ds_read_b128 v[156:159], v63 offset:128
    v_mfma_f32_16x16x32_bf16 v[220:223], v[100:103], v[184:187], v[220:223]
    v_mfma_f32_16x16x32_bf16 v[220:223], v[104:107], v[180:183], v[220:223]
    ds_read_b128 v[92:95], v62 offset:3712
    v_mfma_f32_16x16x32_bf16 v[220:223], v[108:111], v[176:179], v[220:223]
    v_mfma_f32_16x16x32_bf16 v[220:223], v[112:115], v[172:175], v[220:223]
    v_mfma_f32_16x16x32_bf16 v[220:223], v[116:119], v[168:171], v[220:223]
    v_mfma_f32_16x16x32_bf16 v[220:223], v[120:123], v[164:167], v[220:223]
    v_mfma_f32_16x16x32_bf16 v[220:223], v[124:127], v[160:163], v[220:223]
    s_waitcnt lgkmcnt(0)
    v_mfma_f32_16x16x32_bf16 v[192:195], v[64:67], v[128:131], v[192:195]
    buffer_store_dwordx4 a[0:3], v228, s[4:7], s65 offen sc1
    ds_read_b128 v[160:163], v63 offset:3776
    v_mfma_f32_16x16x32_bf16 v[196:199], v[64:67], v[132:135], v[196:199]
    v_mfma_f32_16x16x32_bf16 v[196:199], v[68:71], v[128:131], v[196:199]
    s_add_u32 s65, s65, 229376
    buffer_store_dwordx4 a[4:7], v228, s[4:7], s65 offen sc1
    ds_read_b128 v[96:99], v62 offset:192
    v_mfma_f32_16x16x32_bf16 v[200:203], v[64:67], v[136:139], v[200:203]
    v_mfma_f32_16x16x32_bf16 v[200:203], v[68:71], v[132:135], v[200:203]
    s_add_u32 s65, s65, 229376
    buffer_store_dwordx4 a[8:11], v228, s[4:7], s65 offen sc1
    ds_read_b128 v[164:167], v63 offset:3264
    v_mfma_f32_16x16x32_bf16 v[200:203], v[72:75], v[128:131], v[200:203]
    v_mfma_f32_16x16x32_bf16 v[204:207], v[64:67], v[140:143], v[204:207]
    s_add_u32 s65, s65, 229376
    buffer_store_dwordx4 a[12:15], v228, s[4:7], s65 offen sc1
    ds_read_b128 v[100:103], v62 offset:704
    v_mfma_f32_16x16x32_bf16 v[204:207], v[68:71], v[136:139], v[204:207]
    v_mfma_f32_16x16x32_bf16 v[204:207], v[72:75], v[132:135], v[204:207]
    ds_read_b128 v[168:171], v63 offset:2752
    v_mfma_f32_16x16x32_bf16 v[204:207], v[76:79], v[128:131], v[204:207]
    v_mfma_f32_16x16x32_bf16 v[208:211], v[64:67], v[144:147], v[208:211]
    ds_read_b128 v[104:107], v62 offset:1216
    v_mfma_f32_16x16x32_bf16 v[208:211], v[68:71], v[140:143], v[208:211]
    v_mfma_f32_16x16x32_bf16 v[208:211], v[72:75], v[136:139], v[208:211]
    ds_read_b128 v[172:175], v63 offset:2240
    v_mfma_f32_16x16x32_bf16 v[208:211], v[76:79], v[132:135], v[208:211]
    v_mfma_f32_16x16x32_bf16 v[208:211], v[80:83], v[128:131], v[208:211]
    ds_read_b128 v[108:111], v62 offset:1728
    v_mfma_f32_16x16x32_bf16 v[212:215], v[64:67], v[148:151], v[212:215]
    v_mfma_f32_16x16x32_bf16 v[212:215], v[68:71], v[144:147], v[212:215]
    ds_read_b128 v[176:179], v63 offset:1728
    v_mfma_f32_16x16x32_bf16 v[212:215], v[72:75], v[140:143], v[212:215]
    v_mfma_f32_16x16x32_bf16 v[212:215], v[76:79], v[136:139], v[212:215]
    ds_read_b128 v[112:115], v62 offset:2240
    v_mfma_f32_16x16x32_bf16 v[212:215], v[80:83], v[132:135], v[212:215]
    v_mfma_f32_16x16x32_bf16 v[212:215], v[84:87], v[128:131], v[212:215]
    ds_read_b128 v[180:183], v63 offset:1216
    v_mfma_f32_16x16x32_bf16 v[216:219], v[64:67], v[152:155], v[216:219]
    v_mfma_f32_16x16x32_bf16 v[216:219], v[68:71], v[148:151], v[216:219]
    ds_read_b128 v[116:119], v62 offset:2752
    v_mfma_f32_16x16x32_bf16 v[216:219], v[72:75], v[144:147], v[216:219]
    v_mfma_f32_16x16x32_bf16 v[216:219], v[76:79], v[140:143], v[216:219]
    ds_read_b128 v[184:187], v63 offset:704
    v_mfma_f32_16x16x32_bf16 v[216:219], v[80:83], v[136:139], v[216:219]
    v_mfma_f32_16x16x32_bf16 v[216:219], v[84:87], v[132:135], v[216:219]
    ds_read_b128 v[120:123], v62 offset:3264
    v_mfma_f32_16x16x32_bf16 v[216:219], v[88:91], v[128:131], v[216:219]
    v_mfma_f32_16x16x32_bf16 v[220:223], v[64:67], v[156:159], v[220:223]
    ds_read_b128 v[188:191], v63 offset:192
    v_mfma_f32_16x16x32_bf16 v[220:223], v[68:71], v[152:155], v[220:223]
    v_mfma_f32_16x16x32_bf16 v[220:223], v[72:75], v[148:151], v[220:223]
    ds_read_b128 v[124:127], v62 offset:3776
    v_mfma_f32_16x16x32_bf16 v[220:223], v[76:79], v[144:147], v[220:223]
    v_mfma_f32_16x16x32_bf16 v[220:223], v[80:83], v[140:143], v[220:223]
    v_mfma_f32_16x16x32_bf16 v[220:223], v[84:87], v[136:139], v[220:223]
    v_mfma_f32_16x16x32_bf16 v[220:223], v[88:91], v[132:135], v[220:223]
    v_mfma_f32_16x16x32_bf16 v[220:223], v[92:95], v[128:131], v[220:223]
    s_waitcnt lgkmcnt(0)
    v_mfma_f32_16x16x32_bf16 v[192:195], v[96:99], v[160:163], v[192:195]
    v_mfma_f32_16x16x32_bf16 v[196:199], v[96:99], v[164:167], v[196:199]
    v_mfma_f32_16x16x32_bf16 v[196:199], v[100:103], v[160:163], v[196:199]
    buffer_load_dwordx4 v[24:27], v253, s[4:7], 0 offen sc1
    v_mfma_f32_16x16x32_bf16 v[200:203], v[96:99], v[168:171], v[200:203]
    v_mfma_f32_16x16x32_bf16 v[200:203], v[100:103], v[164:167], v[200:203]
    v_mfma_f32_16x16x32_bf16 v[200:203], v[104:107], v[160:163], v[200:203]
    v_mfma_f32_16x16x32_bf16 v[204:207], v[96:99], v[172:175], v[204:207]
    v_mfma_f32_16x16x32_bf16 v[204:207], v[100:103], v[168:171], v[204:207]
    v_mfma_f32_16x16x32_bf16 v[204:207], v[104:107], v[164:167], v[204:207]
    v_mfma_f32_16x16x32_bf16 v[204:207], v[108:111], v[160:163], v[204:207]
    v_mfma_f32_16x16x32_bf16 v[208:211], v[96:99], v[176:179], v[208:211]
    v_mfma_f32_16x16x32_bf16 v[208:211], v[100:103], v[172:175], v[208:211]
    v_mfma_f32_16x16x32_bf16 v[208:211], v[104:107], v[168:171], v[208:211]
    v_mfma_f32_16x16x32_bf16 v[208:211], v[108:111], v[164:167], v[208:211]
    v_mfma_f32_16x16x32_bf16 v[208:211], v[112:115], v[160:163], v[208:211]
    v_mfma_f32_16x16x32_bf16 v[212:215], v[96:99], v[180:183], v[212:215]
    v_mfma_f32_16x16x32_bf16 v[212:215], v[100:103], v[176:179], v[212:215]
    v_mfma_f32_16x16x32_bf16 v[212:215], v[104:107], v[172:175], v[212:215]
    v_mfma_f32_16x16x32_bf16 v[212:215], v[108:111], v[168:171], v[212:215]
    v_mfma_f32_16x16x32_bf16 v[212:215], v[112:115], v[164:167], v[212:215]
    v_mfma_f32_16x16x32_bf16 v[212:215], v[116:119], v[160:163], v[212:215]
    v_mfma_f32_16x16x32_bf16 v[216:219], v[96:99], v[184:187], v[216:219]
    v_mfma_f32_16x16x32_bf16 v[216:219], v[100:103], v[180:183], v[216:219]
    v_mfma_f32_16x16x32_bf16 v[216:219], v[104:107], v[176:179], v[216:219]
    v_mfma_f32_16x16x32_bf16 v[216:219], v[108:111], v[172:175], v[216:219]
    v_mfma_f32_16x16x32_bf16 v[216:219], v[112:115], v[168:171], v[216:219]
    v_mfma_f32_16x16x32_bf16 v[216:219], v[116:119], v[164:167], v[216:219]
    v_mfma_f32_16x16x32_bf16 v[216:219], v[120:123], v[160:163], v[216:219]
    v_mfma_f32_16x16x32_bf16 v[220:223], v[96:99], v[188:191], v[220:223]
    v_mfma_f32_16x16x32_bf16 v[220:223], v[100:103], v[184:187], v[220:223]
    v_mfma_f32_16x16x32_bf16 v[220:223], v[104:107], v[180:183], v[220:223]
    v_mfma_f32_16x16x32_bf16 v[220:223], v[108:111], v[176:179], v[220:223]
    v_mfma_f32_16x16x32_bf16 v[220:223], v[112:115], v[172:175], v[220:223]
    v_mfma_f32_16x16x32_bf16 v[220:223], v[116:119], v[168:171], v[220:223]
    v_mfma_f32_16x16x32_bf16 v[220:223], v[120:123], v[164:167], v[220:223]
    v_mfma_f32_16x16x32_bf16 v[220:223], v[124:127], v[160:163], v[220:223]
    s_waitcnt vmcnt(7)
    s_barrier
    s_add_u32 s24, s86, 24576
    buffer_store_dword v18, v250, s[4:7], s24 offen sc1
    v_add_u32 v20, s23, v1
    s_lshl_b32 s24, s16, 11
    v_add_u32 v21, s24, v1
    s_nop 4
    ds_write_b128 v20, v[192:195] offset:0
    ds_write_b128 v20, v[196:199] offset:1024
    ds_write_b128 v20, v[200:203] offset:2048
    ds_write_b128 v20, v[204:207] offset:3072
    ds_write_b128 v20, v[208:211] offset:4096
    ds_write_b128 v20, v[212:215] offset:5120
    ds_write_b128 v20, v[216:219] offset:6144
    ds_write_b128 v20, v[220:223] offset:7168
    s_waitcnt lgkmcnt(0)
    s_waitcnt vmcnt(2)
    s_waitcnt vmcnt(1)
    v_xor_b32 v24, s51, v24
    v_xor_b32 v25, s51, v25
    v_xor_b32 v26, s51, v26
    v_xor_b32 v27, s51, v27
    v_or3_b32 v24, v24, v25, v26
    v_or_b32 v24, v24, v27
    v_cmp_ne_u32 vcc, 0, v24
    s_cbranch_vccnz L_afs_100010
L_afb_100011:
    s_barrier
    s_add_u32 s24, s86, 98304
    buffer_store_dword v18, v250, s[4:7], s24 offen sc1
    s_add_u32 m0, s23, 65536
    s_mov_b32 s50, s39
    buffer_load_dwordx4 v1, s[4:7], s50 offen lds
    buffer_load_dwordx4 v1, s[4:7], s50 offen offset:1024 lds
    buffer_load_dwordx4 v1, s[4:7], s50 offen offset:2048 lds
    buffer_load_dwordx4 v1, s[4:7], s50 offen offset:3072 lds
    s_add_u32 m0, s23, 69632
    s_add_u32 s50, s39, 4096
    buffer_load_dwordx4 v1, s[4:7], s50 offen lds
    buffer_load_dwordx4 v1, s[4:7], s50 offen offset:1024 lds
    buffer_load_dwordx4 v1, s[4:7], s50 offen offset:2048 lds
    buffer_load_dwordx4 v1, s[4:7], s50 offen offset:3072 lds
    ds_read_b128 v[64:67], v21 offset:0
    ds_read_b128 v[68:71], v21 offset:8192
    ds_read_b128 v[72:75], v21 offset:16384
    ds_read_b128 v[76:79], v21 offset:24576
    ds_read_b128 v[128:131], v248 offset:512
    ds_read_b128 v[132:135], v248 offset:9984
    ds_read_b128 v[96:99], v21 offset:1024
    ds_read_b128 v[100:103], v21 offset:9216
    ds_read_b128 v[104:107], v21 offset:17408
    ds_read_b128 v[108:111], v21 offset:25600
    ds_read_b128 v[136:139], v248 offset:0
    ds_read_b128 v[140:143], v248 offset:9472
    s_waitcnt lgkmcnt(6)
    v_add_f32 v64, v64, v68
    v_add_f32 v65, v65, v69
    v_add_f32 v66, v66, v70
    v_add_f32 v67, v67, v71
    v_lshlrev_b32 v128, 16, v128
    v_lshlrev_b32 v129, 16, v129
    v_lshlrev_b32 v130, 16, v130
    v_lshlrev_b32 v131, 16, v131
    v_fmac_f32 v64, s60, v131
    v_fmac_f32 v65, s60, v130
    v_fmac_f32 v66, s60, v129
    v_fmac_f32 v67, s60, v128
    v_add_f32 v72, v72, v76
    v_add_f32 v73, v73, v77
    v_add_f32 v74, v74, v78
    v_add_f32 v75, v75, v79
    v_lshlrev_b32 v132, 16, v132
    v_lshlrev_b32 v133, 16, v133
    v_lshlrev_b32 v134, 16, v134
    v_lshlrev_b32 v135, 16, v135
    v_fmac_f32 v72, s61, v135
    v_fmac_f32 v73, s61, v134
    v_fmac_f32 v74, s61, v133
    v_fmac_f32 v75, s61, v132
    v_cvt_pk_bf16_f32 v148, v64, v72
    v_cvt_pk_bf16_f32 v149, v65, v73
    v_cvt_pk_bf16_f32 v150, v66, v74
    v_cvt_pk_bf16_f32 v151, v67, v75
    v_mov_b32 v152, v150
    v_mov_b32 v153, v148
    v_mov_b32 v154, v151
    v_mov_b32 v155, v149
    v_mov_b32_dpp v152, v148 row_ror:8 row_mask:0xf bank_mask:0x3
    v_mov_b32_dpp v153, v150 row_ror:8 row_mask:0xf bank_mask:0xc
    v_mov_b32_dpp v154, v149 row_ror:8 row_mask:0xf bank_mask:0x3
    v_mov_b32_dpp v155, v151 row_ror:8 row_mask:0xf bank_mask:0xc
    buffer_store_dwordx4 v[152:155], v249, s[4:7], s58 offen sc1
    s_waitcnt lgkmcnt(0)
    v_add_f32 v96, v96, v100
    v_add_f32 v97, v97, v101
    v_add_f32 v98, v98, v102
    v_add_f32 v99, v99, v103
    v_lshlrev_b32 v136, 16, v136
    v_lshlrev_b32 v137, 16, v137
    v_lshlrev_b32 v138, 16, v138
    v_lshlrev_b32 v139, 16, v139
    v_fmac_f32 v96, s60, v139
    v_fmac_f32 v97, s60, v138
    v_fmac_f32 v98, s60, v137
    v_fmac_f32 v99, s60, v136
    v_add_f32 v104, v104, v108
    v_add_f32 v105, v105, v109
    v_add_f32 v106, v106, v110
    v_add_f32 v107, v107, v111
    v_lshlrev_b32 v140, 16, v140
    v_lshlrev_b32 v141, 16, v141
    v_lshlrev_b32 v142, 16, v142
    v_lshlrev_b32 v143, 16, v143
    v_fmac_f32 v104, s61, v143
    v_fmac_f32 v105, s61, v142
    v_fmac_f32 v106, s61, v141
    v_fmac_f32 v107, s61, v140
    v_cvt_pk_bf16_f32 v148, v96, v104
    v_cvt_pk_bf16_f32 v149, v97, v105
    v_cvt_pk_bf16_f32 v150, v98, v106
    v_cvt_pk_bf16_f32 v151, v99, v107
    v_mov_b32 v156, v150
    v_mov_b32 v157, v148
    v_mov_b32 v158, v151
    v_mov_b32 v159, v149
    v_mov_b32_dpp v156, v148 row_ror:8 row_mask:0xf bank_mask:0x3
    v_mov_b32_dpp v157, v150 row_ror:8 row_mask:0xf bank_mask:0xc
    v_mov_b32_dpp v158, v149 row_ror:8 row_mask:0xf bank_mask:0x3
    v_mov_b32_dpp v159, v151 row_ror:8 row_mask:0xf bank_mask:0xc
    s_add_u32 s58, s58, 262144
    buffer_store_dwordx4 v[156:159], v249, s[4:7], s58 offen sc1
    s_add_u32 s24, s59, 16384
    s_add_u32 m0, s23, 98304
    s_add_u32 s50, s39, 32768
    buffer_load_dwordx4 v1, s[4:7], s50 offen lds
    buffer_load_dwordx4 v1, s[4:7], s50 offen offset:1024 lds
    buffer_load_dwordx4 v1, s[4:7], s50 offen offset:2048 lds
    buffer_load_dwordx4 v1, s[4:7], s50 offen offset:3072 lds
    s_add_u32 m0, s23, 102400
    s_add_u32 s50, s39, 36864
    buffer_load_dwordx4 v1, s[4:7], s50 offen lds
    buffer_load_dwordx4 v1, s[4:7], s50 offen offset:1024 lds
    buffer_load_dwordx4 v1, s[4:7], s50 offen offset:2048 lds
    buffer_load_dwordx4 v1, s[4:7], s50 offen offset:3072 lds
    v_lshrrev_b32 v30, 2, v8
    v_lshlrev_b32 v30, 7, v30
    v_and_b32 v31, 3, v8
    v_lshl_add_u32 v30, v31, 2, v30
    s_lshl_b32 s25, s16, 11
    v_add_u32 v30, s25, v30
    s_mov_b32 s25, 24576
    buffer_load_dword v17, v30, s[4:7], s25 offen sc1
    s_add_u32 m0, s23, 131072
    s_add_u32 s50, s39, 65536
    buffer_load_dwordx4 v1, s[4:7], s50 offen lds
    buffer_load_dwordx4 v1, s[4:7], s50 offen offset:1024 lds
    buffer_load_dwordx4 v1, s[4:7], s50 offen offset:2048 lds
    buffer_load_dwordx4 v1, s[4:7], s50 offen offset:3072 lds
    v_accvgpr_read_b32 v128, a232
    v_accvgpr_read_b32 v129, a233
    v_accvgpr_read_b32 v130, a234
    v_accvgpr_read_b32 v131, a235
    v_accvgpr_read_b32 v132, a236
    v_accvgpr_read_b32 v133, a237
    v_accvgpr_read_b32 v134, a238
    v_accvgpr_read_b32 v135, a239
    v_lshlrev_b32 v144, 16, v128
    v_and_b32 v145, s31, v128
    v_lshlrev_b32 v146, 16, v129
    v_and_b32 v147, s31, v129
    v_lshlrev_b32 v148, 16, v130
    v_and_b32 v149, s31, v130
    v_lshlrev_b32 v150, 16, v131
    v_and_b32 v151, s31, v131
    v_lshlrev_b32 v152, 16, v132
    v_and_b32 v153, s31, v132
    v_lshlrev_b32 v154, 16, v133
    v_and_b32 v155, s31, v133
    v_lshlrev_b32 v156, 16, v134
    v_and_b32 v157, s31, v134
    v_lshlrev_b32 v158, 16, v135
    v_and_b32 v159, s31, v135
    v_pk_add_f32 v[192:193], v[144:145], v[146:147]
    v_pk_mul_f32 v[194:195], v[144:145], v[144:145]
    v_pk_fma_f32 v[194:195], v[146:147], v[146:147], v[194:195]
    v_pk_fma_f32 v[194:195], v[148:149], v[148:149], v[194:195]
    v_pk_add_f32 v[192:193], v[192:193], v[148:149]
    v_pk_fma_f32 v[194:195], v[150:151], v[150:151], v[194:195]
    v_pk_add_f32 v[192:193], v[192:193], v[150:151]
    v_pk_fma_f32 v[194:195], v[152:153], v[152:153], v[194:195]
    v_pk_add_f32 v[192:193], v[192:193], v[152:153]
    v_pk_fma_f32 v[194:195], v[154:155], v[154:155], v[194:195]
    v_pk_add_f32 v[192:193], v[192:193], v[154:155]
    v_pk_fma_f32 v[194:195], v[156:157], v[156:157], v[194:195]
    v_pk_add_f32 v[192:193], v[192:193], v[156:157]
    v_pk_fma_f32 v[194:195], v[158:159], v[158:159], v[194:195]
    v_pk_add_f32 v[192:193], v[192:193], v[158:159]
    v_add_f32 v192, v192, v193
    v_add_f32 v194, v194, v195
    s_nop 1
    v_permlane16_swap_b32 v192, v194
    v_add_f32 v192, v192, v194
    s_nop 1
    v_add_f32_dpp v192, v192, v192 row_ror:8 row_mask:0xf bank_mask:0xf
    v_mov_b32 v193, v192
    s_nop 1
    v_permlane32_swap_b32 v192, v193
    v_add_f32 v192, v192, v193
    s_mov_b64 exec, 0x00ff00ff
    ds_write_b32 v11, v192 offset:0
    s_mov_b64 exec, -1
    s_waitcnt lgkmcnt(0)
    s_waitcnt vmcnt(4)
    v_cmp_ne_u32 vcc, s51, v17
    s_cbranch_vccnz L_qs_100013
L_qb_100014:
    s_barrier
    ds_read_b128 v[196:199], v12 offset:0
    ds_read_b128 v[200:203], v12 offset:16
    buffer_load_dword v136, v10, s[4:7], s59 offen sc1
    buffer_load_dword v137, v10, s[4:7], s59 offen offset:512 sc1
    buffer_load_dword v138, v10, s[4:7], s59 offen offset:1024 sc1
    buffer_load_dword v139, v10, s[4:7], s59 offen offset:1536 sc1
    buffer_load_dword v140, v10, s[4:7], s24 offen sc1
    buffer_load_dword v141, v10, s[4:7], s24 offen offset:512 sc1
    buffer_load_dword v142, v10, s[4:7], s24 offen offset:1024 sc1
    buffer_load_dword v143, v10, s[4:7], s24 offen offset:1536 sc1
    s_mov_b32 s25, 98304
    buffer_load_dword v17, v30, s[4:7], s25 offen sc1
    s_add_u32 m0, s23, 135168
    s_add_u32 s50, s39, 69632
    buffer_load_dwordx4 v1, s[4:7], s50 offen lds
    buffer_load_dwordx4 v1, s[4:7], s50 offen offset:1024 lds
    buffer_load_dwordx4 v1, s[4:7], s50 offen offset:2048 lds
    buffer_load_dwordx4 v1, s[4:7], s50 offen offset:3072 lds
    s_waitcnt lgkmcnt(0)
    v_pk_add_f32 v[196:197], v[196:197], v[198:199]
    v_pk_add_f32 v[200:201], v[200:201], v[202:203]
    v_pk_add_f32 v[196:197], v[196:197], v[200:201]
    v_mul_f32 v196, 0x3b000000, v196
    v_mul_f32 v197, 0x3b000000, v197
    v_fma_f32 v197, -v196, v196, v197
    v_max_f32 v197, 0, v197
    v_add_f32 v197, 0x3727c5ac, v197
    v_rsq_f32 v204, v197
    s_nop 0
    v_mul_f32_e64 v206, -v196, v204
    v_pk_fma_f32 v[176:177], v[144:145], v[204:205], v[206:207] op_sel_hi:[1,0,0]
    v_pk_fma_f32 v[178:179], v[146:147], v[204:205], v[206:207] op_sel_hi:[1,0,0]
    v_pk_fma_f32 v[180:181], v[148:149], v[204:205], v[206:207] op_sel_hi:[1,0,0]
    v_pk_fma_f32 v[182:183], v[150:151], v[204:205], v[206:207] op_sel_hi:[1,0,0]
    v_pk_fma_f32 v[184:185], v[152:153], v[204:205], v[206:207] op_sel_hi:[1,0,0]
    v_pk_fma_f32 v[186:187], v[154:155], v[204:205], v[206:207] op_sel_hi:[1,0,0]
    v_pk_fma_f32 v[188:189], v[156:157], v[204:205], v[206:207] op_sel_hi:[1,0,0]
    v_pk_fma_f32 v[190:191], v[158:159], v[204:205], v[206:207] op_sel_hi:[1,0,0]
    s_add_u32 m0, s23, 0
    s_add_u32 s50, s39, 98304
    buffer_load_dwordx4 v1, s[4:7], s50 offen lds
    buffer_load_dwordx4 v1, s[4:7], s50 offen offset:1024 lds
    buffer_load_dwordx4 v1, s[4:7], s50 offen offset:2048 lds
    buffer_load_dwordx4 v1, s[4:7], s50 offen offset:3072 lds
    s_add_u32 m0, s23, 4096
    s_add_u32 s50, s39, 102400
    buffer_load_dwordx4 v1, s[4:7], s50 offen lds
    buffer_load_dwordx4 v1, s[4:7], s50 offen offset:1024 lds
    buffer_load_dwordx4 v1, s[4:7], s50 offen offset:2048 lds
    buffer_load_dwordx4 v1, s[4:7], s50 offen offset:3072 lds
    s_waitcnt vmcnt(13)
    v_max3_u32 v31, v136, v137, v138
    v_max3_u32 v31, v31, v139, v140
    v_max3_u32 v31, v31, v141, v142
    v_max_u32 v31, v31, v143
    v_cmp_eq_u32 vcc, -1, v31
    s_cbranch_vccnz L_mks_100016
L_mkb_100017:
    v_accvgpr_write_b32 a224, v136
    v_accvgpr_write_b32 a225, v137
    v_accvgpr_write_b32 a226, v138
    v_accvgpr_write_b32 a227, v139
    v_accvgpr_write_b32 a228, v140
    v_accvgpr_write_b32 a229, v141
    v_accvgpr_write_b32 a230, v142
    v_accvgpr_write_b32 a231, v143
    v_lshlrev_b32 v160, 16, v136
    v_and_b32 v161, s31, v136
    v_lshlrev_b32 v162, 16, v137
    v_and_b32 v163, s31, v137
    v_lshlrev_b32 v164, 16, v138
    v_and_b32 v165, s31, v138
    v_lshlrev_b32 v166, 16, v139
    v_and_b32 v167, s31, v139
    v_lshlrev_b32 v168, 16, v140
    v_and_b32 v169, s31, v140
    v_lshlrev_b32 v170, 16, v141
    v_and_b32 v171, s31, v141
    v_lshlrev_b32 v172, 16, v142
    v_and_b32 v173, s31, v142
    v_lshlrev_b32 v174, 16, v143
    v_and_b32 v175, s31, v143
    v_pk_fma_f32 v[144:145], v[176:177], v[160:161], v[144:145]
    v_pk_fma_f32 v[146:147], v[178:179], v[162:163], v[146:147]
    v_pk_fma_f32 v[148:149], v[180:181], v[164:165], v[148:149]
    v_pk_fma_f32 v[150:151], v[182:183], v[166:167], v[150:151]
    v_pk_fma_f32 v[152:153], v[184:185], v[168:169], v[152:153]
    v_pk_fma_f32 v[154:155], v[186:187], v[170:171], v[154:155]
    v_pk_fma_f32 v[156:157], v[188:189], v[172:173], v[156:157]
    v_pk_fma_f32 v[158:159], v[190:191], v[174:175], v[158:159]
    v_pk_add_f32 v[192:193], v[144:145], v[146:147]
    v_pk_mul_f32 v[194:195], v[144:145], v[144:145]
    v_pk_fma_f32 v[194:195], v[146:147], v[146:147], v[194:195]
    v_pk_fma_f32 v[194:195], v[148:149], v[148:149], v[194:195]
    v_pk_add_f32 v[192:193], v[192:193], v[148:149]
    v_pk_fma_f32 v[194:195], v[150:151], v[150:151], v[194:195]
    v_pk_add_f32 v[192:193], v[192:193], v[150:151]
    v_pk_fma_f32 v[194:195], v[152:153], v[152:153], v[194:195]
    v_pk_add_f32 v[192:193], v[192:193], v[152:153]
    v_pk_fma_f32 v[194:195], v[154:155], v[154:155], v[194:195]
    v_pk_add_f32 v[192:193], v[192:193], v[154:155]
    v_pk_fma_f32 v[194:195], v[156:157], v[156:157], v[194:195]
    v_pk_add_f32 v[192:193], v[192:193], v[156:157]
    v_pk_fma_f32 v[194:195], v[158:159], v[158:159], v[194:195]
    v_pk_add_f32 v[192:193], v[192:193], v[158:159]
    v_add_f32 v192, v192, v193
    v_add_f32 v194, v194, v195
    s_nop 1
    v_permlane16_swap_b32 v192, v194
    v_add_f32 v192, v192, v194
    s_nop 1
    v_add_f32_dpp v192, v192, v192 row_ror:8 row_mask:0xf bank_mask:0xf
    v_mov_b32 v193, v192
    s_nop 1
    v_permlane32_swap_b32 v192, v193
    v_add_f32 v192, v192, v193
    s_mov_b64 exec, 0x00ff00ff
    ds_write_b32 v11, v192 offset:256
    s_mov_b64 exec, -1
    s_waitcnt lgkmcnt(0)
    s_waitcnt vmcnt(12)
    v_cmp_ne_u32 vcc, s51, v17
    s_cbranch_vccnz L_qs_100027
L_qb_100028:
    s_barrier
    ds_read_b128 v[196:199], v12 offset:256
    ds_read_b128 v[200:203], v12 offset:272
    buffer_store_dword v18, v254, s[4:7], 0 offen sc1
    s_waitcnt lgkmcnt(0)
    v_pk_add_f32 v[196:197], v[196:197], v[198:199]
    v_pk_add_f32 v[200:201], v[200:201], v[202:203]
    v_pk_add_f32 v[196:197], v[196:197], v[200:201]
    v_mul_f32 v196, 0x3b000000, v196
    v_mul_f32 v197, 0x3b000000, v197
    v_fma_f32 v197, -v196, v196, v197
    v_max_f32 v197, 0, v197
    v_add_f32 v197, 0x3727c5ac, v197
    v_rsq_f32 v204, v197
    s_nop 0
    v_mul_f32 v204, 0x3fb8aa3b, v204
    v_mul_f32_e64 v206, -v196, v204
    v_pk_fma_f32 v[176:177], v[144:145], v[204:205], v[206:207] op_sel_hi:[1,0,0]
    v_pk_fma_f32 v[178:179], v[146:147], v[204:205], v[206:207] op_sel_hi:[1,0,0]
    v_pk_fma_f32 v[180:181], v[148:149], v[204:205], v[206:207] op_sel_hi:[1,0,0]
    v_pk_fma_f32 v[182:183], v[150:151], v[204:205], v[206:207] op_sel_hi:[1,0,0]
    v_pk_fma_f32 v[184:185], v[152:153], v[204:205], v[206:207] op_sel_hi:[1,0,0]
    v_pk_fma_f32 v[186:187], v[154:155], v[204:205], v[206:207] op_sel_hi:[1,0,0]
    v_pk_fma_f32 v[188:189], v[156:157], v[204:205], v[206:207] op_sel_hi:[1,0,0]
    v_pk_fma_f32 v[190:191], v[158:159], v[204:205], v[206:207] op_sel_hi:[1,0,0]
    v_cvt_pk_bf16_f32 v216, v176, v177
    v_cvt_pk_bf16_f32 v217, v178, v179
    v_cvt_pk_bf16_f32 v218, v180, v181
    v_cvt_pk_bf16_f32 v219, v182, v183
    v_cvt_pk_bf16_f32 v220, v184, v185
    v_cvt_pk_bf16_f32 v221, v186, v187
    v_cvt_pk_bf16_f32 v222, v188, v189
    v_cvt_pk_bf16_f32 v223, v190, v191
    s_add_u32 s46, s34, 1048576
    s_add_u32 s47, s34, 1052672
    buffer_store_dwordx4 v[216:219], v7, s[4:7], s46 offen
    buffer_store_dwordx4 v[220:223], v7, s[4:7], s47 offen
    v_cvt_pk_bf16_f32 v20, v144, v145
    v_cvt_pk_bf16_f32 v21, v146, v147
    v_cvt_pk_bf16_f32 v22, v148, v149
    v_cvt_pk_bf16_f32 v23, v150, v151
    v_cvt_pk_bf16_f32 v24, v152, v153
    v_cvt_pk_bf16_f32 v25, v154, v155
    v_cvt_pk_bf16_f32 v26, v156, v157
    v_cvt_pk_bf16_f32 v27, v158, v159
    s_waitcnt vmcnt(0)
    buffer_wbl2 sc1
    s_waitcnt vmcnt(0)
    buffer_store_dword v18, v6, s[4:7], s40 offen sc1
    s_barrier
    s_waitcnt vmcnt(0)
    s_mov_b32 s49, 0
L_polll_100032:
    buffer_inv sc1
    s_waitcnt vmcnt(0)
    buffer_load_dword v17, v5, s[4:7], s41 offen sc1
    s_add_u32 s49, s49, 1
    s_waitcnt vmcnt(0)
    v_cmp_ne_u32 vcc, s51, v17
    s_cmp_gt_u32 s49, 0x2000
    s_cbranch_scc1 L_pollb_100031
    s_cbranch_vccnz L_polll_100032
L_pollb_100031:
    buffer_inv sc1
    s_waitcnt vmcnt(0)
    s_add_u32 s3, s35, 1048576
    buffer_load_dwordx4 v[128:131], v1, s[4:7], s3 offen sc1
    buffer_load_dwordx4 v[132:135], v1, s[4:7], s3 offen offset:1024 sc1
    buffer_load_dwordx4 v[136:139], v1, s[4:7], s3 offen offset:2048 sc1
    buffer_load_dwordx4 v[140:143], v1, s[4:7], s3 offen offset:3072 sc1
    s_add_u32 s3, s35, 1052672
    buffer_load_dwordx4 v[144:147], v1, s[4:7], s3 offen sc1
    s_waitcnt vmcnt(4)
    ds_read_b128 v[32:35], v2 offset:0
    ds_read_b128 v[36:39], v2 offset:32768
    ds_read_b128 v[40:43], v3 offset:0
    ds_read_b128 v[44:47], v2 offset:1024
    ds_read_b128 v[48:51], v2 offset:33792
    ds_read_b128 v[52:55], v3 offset:1024
    s_waitcnt lgkmcnt(4)
    v_mfma_f32_32x32x16_bf16 v[64:79], v[32:35], v[128:131], 0
    ds_read_b128 v[56:59], v2 offset:2048
    buffer_load_dwordx4 v[148:151], v1, s[4:7], s3 offen offset:1024 sc1
    v_mfma_f32_32x32x16_bf16 v[80:95], v[36:39], v[128:131], 0
    ds_read_b128 v[60:63], v2 offset:34816
    s_waitcnt lgkmcnt(4)
    v_mfma_f32_32x32x16_bf16 v[96:111], v[40:43], v[128:131], 0
    ds_read_b128 v[32:35], v3 offset:2048
    buffer_load_dwordx4 v[152:155], v1, s[4:7], s3 offen offset:2048 sc1
    s_waitcnt vmcnt(5)
    v_mfma_f32_32x32x16_bf16 v[64:79], v[44:47], v[132:135], v[64:79]
    ds_read_b128 v[36:39], v2 offset:3072
    s_waitcnt lgkmcnt(4)
    v_mfma_f32_32x32x16_bf16 v[80:95], v[48:51], v[132:135], v[80:95]
    ds_read_b128 v[40:43], v2 offset:35840
    buffer_load_dwordx4 v[156:159], v1, s[4:7], s3 offen offset:3072 sc1
    v_mfma_f32_32x32x16_bf16 v[96:111], v[52:55], v[132:135], v[96:111]
    ds_read_b128 v[44:47], v3 offset:3072
    s_waitcnt vmcnt(5)
    s_waitcnt lgkmcnt(4)
    v_mfma_f32_32x32x16_bf16 v[64:79], v[56:59], v[136:139], v[64:79]
    ds_read_b128 v[48:51], v2 offset:4096
    s_add_u32 s3, s35, 1056768
    v_mfma_f32_32x32x16_bf16 v[80:95], v[60:63], v[136:139], v[80:95]
    ds_read_b128 v[52:55], v2 offset:36864
    buffer_load_dwordx4 v[160:163], v1, s[4:7], s3 offen sc1
    s_waitcnt lgkmcnt(4)
    v_mfma_f32_32x32x16_bf16 v[96:111], v[32:35], v[136:139], v[96:111]
    ds_read_b128 v[56:59], v3 offset:4096
    s_waitcnt vmcnt(5)
    v_mfma_f32_32x32x16_bf16 v[64:79], v[36:39], v[140:143], v[64:79]
    ds_read_b128 v[60:63], v2 offset:5120
    buffer_load_dwordx4 v[164:167], v1, s[4:7], s3 offen offset:1024 sc1
    s_waitcnt lgkmcnt(4)
    v_mfma_f32_32x32x16_bf16 v[80:95], v[40:43], v[140:143], v[80:95]
    ds_read_b128 v[32:35], v2 offset:37888
    v_mfma_f32_32x32x16_bf16 v[96:111], v[44:47], v[140:143], v[96:111]
    ds_read_b128 v[36:39], v3 offset:5120
    buffer_load_dwordx4 v[168:171], v1, s[4:7], s3 offen offset:2048 sc1
    s_waitcnt vmcnt(6)
    s_waitcnt lgkmcnt(4)
    v_mfma_f32_32x32x16_bf16 v[64:79], v[48:51], v[144:147], v[64:79]
    ds_read_b128 v[40:43], v2 offset:6144
    v_mfma_f32_32x32x16_bf16 v[80:95], v[52:55], v[144:147], v[80:95]
    ds_read_b128 v[44:47], v2 offset:38912
    buffer_load_dwordx4 v[172:175], v1, s[4:7], s3 offen offset:3072 sc1
    s_waitcnt lgkmcnt(4)
    v_mfma_f32_32x32x16_bf16 v[96:111], v[56:59], v[144:147], v[96:111]
    ds_read_b128 v[48:51], v3 offset:6144
    s_add_u32 s3, s35, 1060864
    s_waitcnt vmcnt(6)
    v_mfma_f32_32x32x16_bf16 v[64:79], v[60:63], v[148:151], v[64:79]
    ds_read_b128 v[52:55], v2 offset:7168
    buffer_load_dwordx4 v[176:179], v1, s[4:7], s3 offen sc1
    s_waitcnt lgkmcnt(4)
    v_mfma_f32_32x32x16_bf16 v[80:95], v[32:35], v[148:151], v[80:95]
    ds_read_b128 v[56:59], v2 offset:39936
    v_mfma_f32_32x32x16_bf16 v[96:111], v[36:39], v[148:151], v[96:111]
    ds_read_b128 v[60:63], v3 offset:7168
    buffer_load_dwordx4 v[180:183], v1, s[4:7], s3 offen offset:1024 sc1
    s_waitcnt vmcnt(7)
    s_waitcnt lgkmcnt(4)
    v_mfma_f32_32x32x16_bf16 v[64:79], v[40:43], v[152:155], v[64:79]
    ds_read_b128 v[32:35], v2 offset:8192
    v_mfma_f32_32x32x16_bf16 v[80:95], v[44:47], v[152:155], v[80:95]
    ds_read_b128 v[36:39], v2 offset:40960
    buffer_load_dwordx4 v[184:187], v1, s[4:7], s3 offen offset:2048 sc1
    s_waitcnt lgkmcnt(4)
    v_mfma_f32_32x32x16_bf16 v[96:111], v[48:51], v[152:155], v[96:111]
    ds_read_b128 v[40:43], v3 offset:8192
    s_waitcnt vmcnt(7)
    v_mfma_f32_32x32x16_bf16 v[64:79], v[52:55], v[156:159], v[64:79]
    ds_read_b128 v[44:47], v2 offset:9216
    buffer_load_dwordx4 v[188:191], v1, s[4:7], s3 offen offset:3072 sc1
    s_waitcnt lgkmcnt(4)
    v_mfma_f32_32x32x16_bf16 v[80:95], v[56:59], v[156:159], v[80:95]
    ds_read_b128 v[48:51], v2 offset:41984
    s_add_u32 s3, s35, 1064960
    v_mfma_f32_32x32x16_bf16 v[96:111], v[60:63], v[156:159], v[96:111]
    ds_read_b128 v[52:55], v3 offset:9216
    buffer_load_dwordx4 v[192:195], v1, s[4:7], s3 offen sc1
    s_waitcnt vmcnt(8)
    s_waitcnt lgkmcnt(4)
    v_mfma_f32_32x32x16_bf16 v[64:79], v[32:35], v[160:163], v[64:79]
    ds_read_b128 v[56:59], v2 offset:10240
    v_mfma_f32_32x32x16_bf16 v[80:95], v[36:39], v[160:163], v[80:95]
    ds_read_b128 v[60:63], v2 offset:43008
    buffer_load_dwordx4 v[196:199], v1, s[4:7], s3 offen offset:1024 sc1
    s_waitcnt lgkmcnt(4)
    v_mfma_f32_32x32x16_bf16 v[96:111], v[40:43], v[160:163], v[96:111]
    ds_read_b128 v[32:35], v3 offset:10240
    s_waitcnt vmcnt(8)
    v_mfma_f32_32x32x16_bf16 v[64:79], v[44:47], v[164:167], v[64:79]
    ds_read_b128 v[36:39], v2 offset:11264
    buffer_load_dwordx4 v[200:203], v1, s[4:7], s3 offen offset:2048 sc1
    s_waitcnt lgkmcnt(4)
    v_mfma_f32_32x32x16_bf16 v[80:95], v[48:51], v[164:167], v[80:95]
    ds_read_b128 v[40:43], v2 offset:44032
    v_mfma_f32_32x32x16_bf16 v[96:111], v[52:55], v[164:167], v[96:111]
    ds_read_b128 v[44:47], v3 offset:11264
    buffer_load_dwordx4 v[204:207], v1, s[4:7], s3 offen offset:3072 sc1
    s_waitcnt vmcnt(9)
    s_waitcnt lgkmcnt(4)
    v_mfma_f32_32x32x16_bf16 v[64:79], v[56:59], v[168:171], v[64:79]
    ds_read_b128 v[48:51], v2 offset:12288
    s_add_u32 s3, s35, 1069056
    v_mfma_f32_32x32x16_bf16 v[80:95], v[60:63], v[168:171], v[80:95]
    ds_read_b128 v[52:55], v2 offset:45056
    buffer_load_dwordx4 v[208:211], v1, s[4:7], s3 offen sc1
    s_waitcnt lgkmcnt(4)
    v_mfma_f32_32x32x16_bf16 v[96:111], v[32:35], v[168:171], v[96:111]
    ds_read_b128 v[56:59], v3 offset:12288
    s_waitcnt vmcnt(9)
    v_mfma_f32_32x32x16_bf16 v[64:79], v[36:39], v[172:175], v[64:79]
    ds_read_b128 v[60:63], v2 offset:13312
    buffer_load_dwordx4 v[212:215], v1, s[4:7], s3 offen offset:1024 sc1
    s_waitcnt lgkmcnt(4)
    v_mfma_f32_32x32x16_bf16 v[80:95], v[40:43], v[172:175], v[80:95]
    ds_read_b128 v[32:35], v2 offset:46080
    v_mfma_f32_32x32x16_bf16 v[96:111], v[44:47], v[172:175], v[96:111]
    ds_read_b128 v[36:39], v3 offset:13312
    buffer_load_dwordx4 v[216:219], v1, s[4:7], s3 offen offset:2048 sc1
    s_waitcnt vmcnt(10)
    s_waitcnt lgkmcnt(4)
    v_mfma_f32_32x32x16_bf16 v[64:79], v[48:51], v[176:179], v[64:79]
    ds_read_b128 v[40:43], v2 offset:14336
    v_mfma_f32_32x32x16_bf16 v[80:95], v[52:55], v[176:179], v[80:95]
    ds_read_b128 v[44:47], v2 offset:47104
    buffer_load_dwordx4 v[220:223], v1, s[4:7], s3 offen offset:3072 sc1
    s_waitcnt lgkmcnt(4)
    v_mfma_f32_32x32x16_bf16 v[96:111], v[56:59], v[176:179], v[96:111]
    ds_read_b128 v[48:51], v3 offset:14336
    s_add_u32 s3, s35, 1073152
    s_waitcnt vmcnt(10)
    v_mfma_f32_32x32x16_bf16 v[64:79], v[60:63], v[180:183], v[64:79]
    ds_read_b128 v[52:55], v2 offset:15360
    buffer_load_dwordx4 v[224:227], v1, s[4:7], s3 offen sc1
    s_waitcnt lgkmcnt(4)
    v_mfma_f32_32x32x16_bf16 v[80:95], v[32:35], v[180:183], v[80:95]
    ds_read_b128 v[56:59], v2 offset:48128
    v_mfma_f32_32x32x16_bf16 v[96:111], v[36:39], v[180:183], v[96:111]
    ds_read_b128 v[60:63], v3 offset:15360
    buffer_load_dwordx4 v[228:231], v1, s[4:7], s3 offen offset:1024 sc1
    s_waitcnt vmcnt(11)
    s_waitcnt lgkmcnt(4)
    v_mfma_f32_32x32x16_bf16 v[64:79], v[40:43], v[184:187], v[64:79]
    ds_read_b128 v[32:35], v2 offset:16384
    v_mfma_f32_32x32x16_bf16 v[80:95], v[44:47], v[184:187], v[80:95]
    ds_read_b128 v[36:39], v2 offset:49152
    buffer_load_dwordx4 v[232:235], v1, s[4:7], s3 offen offset:2048 sc1
    s_waitcnt lgkmcnt(4)
    v_mfma_f32_32x32x16_bf16 v[96:111], v[48:51], v[184:187], v[96:111]
    ds_read_b128 v[40:43], v3 offset:16384
    s_waitcnt vmcnt(11)
    v_mfma_f32_32x32x16_bf16 v[64:79], v[52:55], v[188:191], v[64:79]
    ds_read_b128 v[44:47], v2 offset:17408
    buffer_load_dwordx4 v[236:239], v1, s[4:7], s3 offen offset:3072 sc1
    s_waitcnt lgkmcnt(4)
    v_mfma_f32_32x32x16_bf16 v[80:95], v[56:59], v[188:191], v[80:95]
    ds_read_b128 v[48:51], v2 offset:50176
    s_add_u32 s3, s35, 1077248
    v_mfma_f32_32x32x16_bf16 v[96:111], v[60:63], v[188:191], v[96:111]
    ds_read_b128 v[52:55], v3 offset:17408
    buffer_load_dwordx4 v[240:243], v1, s[4:7], s3 offen sc1
    s_waitcnt vmcnt(12)
    s_waitcnt lgkmcnt(4)
    v_mfma_f32_32x32x16_bf16 v[64:79], v[32:35], v[192:195], v[64:79]
    ds_read_b128 v[56:59], v2 offset:18432
    v_mfma_f32_32x32x16_bf16 v[80:95], v[36:39], v[192:195], v[80:95]
    ds_read_b128 v[60:63], v2 offset:51200
    buffer_load_dwordx4 v[244:247], v1, s[4:7], s3 offen offset:1024 sc1
    s_waitcnt lgkmcnt(4)
    v_mfma_f32_32x32x16_bf16 v[96:111], v[40:43], v[192:195], v[96:111]
    ds_read_b128 v[32:35], v3 offset:18432
    s_waitcnt vmcnt(12)
    v_mfma_f32_32x32x16_bf16 v[64:79], v[44:47], v[196:199], v[64:79]
    ds_read_b128 v[36:39], v2 offset:19456
    buffer_load_dwordx4 v[248:251], v1, s[4:7], s3 offen offset:2048 sc1
    s_waitcnt lgkmcnt(4)
    v_mfma_f32_32x32x16_bf16 v[80:95], v[48:51], v[196:199], v[80:95]
    ds_read_b128 v[40:43], v2 offset:52224
    v_mfma_f32_32x32x16_bf16 v[96:111], v[52:55], v[196:199], v[96:111]
    ds_read_b128 v[44:47], v3 offset:19456
    buffer_load_dwordx4 v[252:255], v1, s[4:7], s3 offen offset:3072 sc1
    s_waitcnt vmcnt(13)
    s_waitcnt lgkmcnt(4)
    v_mfma_f32_32x32x16_bf16 v[64:79], v[56:59], v[200:203], v[64:79]
    ds_read_b128 v[48:51], v2 offset:20480
    s_add_u32 m0, s23, 32768
    s_add_u32 s50, s39, 131072
    v_mfma_f32_32x32x16_bf16 v[80:95], v[60:63], v[200:203], v[80:95]
    ds_read_b128 v[52:55], v2 offset:53248
    buffer_load_dwordx4 v1, s[4:7], s50 offen lds
    s_waitcnt lgkmcnt(4)
    v_mfma_f32_32x32x16_bf16 v[96:111], v[32:35], v[200:203], v[96:111]
    ds_read_b128 v[56:59], v3 offset:20480
    s_waitcnt vmcnt(13)
    v_mfma_f32_32x32x16_bf16 v[64:79], v[36:39], v[204:207], v[64:79]
    ds_read_b128 v[60:63], v2 offset:21504
    buffer_load_dwordx4 v1, s[4:7], s50 offen offset:1024 lds
    s_waitcnt lgkmcnt(4)
    v_mfma_f32_32x32x16_bf16 v[80:95], v[40:43], v[204:207], v[80:95]
    ds_read_b128 v[32:35], v2 offset:54272
    v_mfma_f32_32x32x16_bf16 v[96:111], v[44:47], v[204:207], v[96:111]
    ds_read_b128 v[36:39], v3 offset:21504
    buffer_load_dwordx4 v1, s[4:7], s50 offen offset:2048 lds
    s_waitcnt vmcnt(14)
    s_waitcnt lgkmcnt(4)
    v_mfma_f32_32x32x16_bf16 v[64:79], v[48:51], v[208:211], v[64:79]
    ds_read_b128 v[40:43], v2 offset:22528
    v_mfma_f32_32x32x16_bf16 v[80:95], v[52:55], v[208:211], v[80:95]
    ds_read_b128 v[44:47], v2 offset:55296
    buffer_load_dwordx4 v1, s[4:7], s50 offen offset:3072 lds
    s_add_u32 m0, s23, 36864
    s_add_u32 s50, s39, 135168
    s_waitcnt lgkmcnt(4)
    v_mfma_f32_32x32x16_bf16 v[96:111], v[56:59], v[208:211], v[96:111]
    ds_read_b128 v[48:51], v3 offset:22528
    s_waitcnt vmcnt(14)
    v_mfma_f32_32x32x16_bf16 v[64:79], v[60:63], v[212:215], v[64:79]
    ds_read_b128 v[52:55], v2 offset:23552
    buffer_load_dwordx4 v1, s[4:7], s50 offen lds
    s_waitcnt lgkmcnt(4)
    v_mfma_f32_32x32x16_bf16 v[80:95], v[32:35], v[212:215], v[80:95]
    ds_read_b128 v[56:59], v2 offset:56320
    v_mfma_f32_32x32x16_bf16 v[96:111], v[36:39], v[212:215], v[96:111]
    ds_read_b128 v[60:63], v3 offset:23552
    buffer_load_dwordx4 v1, s[4:7], s50 offen offset:1024 lds
    s_waitcnt vmcnt(15)
    s_waitcnt lgkmcnt(4)
    v_mfma_f32_32x32x16_bf16 v[64:79], v[40:43], v[216:219], v[64:79]
    ds_read_b128 v[32:35], v2 offset:24576
    v_mfma_f32_32x32x16_bf16 v[80:95], v[44:47], v[216:219], v[80:95]
    ds_read_b128 v[36:39], v2 offset:57344
    buffer_load_dwordx4 v1, s[4:7], s50 offen offset:2048 lds
    s_waitcnt lgkmcnt(4)
    v_mfma_f32_32x32x16_bf16 v[96:111], v[48:51], v[216:219], v[96:111]
    ds_read_b128 v[40:43], v3 offset:24576
    s_waitcnt vmcnt(15)
    v_mfma_f32_32x32x16_bf16 v[64:79], v[52:55], v[220:223], v[64:79]
    ds_read_b128 v[44:47], v2 offset:25600
    buffer_load_dwordx4 v1, s[4:7], s50 offen offset:3072 lds
    s_add_u32 s26, s30, 0
    s_waitcnt lgkmcnt(4)
    v_mfma_f32_32x32x16_bf16 v[80:95], v[56:59], v[220:223], v[80:95]
    ds_read_b128 v[48:51], v2 offset:58368
    buffer_load_dwordx4 a[0:3], v28, s[4:7], s26 offen
    v_mfma_f32_32x32x16_bf16 v[96:111], v[60:63], v[220:223], v[96:111]
    ds_read_b128 v[52:55], v3 offset:25600
    s_waitcnt vmcnt(16)
    s_waitcnt lgkmcnt(4)
    v_mfma_f32_32x32x16_bf16 v[64:79], v[32:35], v[224:227], v[64:79]
    ds_read_b128 v[56:59], v2 offset:26624
    buffer_load_dwordx4 a[4:7], v29, s[4:7], s26 offen
    v_mfma_f32_32x32x16_bf16 v[80:95], v[36:39], v[224:227], v[80:95]
    ds_read_b128 v[60:63], v2 offset:59392
    s_add_u32 s26, s30, 14336
    s_waitcnt lgkmcnt(4)
    v_mfma_f32_32x32x16_bf16 v[96:111], v[40:43], v[224:227], v[96:111]
    ds_read_b128 v[32:35], v3 offset:26624
    buffer_load_dwordx4 a[56:59], v28, s[4:7], s26 offen
    s_waitcnt vmcnt(17)
    v_mfma_f32_32x32x16_bf16 v[64:79], v[44:47], v[228:231], v[64:79]
    ds_read_b128 v[36:39], v2 offset:27648
    s_waitcnt lgkmcnt(4)
    v_mfma_f32_32x32x16_bf16 v[80:95], v[48:51], v[228:231], v[80:95]
    ds_read_b128 v[40:43], v2 offset:60416
    buffer_load_dwordx4 a[60:63], v29, s[4:7], s26 offen
    v_mfma_f32_32x32x16_bf16 v[96:111], v[52:55], v[228:231], v[96:111]
    ds_read_b128 v[44:47], v3 offset:27648
    s_add_u32 s26, s30, 28672
    s_waitcnt vmcnt(17)
    s_waitcnt lgkmcnt(4)
    v_mfma_f32_32x32x16_bf16 v[64:79], v[56:59], v[232:235], v[64:79]
    ds_read_b128 v[48:51], v2 offset:28672
    buffer_load_dwordx4 a[112:115], v28, s[4:7], s26 offen
    v_mfma_f32_32x32x16_bf16 v[80:95], v[60:63], v[232:235], v[80:95]
    ds_read_b128 v[52:55], v2 offset:61440
    s_waitcnt lgkmcnt(4)
    v_mfma_f32_32x32x16_bf16 v[96:111], v[32:35], v[232:235], v[96:111]
    ds_read_b128 v[56:59], v3 offset:28672
    buffer_load_dwordx4 a[116:119], v29, s[4:7], s26 offen
    s_waitcnt vmcnt(18)
    v_mfma_f32_32x32x16_bf16 v[64:79], v[36:39], v[236:239], v[64:79]
    ds_read_b128 v[60:63], v2 offset:29696
    s_add_u32 s26, s30, 43008
    s_waitcnt lgkmcnt(4)
    v_mfma_f32_32x32x16_bf16 v[80:95], v[40:43], v[236:239], v[80:95]
    ds_read_b128 v[32:35], v2 offset:62464
    buffer_load_dwordx4 a[168:171], v28, s[4:7], s26 offen
    v_mfma_f32_32x32x16_bf16 v[96:111], v[44:47], v[236:239], v[96:111]
    ds_read_b128 v[36:39], v3 offset:29696
    s_waitcnt vmcnt(18)
    s_waitcnt lgkmcnt(4)
    v_mfma_f32_32x32x16_bf16 v[64:79], v[48:51], v[240:243], v[64:79]
    ds_read_b128 v[40:43], v2 offset:30720
    buffer_load_dwordx4 a[172:175], v29, s[4:7], s26 offen
    v_mfma_f32_32x32x16_bf16 v[80:95], v[52:55], v[240:243], v[80:95]
    ds_read_b128 v[44:47], v2 offset:63488
    s_add_u32 s26, s30, 2048
    s_waitcnt lgkmcnt(4)
    v_mfma_f32_32x32x16_bf16 v[96:111], v[56:59], v[240:243], v[96:111]
    ds_read_b128 v[48:51], v3 offset:30720
    buffer_load_dwordx4 a[8:11], v28, s[4:7], s26 offen
    s_waitcnt vmcnt(19)
    v_mfma_f32_32x32x16_bf16 v[64:79], v[60:63], v[244:247], v[64:79]
    ds_read_b128 v[52:55], v2 offset:31744
    s_waitcnt lgkmcnt(4)
    v_mfma_f32_32x32x16_bf16 v[80:95], v[32:35], v[244:247], v[80:95]
    ds_read_b128 v[56:59], v2 offset:64512
    buffer_load_dwordx4 a[12:15], v29, s[4:7], s26 offen
    v_mfma_f32_32x32x16_bf16 v[96:111], v[36:39], v[244:247], v[96:111]
    ds_read_b128 v[60:63], v3 offset:31744
    s_add_u32 s26, s30, 16384
    s_waitcnt vmcnt(19)
    s_waitcnt lgkmcnt(4)
    v_mfma_f32_32x32x16_bf16 v[64:79], v[40:43], v[248:251], v[64:79]
    ds_read_b128 v[32:35], v1 offset:0
    buffer_load_dwordx4 a[64:67], v28, s[4:7], s26 offen
    v_mfma_f32_32x32x16_bf16 v[80:95], v[44:47], v[248:251], v[80:95]
    ds_read_b128 v[36:39], v1 offset:1024
    s_waitcnt lgkmcnt(4)
    v_mfma_f32_32x32x16_bf16 v[96:111], v[48:51], v[248:251], v[96:111]
    ds_read_b128 v[40:43], v1 offset:2048
    buffer_load_dwordx4 a[68:71], v29, s[4:7], s26 offen
    s_waitcnt vmcnt(20)
    v_mfma_f32_32x32x16_bf16 v[64:79], v[52:55], v[252:255], v[64:79]
    ds_read_b128 v[44:47], v1 offset:3072
    s_add_u32 s26, s30, 30720
    s_waitcnt lgkmcnt(4)
    v_mfma_f32_32x32x16_bf16 v[80:95], v[56:59], v[252:255], v[80:95]
    ds_read_b128 v[48:51], v1 offset:4096
    buffer_load_dwordx4 a[120:123], v28, s[4:7], s26 offen
    v_mfma_f32_32x32x16_bf16 v[96:111], v[60:63], v[252:255], v[96:111]
    ds_read_b128 v[52:55], v1 offset:5120
    s_waitcnt lgkmcnt(4)
    v_mfma_f32_32x32x16_bf16 v[112:127], v[32:35], v[128:131], 0
    ds_read_b128 v[56:59], v1 offset:6144
    buffer_load_dwordx4 a[124:127], v29, s[4:7], s26 offen
    s_barrier
    v_mfma_f32_32x32x16_bf16 v[112:127], v[36:39], v[132:135], v[112:127]
    ds_read_b128 v[60:63], v1 offset:7168
    s_add_u32 m0, s23, 65536
    s_add_u32 s50, s39, 163840
    s_add_u32 s26, s30, 45056
    s_waitcnt lgkmcnt(4)
    v_mfma_f32_32x32x16_bf16 v[112:127], v[40:43], v[136:139], v[112:127]
    ds_read_b128 v[32:35], v1 offset:8192
    buffer_load_dwordx4 v1, s[4:7], s50 offen lds
    v_mfma_f32_32x32x16_bf16 v[112:127], v[44:47], v[140:143], v[112:127]
    ds_read_b128 v[36:39], v1 offset:9216
    buffer_load_dwordx4 a[176:179], v28, s[4:7], s26 offen
    v_exp_f32_e64 v64, -v64
    s_waitcnt lgkmcnt(4)
    v_mfma_f32_32x32x16_bf16 v[112:127], v[48:51], v[144:147], v[112:127]
    ds_read_b128 v[40:43], v1 offset:10240
    buffer_load_dwordx4 v1, s[4:7], s50 offen offset:1024 lds
    v_add_f32 v64, 1.0, v64
    v_exp_f32_e64 v65, -v65
    v_mfma_f32_32x32x16_bf16 v[112:127], v[52:55], v[148:151], v[112:127]
    ds_read_b128 v[44:47], v1 offset:11264
    buffer_load_dwordx4 a[180:183], v29, s[4:7], s26 offen
    v_add_f32 v65, 1.0, v65
    v_exp_f32_e64 v66, -v66
    s_waitcnt lgkmcnt(4)
    v_mfma_f32_32x32x16_bf16 v[112:127], v[56:59], v[152:155], v[112:127]
    ds_read_b128 v[48:51], v1 offset:12288
    buffer_load_dwordx4 v1, s[4:7], s50 offen offset:2048 lds
    s_add_u32 s26, s30, 4096
    v_add_f32 v66, 1.0, v66
    v_exp_f32_e64 v67, -v67
    v_mfma_f32_32x32x16_bf16 v[112:127], v[60:63], v[156:159], v[112:127]
    ds_read_b128 v[52:55], v1 offset:13312
    buffer_load_dwordx4 a[16:19], v28, s[4:7], s26 offen
    v_add_f32 v67, 1.0, v67
    v_exp_f32_e64 v68, -v68
    s_waitcnt lgkmcnt(4)
    v_mfma_f32_32x32x16_bf16 v[112:127], v[32:35], v[160:163], v[112:127]
    ds_read_b128 v[56:59], v1 offset:14336
    buffer_load_dwordx4 v1, s[4:7], s50 offen offset:3072 lds
    v_add_f32 v68, 1.0, v68
    v_exp_f32_e64 v69, -v69
    v_mfma_f32_32x32x16_bf16 v[112:127], v[36:39], v[164:167], v[112:127]
    ds_read_b128 v[60:63], v1 offset:15360
    buffer_load_dwordx4 a[20:23], v29, s[4:7], s26 offen
    s_add_u32 m0, s23, 69632
    s_add_u32 s50, s39, 167936
    v_add_f32 v69, 1.0, v69
    v_exp_f32_e64 v70, -v70
    s_waitcnt lgkmcnt(4)
    v_mfma_f32_32x32x16_bf16 v[112:127], v[40:43], v[168:171], v[112:127]
    ds_read_b128 v[32:35], v1 offset:16384
    buffer_load_dwordx4 v1, s[4:7], s50 offen lds
    s_add_u32 s26, s30, 18432
    v_add_f32 v70, 1.0, v70
    v_exp_f32_e64 v71, -v71
    v_mfma_f32_32x32x16_bf16 v[112:127], v[44:47], v[172:175], v[112:127]
    ds_read_b128 v[36:39], v1 offset:17408
    buffer_load_dwordx4 a[72:75], v28, s[4:7], s26 offen
    v_rcp_f32 v64, v64
    v_add_f32 v71, 1.0, v71
    s_waitcnt lgkmcnt(4)
    v_mfma_f32_32x32x16_bf16 v[112:127], v[48:51], v[176:179], v[112:127]
    ds_read_b128 v[40:43], v1 offset:18432
    buffer_load_dwordx4 v1, s[4:7], s50 offen offset:1024 lds
    v_mul_f32 v64, v64, v72
    v_rcp_f32 v65, v65
    v_mfma_f32_32x32x16_bf16 v[112:127], v[52:55], v[180:183], v[112:127]
    ds_read_b128 v[44:47], v1 offset:19456
    buffer_load_dwordx4 a[76:79], v29, s[4:7], s26 offen
    s_add_u32 s94, s36, 13631488
    v_mul_f32 v65, v65, v73
    v_rcp_f32 v66, v66
    s_waitcnt lgkmcnt(4)
    v_mfma_f32_32x32x16_bf16 v[112:127], v[56:59], v[184:187], v[112:127]
    ds_read_b128 v[48:51], v1 offset:20480
    s_add_u32 s26, s30, 32768
    v_mul_f32 v66, v66, v74
    v_rcp_f32 v67, v67
    v_cvt_pk_bf16_f32 v72, v64, v65
    v_mfma_f32_32x32x16_bf16 v[112:127], v[60:63], v[188:191], v[112:127]
    ds_read_b128 v[52:55], v1 offset:21504
    buffer_load_dwordx4 v1, s[4:7], s50 offen offset:2048 lds
    v_mul_f32 v67, v67, v75
    v_rcp_f32 v68, v68
    s_waitcnt lgkmcnt(4)
    v_mfma_f32_32x32x16_bf16 v[112:127], v[32:35], v[192:195], v[112:127]
    ds_read_b128 v[56:59], v1 offset:22528
    buffer_load_dwordx4 a[128:131], v28, s[4:7], s26 offen
    v_mul_f32 v68, v68, v76
    v_rcp_f32 v69, v69
    v_cvt_pk_bf16_f32 v73, v66, v67
    v_mfma_f32_32x32x16_bf16 v[112:127], v[36:39], v[196:199], v[112:127]
    ds_read_b128 v[60:63], v1 offset:23552
    buffer_load_dwordx4 v1, s[4:7], s50 offen offset:3072 lds
    v_mul_f32 v69, v69, v77
    v_rcp_f32 v70, v70
    s_waitcnt lgkmcnt(4)
    v_mfma_f32_32x32x16_bf16 v[112:127], v[40:43], v[200:203], v[112:127]
    ds_read_b128 v[32:35], v1 offset:24576
    buffer_load_dwordx4 a[132:135], v29, s[4:7], s26 offen
    v_mul_f32 v70, v70, v78
    v_rcp_f32 v71, v71
    v_cvt_pk_bf16_f32 v74, v68, v69
    v_mfma_f32_32x32x16_bf16 v[112:127], v[44:47], v[204:207], v[112:127]
    ds_read_b128 v[36:39], v1 offset:25600
    s_add_u32 m0, s23, 98304
    s_add_u32 s50, s39, 196608
    s_add_u32 s26, s30, 47104
    v_mul_f32 v71, v71, v79
    v_exp_f32_e64 v80, -v80
    s_waitcnt lgkmcnt(4)
    v_mfma_f32_32x32x16_bf16 v[112:127], v[48:51], v[208:211], v[112:127]
    ds_read_b128 v[40:43], v1 offset:26624
    buffer_load_dwordx4 a[184:187], v28, s[4:7], s26 offen
    v_add_f32 v80, 1.0, v80
    v_exp_f32_e64 v81, -v81
    v_cvt_pk_bf16_f32 v75, v70, v71
    v_mfma_f32_32x32x16_bf16 v[112:127], v[52:55], v[212:215], v[112:127]
    ds_read_b128 v[44:47], v1 offset:27648
    buffer_store_dwordx4 v[72:75], v1, s[4:7], s94 offen sc1
    v_add_f32 v81, 1.0, v81
    v_exp_f32_e64 v82, -v82
    s_waitcnt lgkmcnt(4)
    v_mfma_f32_32x32x16_bf16 v[112:127], v[56:59], v[216:219], v[112:127]
    ds_read_b128 v[48:51], v1 offset:28672
    buffer_load_dwordx4 a[188:191], v29, s[4:7], s26 offen
    v_add_f32 v82, 1.0, v82
    v_exp_f32_e64 v83, -v83
    v_mfma_f32_32x32x16_bf16 v[112:127], v[60:63], v[220:223], v[112:127]
    ds_read_b128 v[52:55], v1 offset:29696
    buffer_load_dwordx4 v1, s[4:7], s50 offen lds
    s_add_u32 s26, s30, 6144
    v_add_f32 v83, 1.0, v83
    v_exp_f32_e64 v84, -v84
    s_waitcnt lgkmcnt(4)
    v_mfma_f32_32x32x16_bf16 v[112:127], v[32:35], v[224:227], v[112:127]
    ds_read_b128 v[56:59], v1 offset:30720
    buffer_load_dwordx4 a[24:27], v28, s[4:7], s26 offen
    v_add_f32 v84, 1.0, v84
    v_exp_f32_e64 v85, -v85
    v_mfma_f32_32x32x16_bf16 v[112:127], v[36:39], v[228:231], v[112:127]
    ds_read_b128 v[60:63], v1 offset:31744
    s_waitcnt vmcnt(35)
    s_barrier
    v_add_f32 v85, 1.0, v85
    v_exp_f32_e64 v86, -v86
    s_waitcnt lgkmcnt(4)
    v_mfma_f32_32x32x16_bf16 v[112:127], v[40:43], v[232:235], v[112:127]
    ds_read_b128 v[32:35], v1 offset:32768
    buffer_load_dwordx4 v1, s[4:7], s50 offen offset:1024 lds
    v_add_f32 v86, 1.0, v86
    v_exp_f32_e64 v87, -v87
    v_mfma_f32_32x32x16_bf16 v[112:127], v[44:47], v[236:239], v[112:127]
    ds_read_b128 v[36:39], v1 offset:33792
    buffer_load_dwordx4 a[28:31], v29, s[4:7], s26 offen
    v_rcp_f32 v80, v80
    v_add_f32 v87, 1.0, v87
    s_waitcnt lgkmcnt(4)
    v_mfma_f32_32x32x16_bf16 v[112:127], v[48:51], v[240:243], v[112:127]
    ds_read_b128 v[40:43], v1 offset:34816
    buffer_load_dwordx4 v1, s[4:7], s50 offen offset:2048 lds
    s_add_u32 s26, s30, 20480
    v_mul_f32 v80, v80, v88
    v_rcp_f32 v81, v81
    v_mfma_f32_32x32x16_bf16 v[112:127], v[52:55], v[244:247], v[112:127]
    ds_read_b128 v[44:47], v1 offset:35840
    buffer_load_dwordx4 a[80:83], v28, s[4:7], s26 offen
    s_add_u32 s95, s36, 13635584
    v_mul_f32 v81, v81, v89
    v_rcp_f32 v82, v82
    s_waitcnt lgkmcnt(4)
    v_mfma_f32_32x32x16_bf16 v[112:127], v[56:59], v[248:251], v[112:127]
    ds_read_b128 v[48:51], v1 offset:36864
    v_mul_f32 v82, v82, v90
    v_rcp_f32 v83, v83
    v_cvt_pk_bf16_f32 v88, v80, v81
    v_mfma_f32_32x32x16_bf16 v[112:127], v[60:63], v[252:255], v[112:127]
    ds_read_b128 v[52:55], v1 offset:37888
    buffer_load_dwordx4 v1, s[4:7], s50 offen offset:3072 lds
    s_add_u32 m0, s23, 102400
    v_mul_f32 v83, v83, v91
    v_rcp_f32 v84, v84
    s_waitcnt lgkmcnt(4)
    v_mfma_f32_32x32x16_bf16 v[64:79], v[32:35], v[128:131], 0
    ds_read_b128 v[56:59], v1 offset:38912
    buffer_load_dwordx4 a[84:87], v29, s[4:7], s26 offen
    v_mul_f32 v84, v84, v92
    v_rcp_f32 v85, v85
    v_cvt_pk_bf16_f32 v89, v82, v83
    v_mfma_f32_32x32x16_bf16 v[64:79], v[36:39], v[132:135], v[64:79]
    ds_read_b128 v[60:63], v1 offset:39936
    s_add_u32 s50, s39, 200704
    s_add_u32 s26, s30, 34816
    v_mul_f32 v85, v85, v93
    v_rcp_f32 v86, v86
    s_waitcnt lgkmcnt(4)
    v_mfma_f32_32x32x16_bf16 v[64:79], v[40:43], v[136:139], v[64:79]
    ds_read_b128 v[32:35], v1 offset:40960
    buffer_load_dwordx4 a[136:139], v28, s[4:7], s26 offen
    v_mul_f32 v86, v86, v94
    v_rcp_f32 v87, v87
    v_cvt_pk_bf16_f32 v90, v84, v85
    v_mfma_f32_32x32x16_bf16 v[64:79], v[44:47], v[140:143], v[64:79]
    ds_read_b128 v[36:39], v1 offset:41984
    buffer_load_dwordx4 v1, s[4:7], s50 offen lds
    v_mul_f32 v87, v87, v95
    v_exp_f32_e64 v96, -v96
    s_waitcnt lgkmcnt(4)
    v_mfma_f32_32x32x16_bf16 v[64:79], v[48:51], v[144:147], v[64:79]
    ds_read_b128 v[40:43], v1 offset:43008
    buffer_load_dwordx4 a[140:143], v29, s[4:7], s26 offen
    v_add_f32 v96, 1.0, v96
    v_exp_f32_e64 v97, -v97
    v_cvt_pk_bf16_f32 v91, v86, v87
    v_mfma_f32_32x32x16_bf16 v[64:79], v[52:55], v[148:151], v[64:79]
    ds_read_b128 v[44:47], v1 offset:44032
    buffer_store_dwordx4 v[88:91], v1, s[4:7], s95 offen sc1
    s_add_u32 s26, s30, 49152
    v_add_f32 v97, 1.0, v97
    v_exp_f32_e64 v98, -v98
    s_waitcnt lgkmcnt(4)
    v_mfma_f32_32x32x16_bf16 v[64:79], v[56:59], v[152:155], v[64:79]
    ds_read_b128 v[48:51], v1 offset:45056
    buffer_load_dwordx4 a[192:195], v28, s[4:7], s26 offen
    v_add_f32 v98, 1.0, v98
    v_exp_f32_e64 v99, -v99
    v_mfma_f32_32x32x16_bf16 v[64:79], v[60:63], v[156:159], v[64:79]
    ds_read_b128 v[52:55], v1 offset:46080
    buffer_load_dwordx4 v1, s[4:7], s50 offen offset:1024 lds
    v_add_f32 v99, 1.0, v99
    v_exp_f32_e64 v100, -v100
    s_waitcnt lgkmcnt(4)
    v_mfma_f32_32x32x16_bf16 v[64:79], v[32:35], v[160:163], v[64:79]
    ds_read_b128 v[56:59], v1 offset:47104
    buffer_load_dwordx4 a[196:199], v29, s[4:7], s26 offen
    v_add_f32 v100, 1.0, v100
    v_exp_f32_e64 v101, -v101
    v_mfma_f32_32x32x16_bf16 v[64:79], v[36:39], v[164:167], v[64:79]
    ds_read_b128 v[60:63], v1 offset:48128
    buffer_load_dwordx4 v1, s[4:7], s50 offen offset:2048 lds
    s_add_u32 s26, s30, 8192
    v_add_f32 v101, 1.0, v101
    v_exp_f32_e64 v102, -v102
    s_waitcnt lgkmcnt(4)
    v_mfma_f32_32x32x16_bf16 v[64:79], v[40:43], v[168:171], v[64:79]
    ds_read_b128 v[32:35], v1 offset:49152
    buffer_load_dwordx4 a[32:35], v28, s[4:7], s26 offen
    v_add_f32 v102, 1.0, v102
    v_exp_f32_e64 v103, -v103
    v_mfma_f32_32x32x16_bf16 v[64:79], v[44:47], v[172:175], v[64:79]
    ds_read_b128 v[36:39], v1 offset:50176
    buffer_load_dwordx4 v1, s[4:7], s50 offen offset:3072 lds
    v_rcp_f32 v96, v96
    v_add_f32 v103, 1.0, v103
    s_waitcnt lgkmcnt(4)
    v_mfma_f32_32x32x16_bf16 v[64:79], v[48:51], v[176:179], v[64:79]
    ds_read_b128 v[40:43], v1 offset:51200
    buffer_load_dwordx4 a[36:39], v29, s[4:7], s26 offen
    v_mul_f32 v96, v96, v104
    v_rcp_f32 v97, v97
    v_mfma_f32_32x32x16_bf16 v[64:79], v[52:55], v[180:183], v[64:79]
    ds_read_b128 v[44:47], v1 offset:52224
    s_add_u32 s94, s36, 13639680
    s_add_u32 s26, s30, 22528
    v_mul_f32 v97, v97, v105
    v_rcp_f32 v98, v98
    s_waitcnt lgkmcnt(4)
    v_mfma_f32_32x32x16_bf16 v[64:79], v[56:59], v[184:187], v[64:79]
    ds_read_b128 v[48:51], v1 offset:53248
    buffer_load_dwordx4 a[88:91], v28, s[4:7], s26 offen
    v_mul_f32 v98, v98, v106
    v_rcp_f32 v99, v99
    v_cvt_pk_bf16_f32 v104, v96, v97
    v_mfma_f32_32x32x16_bf16 v[64:79], v[60:63], v[188:191], v[64:79]
    ds_read_b128 v[52:55], v1 offset:54272
    v_mul_f32 v99, v99, v107
    v_rcp_f32 v100, v100
    s_waitcnt lgkmcnt(4)
    v_mfma_f32_32x32x16_bf16 v[64:79], v[32:35], v[192:195], v[64:79]
    ds_read_b128 v[56:59], v1 offset:55296
    buffer_load_dwordx4 a[92:95], v29, s[4:7], s26 offen
    v_mul_f32 v100, v100, v108
    v_rcp_f32 v101, v101
    v_cvt_pk_bf16_f32 v105, v98, v99
    v_mfma_f32_32x32x16_bf16 v[64:79], v[36:39], v[196:199], v[64:79]
    ds_read_b128 v[60:63], v1 offset:56320
    s_add_u32 s26, s30, 36864
    v_mul_f32 v101, v101, v109
    v_rcp_f32 v102, v102
    s_waitcnt lgkmcnt(4)
    v_mfma_f32_32x32x16_bf16 v[64:79], v[40:43], v[200:203], v[64:79]
    ds_read_b128 v[32:35], v1 offset:57344
    buffer_load_dwordx4 a[144:147], v28, s[4:7], s26 offen
    v_mul_f32 v102, v102, v110
    v_rcp_f32 v103, v103
    v_cvt_pk_bf16_f32 v106, v100, v101
    v_mfma_f32_32x32x16_bf16 v[64:79], v[44:47], v[204:207], v[64:79]
    ds_read_b128 v[36:39], v1 offset:58368
    v_mul_f32 v103, v103, v111
    v_exp_f32_e64 v112, -v112
    s_waitcnt lgkmcnt(4)
    v_mfma_f32_32x32x16_bf16 v[64:79], v[48:51], v[208:211], v[64:79]
    ds_read_b128 v[40:43], v1 offset:59392
    buffer_load_dwordx4 a[148:151], v29, s[4:7], s26 offen
    v_add_f32 v112, 1.0, v112
    v_exp_f32_e64 v113, -v113
    v_cvt_pk_bf16_f32 v107, v102, v103
    v_mfma_f32_32x32x16_bf16 v[64:79], v[52:55], v[212:215], v[64:79]
    ds_read_b128 v[44:47], v1 offset:60416
    buffer_store_dwordx4 v[104:107], v1, s[4:7], s94 offen sc1
    s_add_u32 s26, s30, 51200
    v_add_f32 v113, 1.0, v113
    v_exp_f32_e64 v114, -v114
    s_waitcnt lgkmcnt(4)
    v_mfma_f32_32x32x16_bf16 v[64:79], v[56:59], v[216:219], v[64:79]
    ds_read_b128 v[48:51], v1 offset:61440
    buffer_load_dwordx4 a[200:203], v28, s[4:7], s26 offen
    v_add_f32 v114, 1.0, v114
    v_exp_f32_e64 v115, -v115
    v_mfma_f32_32x32x16_bf16 v[64:79], v[60:63], v[220:223], v[64:79]
    ds_read_b128 v[52:55], v1 offset:62464
    v_add_f32 v115, 1.0, v115
    v_exp_f32_e64 v116, -v116
    s_waitcnt lgkmcnt(4)
    v_mfma_f32_32x32x16_bf16 v[64:79], v[32:35], v[224:227], v[64:79]
    ds_read_b128 v[56:59], v1 offset:63488
    buffer_load_dwordx4 a[204:207], v29, s[4:7], s26 offen
    v_add_f32 v116, 1.0, v116
    v_exp_f32_e64 v117, -v117
    v_mfma_f32_32x32x16_bf16 v[64:79], v[36:39], v[228:231], v[64:79]
    ds_read_b128 v[60:63], v1 offset:64512
    s_waitcnt vmcnt(30)
    s_barrier
    s_add_u32 s26, s30, 10240
    v_add_f32 v117, 1.0, v117
    v_exp_f32_e64 v118, -v118
    s_waitcnt lgkmcnt(4)
    v_mfma_f32_32x32x16_bf16 v[64:79], v[40:43], v[232:235], v[64:79]
    ds_read_b128 v[32:35], v2 offset:0
    buffer_load_dwordx4 a[40:43], v28, s[4:7], s26 offen
    v_add_f32 v118, 1.0, v118
    v_exp_f32_e64 v119, -v119
    v_mfma_f32_32x32x16_bf16 v[64:79], v[44:47], v[236:239], v[64:79]
    ds_read_b128 v[36:39], v2 offset:1024
    v_rcp_f32 v112, v112
    v_add_f32 v119, 1.0, v119
    s_waitcnt lgkmcnt(4)
    v_mfma_f32_32x32x16_bf16 v[64:79], v[48:51], v[240:243], v[64:79]
    ds_read_b128 v[40:43], v2 offset:2048
    buffer_load_dwordx4 a[44:47], v29, s[4:7], s26 offen
    v_mul_f32 v112, v112, v120
    v_rcp_f32 v113, v113
    v_mfma_f32_32x32x16_bf16 v[64:79], v[52:55], v[244:247], v[64:79]
    ds_read_b128 v[44:47], v2 offset:3072
    s_add_u32 s95, s36, 13643776
    s_add_u32 s26, s30, 24576
    v_mul_f32 v113, v113, v121
    v_rcp_f32 v114, v114
    s_waitcnt lgkmcnt(4)
    v_mfma_f32_32x32x16_bf16 v[64:79], v[56:59], v[248:251], v[64:79]
    ds_read_b128 v[48:51], v2 offset:4096
    buffer_load_dwordx4 a[96:99], v28, s[4:7], s26 offen
    v_mul_f32 v114, v114, v122
    v_rcp_f32 v115, v115
    v_cvt_pk_bf16_f32 v120, v112, v113
    v_mfma_f32_32x32x16_bf16 v[64:79], v[60:63], v[252:255], v[64:79]
    ds_read_b128 v[52:55], v2 offset:5120
    v_mul_f32 v115, v115, v123
    v_rcp_f32 v116, v116
    s_waitcnt lgkmcnt(4)
    v_mfma_f32_32x32x16_bf16 v[80:95], v[32:35], v[128:131], 0
    ds_read_b128 v[56:59], v2 offset:6144
    buffer_load_dwordx4 a[100:103], v29, s[4:7], s26 offen
    v_mul_f32 v116, v116, v124
    v_rcp_f32 v117, v117
    v_cvt_pk_bf16_f32 v121, v114, v115
    v_mfma_f32_32x32x16_bf16 v[80:95], v[36:39], v[132:135], v[80:95]
    ds_read_b128 v[60:63], v2 offset:7168
    s_waitcnt vmcnt(6)
    s_add_u32 s26, s30, 38912
    v_mul_f32 v117, v117, v125
    v_rcp_f32 v118, v118
    s_waitcnt lgkmcnt(4)
    v_mfma_f32_32x32x16_bf16 v[80:95], v[40:43], v[136:139], v[80:95]
    ds_read_b128 v[32:35], v2 offset:8192
    buffer_load_dwordx4 a[152:155], v28, s[4:7], s26 offen
    v_mul_f32 v118, v118, v126
    v_rcp_f32 v119, v119
    v_cvt_pk_bf16_f32 v122, v116, v117
    v_mfma_f32_32x32x16_bf16 v[80:95], v[44:47], v[140:143], v[80:95]
    ds_read_b128 v[36:39], v2 offset:9216
    s_waitcnt vmcnt(0)
    buffer_wbl2 sc1
    s_waitcnt vmcnt(0)
    buffer_store_dword v18, v6, s[4:7], s42 offen sc1
    v_mul_f32 v119, v119, v127
    v_exp_f32_e64 v64, -v64
    s_waitcnt lgkmcnt(4)
    v_mfma_f32_32x32x16_bf16 v[80:95], v[48:51], v[144:147], v[80:95]
    ds_read_b128 v[40:43], v2 offset:10240
    buffer_load_dwordx4 a[156:159], v29, s[4:7], s26 offen
    v_add_f32 v64, 1.0, v64
    v_exp_f32_e64 v65, -v65
    v_cvt_pk_bf16_f32 v123, v118, v119
    v_mfma_f32_32x32x16_bf16 v[80:95], v[52:55], v[148:151], v[80:95]
    ds_read_b128 v[44:47], v2 offset:11264
    buffer_store_dwordx4 v[120:123], v1, s[4:7], s95 offen sc1
    s_add_u32 s26, s30, 53248
    v_add_f32 v65, 1.0, v65
    v_exp_f32_e64 v66, -v66
    s_waitcnt lgkmcnt(4)
    v_mfma_f32_32x32x16_bf16 v[80:95], v[56:59], v[152:155], v[80:95]
    ds_read_b128 v[48:51], v2 offset:12288
    buffer_load_dwordx4 a[208:211], v28, s[4:7], s26 offen
    v_add_f32 v66, 1.0, v66
    v_exp_f32_e64 v67, -v67
    v_mfma_f32_32x32x16_bf16 v[80:95], v[60:63], v[156:159], v[80:95]
    ds_read_b128 v[52:55], v2 offset:13312
    v_add_f32 v67, 1.0, v67
    v_exp_f32_e64 v68, -v68
    s_waitcnt lgkmcnt(4)
    v_mfma_f32_32x32x16_bf16 v[80:95], v[32:35], v[160:163], v[80:95]
    ds_read_b128 v[56:59], v2 offset:14336
    buffer_load_dwordx4 a[212:215], v29, s[4:7], s26 offen
    v_add_f32 v68, 1.0, v68
    v_exp_f32_e64 v69, -v69
    v_mfma_f32_32x32x16_bf16 v[80:95], v[36:39], v[164:167], v[80:95]
    ds_read_b128 v[60:63], v2 offset:15360
    s_add_u32 s26, s30, 12288
    v_add_f32 v69, 1.0, v69
    v_exp_f32_e64 v70, -v70
    s_waitcnt lgkmcnt(4)
    v_mfma_f32_32x32x16_bf16 v[80:95], v[40:43], v[168:171], v[80:95]
    ds_read_b128 v[32:35], v2 offset:16384
    buffer_load_dwordx4 a[48:51], v28, s[4:7], s26 offen
    v_add_f32 v70, 1.0, v70
    v_exp_f32_e64 v71, -v71
    v_mfma_f32_32x32x16_bf16 v[80:95], v[44:47], v[172:175], v[80:95]
    ds_read_b128 v[36:39], v2 offset:17408
    v_rcp_f32 v64, v64
    v_add_f32 v71, 1.0, v71
    s_waitcnt lgkmcnt(4)
    v_mfma_f32_32x32x16_bf16 v[80:95], v[48:51], v[176:179], v[80:95]
    ds_read_b128 v[40:43], v2 offset:18432
    buffer_load_dwordx4 a[52:55], v29, s[4:7], s26 offen
    v_mul_f32 v64, v64, v72
    v_rcp_f32 v65, v65
    v_mfma_f32_32x32x16_bf16 v[80:95], v[52:55], v[180:183], v[80:95]
    ds_read_b128 v[44:47], v2 offset:19456
    s_add_u32 s94, s36, 13647872
    s_add_u32 s26, s30, 26624
    v_mul_f32 v65, v65, v73
    v_rcp_f32 v66, v66
    s_waitcnt lgkmcnt(4)
    v_mfma_f32_32x32x16_bf16 v[80:95], v[56:59], v[184:187], v[80:95]
    ds_read_b128 v[48:51], v2 offset:20480
    buffer_load_dwordx4 a[104:107], v28, s[4:7], s26 offen
    v_mul_f32 v66, v66, v74
    v_rcp_f32 v67, v67
    v_cvt_pk_bf16_f32 v72, v64, v65
    v_mfma_f32_32x32x16_bf16 v[80:95], v[60:63], v[188:191], v[80:95]
    ds_read_b128 v[52:55], v2 offset:21504
    v_mul_f32 v67, v67, v75
    v_rcp_f32 v68, v68
    s_waitcnt lgkmcnt(4)
    v_mfma_f32_32x32x16_bf16 v[80:95], v[32:35], v[192:195], v[80:95]
    ds_read_b128 v[56:59], v2 offset:22528
    buffer_load_dwordx4 a[108:111], v29, s[4:7], s26 offen
    v_mul_f32 v68, v68, v76
    v_rcp_f32 v69, v69
    v_cvt_pk_bf16_f32 v73, v66, v67
    v_mfma_f32_32x32x16_bf16 v[80:95], v[36:39], v[196:199], v[80:95]
    ds_read_b128 v[60:63], v2 offset:23552
    s_add_u32 s26, s30, 40960
    v_mul_f32 v69, v69, v77
    v_rcp_f32 v70, v70
    s_waitcnt lgkmcnt(4)
    v_mfma_f32_32x32x16_bf16 v[80:95], v[40:43], v[200:203], v[80:95]
    ds_read_b128 v[32:35], v2 offset:24576
    buffer_load_dwordx4 a[160:163], v28, s[4:7], s26 offen
    v_mul_f32 v70, v70, v78
    v_rcp_f32 v71, v71
    v_cvt_pk_bf16_f32 v74, v68, v69
    v_mfma_f32_32x32x16_bf16 v[80:95], v[44:47], v[204:207], v[80:95]
    ds_read_b128 v[36:39], v2 offset:25600
    v_mul_f32 v71, v71, v79
    s_waitcnt lgkmcnt(4)
    v_mfma_f32_32x32x16_bf16 v[80:95], v[48:51], v[208:211], v[80:95]
    ds_read_b128 v[40:43], v2 offset:26624
    buffer_load_dwordx4 a[164:167], v29, s[4:7], s26 offen
    v_cvt_pk_bf16_f32 v75, v70, v71
    v_mfma_f32_32x32x16_bf16 v[80:95], v[52:55], v[212:215], v[80:95]
    ds_read_b128 v[44:47], v2 offset:27648
    buffer_store_dwordx4 v[72:75], v1, s[4:7], s94 offen sc1
    s_add_u32 s96, s37, 13631488
    s_add_u32 s97, s37, 13635584
    s_add_u32 s26, s30, 55296
    s_waitcnt lgkmcnt(4)
    v_mfma_f32_32x32x16_bf16 v[80:95], v[56:59], v[216:219], v[80:95]
    ds_read_b128 v[48:51], v2 offset:28672
    buffer_load_dwordx4 a[216:219], v28, s[4:7], s26 offen
    v_mfma_f32_32x32x16_bf16 v[80:95], v[60:63], v[220:223], v[80:95]
    ds_read_b128 v[52:55], v2 offset:29696
    s_waitcnt vmcnt(0)
    s_mov_b32 s49, 0
L_polll_100035:
    buffer_inv sc1
    s_waitcnt vmcnt(0)
    buffer_load_dword v17, v4, s[4:7], s43 offen sc1
    s_add_u32 s49, s49, 1
    s_waitcnt vmcnt(0)
    v_cmp_ne_u32 vcc, s51, v17
    s_cmp_gt_u32 s49, 0x2000
    s_cbranch_scc1 L_pollb_100034
    s_cbranch_vccnz L_polll_100035
L_pollb_100034:
    buffer_inv sc1
    s_waitcnt vmcnt(0)
    s_waitcnt lgkmcnt(4)
    v_mfma_f32_32x32x16_bf16 v[80:95], v[32:35], v[224:227], v[80:95]
    ds_read_b128 v[56:59], v2 offset:30720
    buffer_load_dwordx4 a[236:239], v1, s[4:7], s96 offen sc1
    v_mfma_f32_32x32x16_bf16 v[80:95], v[36:39], v[228:231], v[80:95]
    ds_read_b128 v[60:63], v2 offset:31744
    buffer_load_dwordx4 a[220:223], v29, s[4:7], s26 offen
    s_barrier
    s_waitcnt lgkmcnt(4)
    v_mfma_f32_32x32x16_bf16 v[80:95], v[40:43], v[232:235], v[80:95]
    ds_read_b128 v[32:35], v2 offset:32768
    buffer_load_dwordx4 a[240:243], v1, s[4:7], s96 offen offset:1024 sc1
    v_mfma_f32_32x32x16_bf16 v[80:95], v[44:47], v[236:239], v[80:95]
    ds_read_b128 v[36:39], v2 offset:33792
    s_waitcnt lgkmcnt(4)
    v_mfma_f32_32x32x16_bf16 v[80:95], v[48:51], v[240:243], v[80:95]
    ds_read_b128 v[40:43], v2 offset:34816
    buffer_load_dwordx4 a[244:247], v1, s[4:7], s96 offen offset:2048 sc1
    v_mfma_f32_32x32x16_bf16 v[80:95], v[52:55], v[244:247], v[80:95]
    ds_read_b128 v[44:47], v2 offset:35840
    s_waitcnt lgkmcnt(4)
    v_mfma_f32_32x32x16_bf16 v[80:95], v[56:59], v[248:251], v[80:95]
    ds_read_b128 v[48:51], v2 offset:36864
    buffer_load_dwordx4 a[248:251], v1, s[4:7], s96 offen offset:3072 sc1
    s_add_u32 s96, s37, 13639680
    v_mfma_f32_32x32x16_bf16 v[80:95], v[60:63], v[252:255], v[80:95]
    ds_read_b128 v[52:55], v2 offset:37888
    s_waitcnt lgkmcnt(4)
    v_mfma_f32_32x32x16_bf16 v[96:111], v[32:35], v[128:131], 0
    ds_read_b128 v[56:59], v2 offset:38912
    buffer_load_dwordx4 a[252:255], v1, s[4:7], s97 offen sc1
    v_mfma_f32_32x32x16_bf16 v[96:111], v[36:39], v[132:135], v[96:111]
    ds_read_b128 v[60:63], v2 offset:39936
    s_waitcnt lgkmcnt(4)
    v_mfma_f32_32x32x16_bf16 v[96:111], v[40:43], v[136:139], v[96:111]
    ds_read_b128 v[32:35], v2 offset:40960
    buffer_load_dwordx4 v[128:131], v1, s[4:7], s97 offen offset:1024 sc1
    v_mfma_f32_32x32x16_bf16 v[96:111], v[44:47], v[140:143], v[96:111]
    ds_read_b128 v[36:39], v2 offset:41984
    s_waitcnt lgkmcnt(4)
    v_mfma_f32_32x32x16_bf16 v[96:111], v[48:51], v[144:147], v[96:111]
    ds_read_b128 v[40:43], v2 offset:43008
    buffer_load_dwordx4 v[132:135], v1, s[4:7], s97 offen offset:2048 sc1
    v_exp_f32_e64 v80, -v80
    v_mfma_f32_32x32x16_bf16 v[96:111], v[52:55], v[148:151], v[96:111]
    ds_read_b128 v[44:47], v2 offset:44032
    v_add_f32 v80, 1.0, v80
    v_exp_f32_e64 v81, -v81
    s_waitcnt lgkmcnt(4)
    v_mfma_f32_32x32x16_bf16 v[96:111], v[56:59], v[152:155], v[96:111]
    ds_read_b128 v[48:51], v2 offset:45056
    buffer_load_dwordx4 v[136:139], v1, s[4:7], s97 offen offset:3072 sc1
    v_add_f32 v81, 1.0, v81
    v_exp_f32_e64 v82, -v82
    v_mfma_f32_32x32x16_bf16 v[96:111], v[60:63], v[156:159], v[96:111]
    ds_read_b128 v[52:55], v2 offset:46080
    s_add_u32 s97, s37, 13746176
    v_add_f32 v82, 1.0, v82
    v_exp_f32_e64 v83, -v83
    s_waitcnt lgkmcnt(4)
    v_mfma_f32_32x32x16_bf16 v[96:111], v[32:35], v[160:163], v[96:111]
    ds_read_b128 v[56:59], v2 offset:47104
    buffer_load_dwordx4 v[140:143], v1, s[4:7], s96 offen sc1
    v_add_f32 v83, 1.0, v83
    v_exp_f32_e64 v84, -v84
    v_mfma_f32_32x32x16_bf16 v[96:111], v[36:39], v[164:167], v[96:111]
    ds_read_b128 v[60:63], v2 offset:48128
    v_add_f32 v84, 1.0, v84
    v_exp_f32_e64 v85, -v85
    s_waitcnt lgkmcnt(4)
    v_mfma_f32_32x32x16_bf16 v[96:111], v[40:43], v[168:171], v[96:111]
    ds_read_b128 v[32:35], v2 offset:49152
    buffer_load_dwordx4 v[144:147], v1, s[4:7], s96 offen offset:1024 sc1
    v_add_f32 v85, 1.0, v85
    v_exp_f32_e64 v86, -v86
    v_mfma_f32_32x32x16_bf16 v[96:111], v[44:47], v[172:175], v[96:111]
    ds_read_b128 v[36:39], v2 offset:50176
    v_add_f32 v86, 1.0, v86
    v_exp_f32_e64 v87, -v87
    s_waitcnt lgkmcnt(4)
    v_mfma_f32_32x32x16_bf16 v[96:111], v[48:51], v[176:179], v[96:111]
    ds_read_b128 v[40:43], v2 offset:51200
    buffer_load_dwordx4 v[148:151], v1, s[4:7], s96 offen offset:2048 sc1
    v_rcp_f32 v80, v80
    v_add_f32 v87, 1.0, v87
    v_mfma_f32_32x32x16_bf16 v[96:111], v[52:55], v[180:183], v[96:111]
    ds_read_b128 v[44:47], v2 offset:52224
    v_mul_f32 v80, v80, v88
    v_rcp_f32 v81, v81
    s_waitcnt lgkmcnt(4)
    v_mfma_f32_32x32x16_bf16 v[96:111], v[56:59], v[184:187], v[96:111]
    ds_read_b128 v[48:51], v2 offset:53248
    s_add_u32 s95, s36, 13651968
    v_mul_f32 v81, v81, v89
    v_rcp_f32 v82, v82
    v_mfma_f32_32x32x16_bf16 v[96:111], v[60:63], v[188:191], v[96:111]
    ds_read_b128 v[52:55], v2 offset:54272
    buffer_load_dwordx4 v[152:155], v1, s[4:7], s96 offen offset:3072 sc1
    v_mul_f32 v82, v82, v90
    v_rcp_f32 v83, v83
    v_cvt_pk_bf16_f32 v88, v80, v81
    s_waitcnt lgkmcnt(4)
    v_mfma_f32_32x32x16_bf16 v[96:111], v[32:35], v[192:195], v[96:111]
    ds_read_b128 v[56:59], v2 offset:55296
    s_add_u32 s96, s37, 13750272
    v_mul_f32 v83, v83, v91
    v_rcp_f32 v84, v84
    v_mfma_f32_32x32x16_bf16 v[96:111], v[36:39], v[196:199], v[96:111]
    ds_read_b128 v[60:63], v2 offset:56320
    buffer_load_dwordx4 v[156:159], v1, s[4:7], s97 offen sc1
    v_mul_f32 v84, v84, v92
    v_rcp_f32 v85, v85
    v_cvt_pk_bf16_f32 v89, v82, v83
    s_waitcnt lgkmcnt(4)
    v_mfma_f32_32x32x16_bf16 v[96:111], v[40:43], v[200:203], v[96:111]
    ds_read_b128 v[32:35], v2 offset:57344
    v_mul_f32 v85, v85, v93
    v_rcp_f32 v86, v86
    v_mfma_f32_32x32x16_bf16 v[96:111], v[44:47], v[204:207], v[96:111]
    ds_read_b128 v[36:39], v2 offset:58368
    buffer_load_dwordx4 v[160:163], v1, s[4:7], s97 offen offset:1024 sc1
    v_mul_f32 v86, v86, v94
    v_rcp_f32 v87, v87
    v_cvt_pk_bf16_f32 v90, v84, v85
    s_waitcnt lgkmcnt(4)
    v_mfma_f32_32x32x16_bf16 v[96:111], v[48:51], v[208:211], v[96:111]
    ds_read_b128 v[40:43], v2 offset:59392
    v_mul_f32 v87, v87, v95
    v_mfma_f32_32x32x16_bf16 v[96:111], v[52:55], v[212:215], v[96:111]
    ds_read_b128 v[44:47], v2 offset:60416
    v_cvt_pk_bf16_f32 v91, v86, v87
    s_waitcnt lgkmcnt(4)
    v_mfma_f32_32x32x16_bf16 v[96:111], v[56:59], v[216:219], v[96:111]
    ds_read_b128 v[48:51], v2 offset:61440
    buffer_store_dwordx4 v[88:91], v1, s[4:7], s95 offen sc1
    v_mfma_f32_32x32x16_bf16 v[96:111], v[60:63], v[220:223], v[96:111]
    ds_read_b128 v[52:55], v2 offset:62464
    s_waitcnt lgkmcnt(4)
    v_mfma_f32_32x32x16_bf16 v[96:111], v[32:35], v[224:227], v[96:111]
    ds_read_b128 v[56:59], v2 offset:63488
    buffer_load_dwordx4 v[164:167], v1, s[4:7], s97 offen offset:2048 sc1
    v_mfma_f32_32x32x16_bf16 v[96:111], v[36:39], v[228:231], v[96:111]
    ds_read_b128 v[60:63], v2 offset:64512
    s_waitcnt lgkmcnt(4)
    v_mfma_f32_32x32x16_bf16 v[96:111], v[40:43], v[232:235], v[96:111]
    buffer_load_dwordx4 v[168:171], v1, s[4:7], s97 offen offset:3072 sc1
    s_add_u32 s97, s37, 13754368
    v_mfma_f32_32x32x16_bf16 v[96:111], v[44:47], v[236:239], v[96:111]
    s_waitcnt lgkmcnt(2)
    v_mfma_f32_32x32x16_bf16 v[96:111], v[48:51], v[240:243], v[96:111]
    buffer_load_dwordx4 v[172:175], v1, s[4:7], s96 offen sc1
    v_mfma_f32_32x32x16_bf16 v[96:111], v[52:55], v[244:247], v[96:111]
    s_waitcnt lgkmcnt(0)
    v_mfma_f32_32x32x16_bf16 v[96:111], v[56:59], v[248:251], v[96:111]
    buffer_load_dwordx4 v[176:179], v1, s[4:7], s96 offen offset:1024 sc1
    v_mfma_f32_32x32x16_bf16 v[96:111], v[60:63], v[252:255], v[96:111]
    s_waitcnt vmcnt(19)
    v_mfma_f32_32x32x16_bf16 v[64:79], a[0:3], a[236:239], 0
    buffer_load_dwordx4 v[180:183], v1, s[4:7], s96 offen offset:2048 sc1
    v_mfma_f32_32x32x16_bf16 v[80:95], a[4:7], a[236:239], 0
    s_waitcnt vmcnt(18)
    v_mfma_f32_32x32x16_bf16 v[64:79], a[56:59], a[240:243], v[64:79]
    buffer_load_dwordx4 v[184:187], v1, s[4:7], s96 offen offset:3072 sc1
    s_waitcnt vmcnt(6)
    v_mfma_f32_32x32x16_bf16 v[80:95], a[60:63], a[240:243], v[80:95]
    s_waitcnt vmcnt(0)
    buffer_wbl2 sc1
    s_waitcnt vmcnt(0)
    buffer_store_dword v18, v6, s[4:7], s42 offen offset:256 sc1
    v_mfma_f32_32x32x16_bf16 v[64:79], a[112:115], a[244:247], v[64:79]
    buffer_load_dwordx4 v[188:191], v1, s[4:7], s97 offen sc1
    v_exp_f32_e64 v96, -v96
    v_mfma_f32_32x32x16_bf16 v[80:95], a[116:119], a[244:247], v[80:95]
    v_add_f32 v96, 1.0, v96
    v_exp_f32_e64 v97, -v97
    v_mfma_f32_32x32x16_bf16 v[64:79], a[168:171], a[248:251], v[64:79]
    buffer_load_dwordx4 v[192:195], v1, s[4:7], s97 offen offset:1024 sc1
    v_add_f32 v97, 1.0, v97
    v_exp_f32_e64 v98, -v98
    v_mfma_f32_32x32x16_bf16 v[80:95], a[172:175], a[248:251], v[80:95]
    v_add_f32 v98, 1.0, v98
    v_exp_f32_e64 v99, -v99
    v_mfma_f32_32x32x16_bf16 v[64:79], a[8:11], a[252:255], v[64:79]
    buffer_load_dwordx4 v[196:199], v1, s[4:7], s97 offen offset:2048 sc1
    v_add_f32 v99, 1.0, v99
    v_exp_f32_e64 v100, -v100
    v_mfma_f32_32x32x16_bf16 v[80:95], a[12:15], a[252:255], v[80:95]
    v_add_f32 v100, 1.0, v100
    v_exp_f32_e64 v101, -v101
    v_mfma_f32_32x32x16_bf16 v[64:79], a[64:67], v[128:131], v[64:79]
    buffer_load_dwordx4 v[200:203], v1, s[4:7], s97 offen offset:3072 sc1
    v_add_f32 v101, 1.0, v101
    v_exp_f32_e64 v102, -v102
    v_mfma_f32_32x32x16_bf16 v[80:95], a[68:71], v[128:131], v[80:95]
    v_add_f32 v102, 1.0, v102
    v_exp_f32_e64 v103, -v103
    v_mfma_f32_32x32x16_bf16 v[64:79], a[120:123], v[132:135], v[64:79]
    v_rcp_f32 v96, v96
    v_add_f32 v103, 1.0, v103
    v_mfma_f32_32x32x16_bf16 v[80:95], a[124:127], v[132:135], v[80:95]
    v_mul_f32 v96, v96, v104
    v_rcp_f32 v97, v97
    v_mfma_f32_32x32x16_bf16 v[64:79], a[176:179], v[136:139], v[64:79]
    s_add_u32 s94, s36, 13656064
    v_mul_f32 v97, v97, v105
    v_rcp_f32 v98, v98
    v_mfma_f32_32x32x16_bf16 v[80:95], a[180:183], v[136:139], v[80:95]
    v_mul_f32 v98, v98, v106
    v_rcp_f32 v99, v99
    v_cvt_pk_bf16_f32 v104, v96, v97
    v_mfma_f32_32x32x16_bf16 v[64:79], a[16:19], v[140:143], v[64:79]
    v_mul_f32 v99, v99, v107
    v_rcp_f32 v100, v100
    v_mfma_f32_32x32x16_bf16 v[80:95], a[20:23], v[140:143], v[80:95]
    v_mul_f32 v100, v100, v108
    v_rcp_f32 v101, v101
    v_cvt_pk_bf16_f32 v105, v98, v99
    v_mfma_f32_32x32x16_bf16 v[64:79], a[72:75], v[144:147], v[64:79]
    v_mul_f32 v101, v101, v109
    v_rcp_f32 v102, v102
    v_mfma_f32_32x32x16_bf16 v[80:95], a[76:79], v[144:147], v[80:95]
    v_mul_f32 v102, v102, v110
    v_rcp_f32 v103, v103
    v_cvt_pk_bf16_f32 v106, v100, v101
    v_mfma_f32_32x32x16_bf16 v[64:79], a[128:131], v[148:151], v[64:79]
    v_mul_f32 v103, v103, v111
    v_mfma_f32_32x32x16_bf16 v[80:95], a[132:135], v[148:151], v[80:95]
    v_cvt_pk_bf16_f32 v107, v102, v103
    v_mfma_f32_32x32x16_bf16 v[64:79], a[184:187], v[152:155], v[64:79]
    buffer_store_dwordx4 v[104:107], v1, s[4:7], s94 offen sc1
    v_mfma_f32_32x32x16_bf16 v[80:95], a[188:191], v[152:155], v[80:95]
    s_add_u32 s96, s37, 13643776
    s_add_u32 s97, s37, 13647872
    v_mfma_f32_32x32x16_bf16 v[112:127], a[0:3], v[156:159], 0
    v_mfma_f32_32x32x16_bf16 v[96:111], a[4:7], v[156:159], 0
    s_waitcnt vmcnt(0)
    s_mov_b32 s49, 0
L_polll_100038:
    buffer_inv sc1
    s_waitcnt vmcnt(0)
    buffer_load_dword v17, v4, s[4:7], s43 offen offset:256 sc1
    s_add_u32 s49, s49, 1
    s_waitcnt vmcnt(0)
    v_cmp_ne_u32 vcc, s51, v17
    s_cmp_gt_u32 s49, 0x2000
    s_cbranch_scc1 L_pollb_100037
    s_cbranch_vccnz L_polll_100038
L_pollb_100037:
    buffer_inv sc1
    s_waitcnt vmcnt(0)
    v_mfma_f32_32x32x16_bf16 v[112:127], a[56:59], v[160:163], v[112:127]
    buffer_load_dwordx4 v[204:207], v1, s[4:7], s96 offen sc1
    v_mfma_f32_32x32x16_bf16 v[96:111], a[60:63], v[160:163], v[96:111]
    v_mfma_f32_32x32x16_bf16 v[112:127], a[112:115], v[164:167], v[112:127]
    buffer_load_dwordx4 v[208:211], v1, s[4:7], s96 offen offset:1024 sc1
    v_mfma_f32_32x32x16_bf16 v[96:111], a[116:119], v[164:167], v[96:111]
    v_mfma_f32_32x32x16_bf16 v[112:127], a[168:171], v[168:171], v[112:127]
    buffer_load_dwordx4 v[212:215], v1, s[4:7], s96 offen offset:2048 sc1
    v_mfma_f32_32x32x16_bf16 v[96:111], a[172:175], v[168:171], v[96:111]
    v_mfma_f32_32x32x16_bf16 v[112:127], a[8:11], v[172:175], v[112:127]
    buffer_load_dwordx4 v[216:219], v1, s[4:7], s96 offen offset:3072 sc1
    s_add_u32 s96, s37, 13651968
    v_mfma_f32_32x32x16_bf16 v[96:111], a[12:15], v[172:175], v[96:111]
    v_mfma_f32_32x32x16_bf16 v[112:127], a[64:67], v[176:179], v[112:127]
    buffer_load_dwordx4 v[220:223], v1, s[4:7], s97 offen sc1
    v_mfma_f32_32x32x16_bf16 v[96:111], a[68:71], v[176:179], v[96:111]
    s_waitcnt vmcnt(0)
    buffer_wbl2 sc1
    s_waitcnt vmcnt(0)
    buffer_store_dword v18, v6, s[4:7], s42 offen offset:512 sc1
    v_mfma_f32_32x32x16_bf16 v[112:127], a[120:123], v[180:183], v[112:127]
    buffer_load_dwordx4 v[224:227], v1, s[4:7], s97 offen offset:1024 sc1
    v_mfma_f32_32x32x16_bf16 v[96:111], a[124:127], v[180:183], v[96:111]
    v_mfma_f32_32x32x16_bf16 v[112:127], a[176:179], v[184:187], v[112:127]
    buffer_load_dwordx4 v[228:231], v1, s[4:7], s97 offen offset:2048 sc1
    v_mfma_f32_32x32x16_bf16 v[96:111], a[180:183], v[184:187], v[96:111]
    v_mfma_f32_32x32x16_bf16 v[112:127], a[16:19], v[188:191], v[112:127]
    buffer_load_dwordx4 v[232:235], v1, s[4:7], s97 offen offset:3072 sc1
    s_add_u32 s97, s37, 13758464
    v_mfma_f32_32x32x16_bf16 v[96:111], a[20:23], v[188:191], v[96:111]
    v_mfma_f32_32x32x16_bf16 v[112:127], a[72:75], v[192:195], v[112:127]
    buffer_load_dwordx4 v[236:239], v1, s[4:7], s96 offen sc1
    v_mfma_f32_32x32x16_bf16 v[96:111], a[76:79], v[192:195], v[96:111]
    v_mfma_f32_32x32x16_bf16 v[112:127], a[128:131], v[196:199], v[112:127]
    buffer_load_dwordx4 v[240:243], v1, s[4:7], s96 offen offset:1024 sc1
    v_mfma_f32_32x32x16_bf16 v[96:111], a[132:135], v[196:199], v[96:111]
    v_mfma_f32_32x32x16_bf16 v[112:127], a[184:187], v[200:203], v[112:127]
    buffer_load_dwordx4 v[244:247], v1, s[4:7], s96 offen offset:2048 sc1
    v_mfma_f32_32x32x16_bf16 v[96:111], a[188:191], v[200:203], v[96:111]
    v_mfma_f32_32x32x16_bf16 v[64:79], a[24:27], v[204:207], v[64:79]
    buffer_load_dwordx4 v[248:251], v1, s[4:7], s96 offen offset:3072 sc1
    v_mfma_f32_32x32x16_bf16 v[80:95], a[28:31], v[204:207], v[80:95]
    v_mfma_f32_32x32x16_bf16 v[64:79], a[80:83], v[208:211], v[64:79]
    buffer_load_dwordx4 v[252:255], v1, s[4:7], s97 offen sc1
    v_mfma_f32_32x32x16_bf16 v[80:95], a[84:87], v[208:211], v[80:95]
    v_mfma_f32_32x32x16_bf16 v[64:79], a[136:139], v[212:215], v[64:79]
    buffer_load_dwordx4 a[236:239], v1, s[4:7], s97 offen offset:1024 sc1
    v_mfma_f32_32x32x16_bf16 v[80:95], a[140:143], v[212:215], v[80:95]
    v_mfma_f32_32x32x16_bf16 v[64:79], a[192:195], v[216:219], v[64:79]
    buffer_load_dwordx4 a[240:243], v1, s[4:7], s97 offen offset:2048 sc1
    v_mfma_f32_32x32x16_bf16 v[80:95], a[196:199], v[216:219], v[80:95]
    s_add_u32 s96, s37, 13656064
    v_mfma_f32_32x32x16_bf16 v[64:79], a[32:35], v[220:223], v[64:79]
    buffer_load_dwordx4 a[244:247], v1, s[4:7], s97 offen offset:3072 sc1
    s_add_u32 s97, s37, 13762560
    v_mfma_f32_32x32x16_bf16 v[80:95], a[36:39], v[220:223], v[80:95]
    s_waitcnt vmcnt(0)
    s_mov_b32 s49, 0
L_polll_100041:
    buffer_inv sc1
    s_waitcnt vmcnt(0)
    buffer_load_dword v17, v4, s[4:7], s43 offen offset:512 sc1
    s_add_u32 s49, s49, 1
    s_waitcnt vmcnt(0)
    v_cmp_ne_u32 vcc, s51, v17
    s_cmp_gt_u32 s49, 0x2000
    s_cbranch_scc1 L_pollb_100040
    s_cbranch_vccnz L_polll_100041
L_pollb_100040:
    buffer_inv sc1
    s_waitcnt vmcnt(0)
    v_mfma_f32_32x32x16_bf16 v[64:79], a[88:91], v[224:227], v[64:79]
    buffer_load_dwordx4 a[248:251], v1, s[4:7], s96 offen sc1
    v_mfma_f32_32x32x16_bf16 v[80:95], a[92:95], v[224:227], v[80:95]
    v_mfma_f32_32x32x16_bf16 v[64:79], a[144:147], v[228:231], v[64:79]
    buffer_load_dwordx4 a[252:255], v1, s[4:7], s96 offen offset:1024 sc1
    v_mfma_f32_32x32x16_bf16 v[80:95], a[148:151], v[228:231], v[80:95]
    v_mfma_f32_32x32x16_bf16 v[64:79], a[200:203], v[232:235], v[64:79]
    buffer_load_dwordx4 v[128:131], v1, s[4:7], s96 offen offset:2048 sc1
    v_mfma_f32_32x32x16_bf16 v[80:95], a[204:207], v[232:235], v[80:95]
    v_mfma_f32_32x32x16_bf16 v[64:79], a[40:43], v[236:239], v[64:79]
    buffer_load_dwordx4 v[132:135], v1, s[4:7], s96 offen offset:3072 sc1
    s_add_u32 s96, s37, 13766656
    v_mfma_f32_32x32x16_bf16 v[80:95], a[44:47], v[236:239], v[80:95]
    v_mfma_f32_32x32x16_bf16 v[64:79], a[96:99], v[240:243], v[64:79]
    buffer_load_dwordx4 v[136:139], v1, s[4:7], s97 offen sc1
    v_mfma_f32_32x32x16_bf16 v[80:95], a[100:103], v[240:243], v[80:95]
    v_mfma_f32_32x32x16_bf16 v[64:79], a[152:155], v[244:247], v[64:79]
    buffer_load_dwordx4 v[140:143], v1, s[4:7], s97 offen offset:1024 sc1
    v_mfma_f32_32x32x16_bf16 v[80:95], a[156:159], v[244:247], v[80:95]
    v_mfma_f32_32x32x16_bf16 v[64:79], a[208:211], v[248:251], v[64:79]
    buffer_load_dwordx4 v[144:147], v1, s[4:7], s97 offen offset:2048 sc1
    v_mfma_f32_32x32x16_bf16 v[80:95], a[212:215], v[248:251], v[80:95]
    v_mfma_f32_32x32x16_bf16 v[112:127], a[24:27], v[252:255], v[112:127]
    buffer_load_dwordx4 v[148:151], v1, s[4:7], s97 offen offset:3072 sc1
    s_add_u32 s97, s37, 13770752
    v_mfma_f32_32x32x16_bf16 v[96:111], a[28:31], v[252:255], v[96:111]
    v_mfma_f32_32x32x16_bf16 v[112:127], a[80:83], a[236:239], v[112:127]
    buffer_load_dwordx4 v[152:155], v1, s[4:7], s96 offen sc1
    v_mfma_f32_32x32x16_bf16 v[96:111], a[84:87], a[236:239], v[96:111]
    v_mfma_f32_32x32x16_bf16 v[112:127], a[136:139], a[240:243], v[112:127]
    buffer_load_dwordx4 v[156:159], v1, s[4:7], s96 offen offset:1024 sc1
    v_mfma_f32_32x32x16_bf16 v[96:111], a[140:143], a[240:243], v[96:111]
    v_mfma_f32_32x32x16_bf16 v[112:127], a[192:195], a[244:247], v[112:127]
    buffer_load_dwordx4 v[160:163], v1, s[4:7], s96 offen offset:2048 sc1
    v_mfma_f32_32x32x16_bf16 v[96:111], a[196:199], a[244:247], v[96:111]
    s_waitcnt vmcnt(10)
    v_mfma_f32_32x32x16_bf16 v[64:79], a[48:51], a[248:251], v[64:79]
    buffer_load_dwordx4 v[164:167], v1, s[4:7], s96 offen offset:3072 sc1
    v_mfma_f32_32x32x16_bf16 v[80:95], a[52:55], a[248:251], v[80:95]
    s_waitcnt vmcnt(10)
    v_mfma_f32_32x32x16_bf16 v[64:79], a[104:107], a[252:255], v[64:79]
    buffer_load_dwordx4 v[168:171], v1, s[4:7], s97 offen sc1
    v_mfma_f32_32x32x16_bf16 v[80:95], a[108:111], a[252:255], v[80:95]
    s_waitcnt vmcnt(10)
    v_mfma_f32_32x32x16_bf16 v[64:79], a[160:163], v[128:131], v[64:79]
    buffer_load_dwordx4 v[172:175], v1, s[4:7], s97 offen offset:1024 sc1
    v_mfma_f32_32x32x16_bf16 v[80:95], a[164:167], v[128:131], v[80:95]
    s_waitcnt vmcnt(10)
    v_mfma_f32_32x32x16_bf16 v[80:95], a[220:223], v[132:135], v[80:95]
    buffer_load_dwordx4 v[176:179], v1, s[4:7], s97 offen offset:2048 sc1
    v_mfma_f32_32x32x16_bf16 v[64:79], a[216:219], v[132:135], v[64:79]
    s_waitcnt vmcnt(10)
    v_mfma_f32_32x32x16_bf16 v[112:127], a[32:35], v[136:139], v[112:127]
    buffer_load_dwordx4 v[180:183], v1, s[4:7], s97 offen offset:3072 sc1
    v_mfma_f32_32x32x16_bf16 v[96:111], a[36:39], v[136:139], v[96:111]
    s_waitcnt vmcnt(10)
    v_mfma_f32_32x32x16_bf16 v[112:127], a[88:91], v[140:143], v[112:127]
    v_mfma_f32_32x32x16_bf16 v[96:111], a[92:95], v[140:143], v[96:111]
    s_waitcnt vmcnt(9)
    v_mfma_f32_32x32x16_bf16 v[112:127], a[144:147], v[144:147], v[112:127]
    s_nop 0
    ds_write_b128 v13, v[80:83] offset:0
    ds_write_b128 v13, v[84:87] offset:1024
    v_mfma_f32_32x32x16_bf16 v[96:111], a[148:151], v[144:147], v[96:111]
    ds_write_b128 v15, v[88:91] offset:0
    ds_write_b128 v15, v[92:95] offset:1024
    ds_write_b128 v14, v[72:75] offset:0
    s_waitcnt vmcnt(8)
    v_mfma_f32_32x32x16_bf16 v[112:127], a[200:203], v[148:151], v[112:127]
    ds_write_b128 v14, v[76:79] offset:1024
    v_mfma_f32_32x32x16_bf16 v[96:111], a[204:207], v[148:151], v[96:111]
    s_waitcnt lgkmcnt(0)
    s_barrier
    s_waitcnt vmcnt(7)
    v_mfma_f32_32x32x16_bf16 v[112:127], a[40:43], v[152:155], v[112:127]
    ds_read_b128 v[32:35], v16 offset:0
    ds_read_b128 v[36:39], v16 offset:1024
    ds_read_b128 v[40:43], v16 offset:2048
    ds_read_b128 v[44:47], v16 offset:3072
    ds_read_b128 v[48:51], v16 offset:4096
    v_mfma_f32_32x32x16_bf16 v[96:111], a[44:47], v[152:155], v[96:111]
    ds_read_b128 v[52:55], v16 offset:5120
    s_waitcnt vmcnt(6)
    v_mfma_f32_32x32x16_bf16 v[112:127], a[96:99], v[156:159], v[112:127]
    v_mfma_f32_32x32x16_bf16 v[96:111], a[100:103], v[156:159], v[96:111]
    s_waitcnt vmcnt(5)
    v_mfma_f32_32x32x16_bf16 v[112:127], a[152:155], v[160:163], v[112:127]
    s_waitcnt lgkmcnt(0)
    v_add_f32 v32, v32, v40
    v_add_f32 v33, v33, v41
    v_add_f32 v34, v34, v42
    v_add_f32 v35, v35, v43
    v_mfma_f32_32x32x16_bf16 v[96:111], a[156:159], v[160:163], v[96:111]
    v_add_f32 v36, v36, v44
    v_add_f32 v37, v37, v45
    v_add_f32 v38, v38, v46
    v_add_f32 v39, v39, v47
    v_add_f32 v64, v64, v48
    v_add_f32 v65, v65, v49
    s_waitcnt vmcnt(4)
    v_mfma_f32_32x32x16_bf16 v[112:127], a[208:211], v[164:167], v[112:127]
    v_add_f32 v66, v66, v50
    v_add_f32 v67, v67, v51
    v_add_f32 v68, v68, v52
    v_add_f32 v69, v69, v53
    v_add_f32 v70, v70, v54
    v_mfma_f32_32x32x16_bf16 v[96:111], a[212:215], v[164:167], v[96:111]
    v_add_f32 v71, v71, v55
    v_add_f32 v64, v64, v32
    v_add_f32 v65, v65, v33
    v_add_f32 v66, v66, v34
    v_add_f32 v67, v67, v35
    v_add_f32 v68, v68, v36
    s_waitcnt vmcnt(3)
    v_mfma_f32_32x32x16_bf16 v[112:127], a[48:51], v[168:171], v[112:127]
    v_add_f32 v69, v69, v37
    v_add_f32 v70, v70, v38
    v_add_f32 v71, v71, v39
    v_mul_f32 v64, s98, v64
    v_mul_f32 v65, s98, v65
    v_mfma_f32_32x32x16_bf16 v[96:111], a[52:55], v[168:171], v[96:111]
    v_mul_f32 v66, s98, v66
    v_mul_f32 v67, s98, v67
    v_mul_f32 v68, s98, v68
    v_mul_f32 v69, s98, v69
    v_mul_f32 v70, s98, v70
    v_mul_f32 v71, s98, v71
    s_waitcnt vmcnt(2)
    v_mfma_f32_32x32x16_bf16 v[112:127], a[104:107], v[172:175], v[112:127]
    s_barrier
    v_cvt_pk_bf16_f32 v32, v64, v65
    v_cvt_pk_bf16_f32 v33, v66, v67
    v_cvt_pk_bf16_f32 v34, v68, v69
    v_cvt_pk_bf16_f32 v35, v70, v71
    v_mfma_f32_32x32x16_bf16 v[96:111], a[108:111], v[172:175], v[96:111]
    s_add_u32 s46, s38, 1048576
    buffer_store_dwordx4 v[32:35], v1, s[4:7], s46 offen
    s_waitcnt vmcnt(2)
    v_mfma_f32_32x32x16_bf16 v[112:127], a[160:163], v[176:179], v[112:127]
    v_mfma_f32_32x32x16_bf16 v[96:111], a[164:167], v[176:179], v[96:111]
    s_waitcnt vmcnt(1)
    v_mfma_f32_32x32x16_bf16 v[96:111], a[220:223], v[180:183], v[96:111]
    v_mfma_f32_32x32x16_bf16 v[112:127], a[216:219], v[180:183], v[112:127]
    s_nop 10
    ds_write_b128 v13, v[96:99] offset:0
    ds_write_b128 v13, v[100:103] offset:1024
    ds_write_b128 v15, v[104:107] offset:0
    ds_write_b128 v15, v[108:111] offset:1024
    ds_write_b128 v14, v[120:123] offset:0
    ds_write_b128 v14, v[124:127] offset:1024
    s_waitcnt lgkmcnt(0)
    s_barrier
    ds_read_b128 v[32:35], v16 offset:0
    ds_read_b128 v[36:39], v16 offset:1024
    ds_read_b128 v[40:43], v16 offset:2048
    ds_read_b128 v[44:47], v16 offset:3072
    ds_read_b128 v[48:51], v16 offset:4096
    ds_read_b128 v[52:55], v16 offset:5120
    s_waitcnt lgkmcnt(0)
    v_pk_add_f32 v[32:33], v[32:33], v[40:41]
    v_pk_add_f32 v[34:35], v[34:35], v[42:43]
    v_pk_add_f32 v[36:37], v[36:37], v[44:45]
    v_pk_add_f32 v[38:39], v[38:39], v[46:47]
    v_pk_add_f32 v[112:113], v[112:113], v[48:49]
    v_pk_add_f32 v[114:115], v[114:115], v[50:51]
    v_pk_add_f32 v[116:117], v[116:117], v[52:53]
    v_pk_add_f32 v[118:119], v[118:119], v[54:55]
    v_pk_add_f32 v[112:113], v[112:113], v[32:33]
    v_pk_add_f32 v[114:115], v[114:115], v[34:35]
    v_pk_add_f32 v[116:117], v[116:117], v[36:37]
    v_pk_add_f32 v[118:119], v[118:119], v[38:39]
    v_pk_mul_f32 v[112:113], v[112:113], s[98:99]
    v_pk_mul_f32 v[114:115], v[114:115], s[98:99]
    v_pk_mul_f32 v[116:117], v[116:117], s[98:99]
    v_pk_mul_f32 v[118:119], v[118:119], s[98:99]
    v_cvt_pk_bf16_f32 v32, v112, v113
    v_cvt_pk_bf16_f32 v33, v114, v115
    v_cvt_pk_bf16_f32 v34, v116, v117
    v_cvt_pk_bf16_f32 v35, v118, v119
    s_add_u32 s46, s38, 1081344
    buffer_store_dwordx4 v[32:35], v1, s[4:7], s46 offen
    s_waitcnt vmcnt(0)
    buffer_wbl2 sc1
    s_waitcnt vmcnt(0)
    buffer_store_dword v18, v6, s[4:7], s44 offen sc1
    v_lshlrev_b32 v176, 16, v20
    v_and_b32 v177, s31, v20
    v_lshlrev_b32 v178, 16, v21
    v_and_b32 v179, s31, v21
    v_lshlrev_b32 v180, 16, v22
    v_and_b32 v181, s31, v22
    v_lshlrev_b32 v182, 16, v23
    v_and_b32 v183, s31, v23
    v_lshlrev_b32 v184, 16, v24
    v_and_b32 v185, s31, v24
    v_lshlrev_b32 v186, 16, v25
    v_and_b32 v187, s31, v25
    v_lshlrev_b32 v188, 16, v26
    v_and_b32 v189, s31, v26
    v_lshlrev_b32 v190, 16, v27
    v_and_b32 v191, s31, v27
    s_lshr_b32 s24, s18, 3
    s_mul_i32 s24, s24, 917504
    s_and_b32 s25, s18, 7
    s_lshl_b32 s25, s25, 17
    s_sub_u32 s24, s24, s25
    s_add_u32 s64, s24, 5242880
    s_waitcnt vmcnt(0)
    s_mov_b32 s49, 0
L_polll_100044:
    buffer_inv sc1
    s_waitcnt vmcnt(0)
    buffer_load_dword v17, v4, s[4:7], s45 offen sc1
    s_add_u32 s49, s49, 1
    s_waitcnt vmcnt(0)
    v_cmp_ne_u32 vcc, s51, v17
    s_cmp_gt_u32 s49, 0x2000
    s_cbranch_scc1 L_pollb_100043
    s_cbranch_vccnz L_polll_100044
L_pollb_100043:
    buffer_inv sc1
    s_waitcnt vmcnt(0)
    s_add_u32 s40, s40, 4096
    s_add_u32 s41, s41, 4096
    s_add_u32 s42, s42, 16384
    s_add_u32 s43, s43, 16384
    s_add_u32 s46, s34, 1048576
    s_add_u32 s47, s34, 1052672
    buffer_load_dwordx4 v[128:131], v7, s[4:7], s46 offen sc1
    buffer_load_dwordx4 v[132:135], v7, s[4:7], s47 offen sc1
    v_accvgpr_read_b32 v136, a224
    v_accvgpr_read_b32 v137, a225
    v_accvgpr_read_b32 v138, a226
    v_accvgpr_read_b32 v139, a227
    v_accvgpr_read_b32 v140, a228
    v_accvgpr_read_b32 v141, a229
    v_accvgpr_read_b32 v142, a230
    v_accvgpr_read_b32 v143, a231
    v_lshlrev_b32 v160, 16, v136
    v_and_b32 v161, s31, v136
    v_lshlrev_b32 v162, 16, v137
    v_and_b32 v163, s31, v137
    v_lshlrev_b32 v164, 16, v138
    v_and_b32 v165, s31, v138
    v_lshlrev_b32 v166, 16, v139
    v_and_b32 v167, s31, v139
    v_lshlrev_b32 v168, 16, v140
    v_and_b32 v169, s31, v140
    v_lshlrev_b32 v170, 16, v141
    v_and_b32 v171, s31, v141
    v_lshlrev_b32 v172, 16, v142
    v_and_b32 v173, s31, v142
    v_lshlrev_b32 v174, 16, v143
    v_and_b32 v175, s31, v143
    s_waitcnt vmcnt(0)
    v_lshlrev_b32 v144, 16, v128
    v_and_b32 v145, s31, v128
    v_lshlrev_b32 v146, 16, v129
    v_and_b32 v147, s31, v129
    v_lshlrev_b32 v148, 16, v130
    v_and_b32 v149, s31, v130
    v_lshlrev_b32 v150, 16, v131
    v_and_b32 v151, s31, v131
    v_lshlrev_b32 v152, 16, v132
    v_and_b32 v153, s31, v132
    v_lshlrev_b32 v154, 16, v133
    v_and_b32 v155, s31, v133
    v_lshlrev_b32 v156, 16, v134
    v_and_b32 v157, s31, v134
    v_lshlrev_b32 v158, 16, v135
    v_and_b32 v159, s31, v135
    v_pk_add_f32 v[144:145], v[144:145], v[176:177]
    v_pk_add_f32 v[146:147], v[146:147], v[178:179]
    v_pk_add_f32 v[148:149], v[148:149], v[180:181]
    v_pk_add_f32 v[150:151], v[150:151], v[182:183]
    v_pk_add_f32 v[152:153], v[152:153], v[184:185]
    v_pk_add_f32 v[154:155], v[154:155], v[186:187]
    v_pk_add_f32 v[156:157], v[156:157], v[188:189]
    v_pk_add_f32 v[158:159], v[158:159], v[190:191]
    v_cvt_pk_bf16_f32 v128, v144, v145
    v_cvt_pk_bf16_f32 v129, v146, v147
    v_cvt_pk_bf16_f32 v130, v148, v149
    v_cvt_pk_bf16_f32 v131, v150, v151
    v_cvt_pk_bf16_f32 v132, v152, v153
    v_cvt_pk_bf16_f32 v133, v154, v155
    v_cvt_pk_bf16_f32 v134, v156, v157
    v_cvt_pk_bf16_f32 v135, v158, v159
    v_lshlrev_b32 v144, 16, v128
    v_and_b32 v145, s31, v128
    v_lshlrev_b32 v146, 16, v129
    v_and_b32 v147, s31, v129
    v_lshlrev_b32 v148, 16, v130
    v_and_b32 v149, s31, v130
    v_lshlrev_b32 v150, 16, v131
    v_and_b32 v151, s31, v131
    v_lshlrev_b32 v152, 16, v132
    v_and_b32 v153, s31, v132
    v_lshlrev_b32 v154, 16, v133
    v_and_b32 v155, s31, v133
    v_lshlrev_b32 v156, 16, v134
    v_and_b32 v157, s31, v134
    v_lshlrev_b32 v158, 16, v135
    v_and_b32 v159, s31, v135
    v_pk_add_f32 v[192:193], v[144:145], v[146:147]
    v_pk_mul_f32 v[194:195], v[144:145], v[144:145]
    v_pk_fma_f32 v[194:195], v[146:147], v[146:147], v[194:195]
    v_pk_fma_f32 v[194:195], v[148:149], v[148:149], v[194:195]
    v_pk_add_f32 v[192:193], v[192:193], v[148:149]
    v_pk_fma_f32 v[194:195], v[150:151], v[150:151], v[194:195]
    v_pk_add_f32 v[192:193], v[192:193], v[150:151]
    v_pk_fma_f32 v[194:195], v[152:153], v[152:153], v[194:195]
    v_pk_add_f32 v[192:193], v[192:193], v[152:153]
    v_pk_fma_f32 v[194:195], v[154:155], v[154:155], v[194:195]
    v_pk_add_f32 v[192:193], v[192:193], v[154:155]
    v_pk_fma_f32 v[194:195], v[156:157], v[156:157], v[194:195]
    v_pk_add_f32 v[192:193], v[192:193], v[156:157]
    v_pk_fma_f32 v[194:195], v[158:159], v[158:159], v[194:195]
    v_pk_add_f32 v[192:193], v[192:193], v[158:159]
    v_add_f32 v192, v192, v193
    v_add_f32 v194, v194, v195
    s_nop 1
    v_permlane16_swap_b32 v192, v194
    v_add_f32 v192, v192, v194
    s_nop 1
    v_add_f32_dpp v192, v192, v192 row_ror:8 row_mask:0xf bank_mask:0xf
    v_mov_b32 v193, v192
    s_nop 1
    v_permlane32_swap_b32 v192, v193
    v_add_f32 v192, v192, v193
    s_mov_b64 exec, 0x00ff00ff
    ds_write_b32 v11, v192 offset:0
    s_mov_b64 exec, -1
    s_waitcnt lgkmcnt(0)
    s_barrier
    ds_read_b128 v[196:199], v12 offset:0
    ds_read_b128 v[200:203], v12 offset:16
    s_waitcnt lgkmcnt(0)
    v_pk_add_f32 v[196:197], v[196:197], v[198:199]
    v_pk_add_f32 v[200:201], v[200:201], v[202:203]
    v_pk_add_f32 v[196:197], v[196:197], v[200:201]
    v_mul_f32 v196, 0x3b000000, v196
    v_mul_f32 v197, 0x3b000000, v197
    v_fma_f32 v197, -v196, v196, v197
    v_max_f32 v197, 0, v197
    v_add_f32 v197, 0x3727c5ac, v197
    v_rsq_f32 v204, v197
    s_nop 0
    v_mul_f32_e64 v206, -v196, v204
    v_pk_fma_f32 v[176:177], v[144:145], v[204:205], v[206:207] op_sel_hi:[1,0,0]
    v_pk_fma_f32 v[178:179], v[146:147], v[204:205], v[206:207] op_sel_hi:[1,0,0]
    v_pk_fma_f32 v[180:181], v[148:149], v[204:205], v[206:207] op_sel_hi:[1,0,0]
    v_pk_fma_f32 v[182:183], v[150:151], v[204:205], v[206:207] op_sel_hi:[1,0,0]
    v_pk_fma_f32 v[184:185], v[152:153], v[204:205], v[206:207] op_sel_hi:[1,0,0]
    v_pk_fma_f32 v[186:187], v[154:155], v[204:205], v[206:207] op_sel_hi:[1,0,0]
    v_pk_fma_f32 v[188:189], v[156:157], v[204:205], v[206:207] op_sel_hi:[1,0,0]
    v_pk_fma_f32 v[190:191], v[158:159], v[204:205], v[206:207] op_sel_hi:[1,0,0]
    v_pk_fma_f32 v[144:145], v[176:177], v[160:161], v[144:145]
    v_pk_fma_f32 v[146:147], v[178:179], v[162:163], v[146:147]
    v_pk_fma_f32 v[148:149], v[180:181], v[164:165], v[148:149]
    v_pk_fma_f32 v[150:151], v[182:183], v[166:167], v[150:151]
    v_pk_fma_f32 v[152:153], v[184:185], v[168:169], v[152:153]
    v_pk_fma_f32 v[154:155], v[186:187], v[170:171], v[154:155]
    v_pk_fma_f32 v[156:157], v[188:189], v[172:173], v[156:157]
    v_pk_fma_f32 v[158:159], v[190:191], v[174:175], v[158:159]
    v_pk_add_f32 v[192:193], v[144:145], v[146:147]
    v_pk_mul_f32 v[194:195], v[144:145], v[144:145]
    v_pk_fma_f32 v[194:195], v[146:147], v[146:147], v[194:195]
    v_pk_fma_f32 v[194:195], v[148:149], v[148:149], v[194:195]
    v_pk_add_f32 v[192:193], v[192:193], v[148:149]
    v_pk_fma_f32 v[194:195], v[150:151], v[150:151], v[194:195]
    v_pk_add_f32 v[192:193], v[192:193], v[150:151]
    v_pk_fma_f32 v[194:195], v[152:153], v[152:153], v[194:195]
    v_pk_add_f32 v[192:193], v[192:193], v[152:153]
    v_pk_fma_f32 v[194:195], v[154:155], v[154:155], v[194:195]
    v_pk_add_f32 v[192:193], v[192:193], v[154:155]
    v_pk_fma_f32 v[194:195], v[156:157], v[156:157], v[194:195]
    v_pk_add_f32 v[192:193], v[192:193], v[156:157]
    v_pk_fma_f32 v[194:195], v[158:159], v[158:159], v[194:195]
    v_pk_add_f32 v[192:193], v[192:193], v[158:159]
    v_add_f32 v192, v192, v193
    v_add_f32 v194, v194, v195
    s_nop 1
    v_permlane16_swap_b32 v192, v194
    v_add_f32 v192, v192, v194
    s_nop 1
    v_add_f32_dpp v192, v192, v192 row_ror:8 row_mask:0xf bank_mask:0xf
    v_mov_b32 v193, v192
    s_nop 1
    v_permlane32_swap_b32 v192, v193
    v_add_f32 v192, v192, v193
    s_mov_b64 exec, 0x00ff00ff
    ds_write_b32 v11, v192 offset:256
    s_mov_b64 exec, -1
    s_waitcnt lgkmcnt(0)
    s_barrier
    ds_read_b128 v[196:199], v12 offset:256
    ds_read_b128 v[200:203], v12 offset:272
    s_waitcnt lgkmcnt(0)
    v_pk_add_f32 v[196:197], v[196:197], v[198:199]
    v_pk_add_f32 v[200:201], v[200:201], v[202:203]
    v_pk_add_f32 v[196:197], v[196:197], v[200:201]
    v_mul_f32 v196, 0x3b000000, v196
    v_mul_f32 v197, 0x3b000000, v197
    v_fma_f32 v197, -v196, v196, v197
    v_max_f32 v197, 0, v197
    v_add_f32 v197, 0x3727c5ac, v197
    v_rsq_f32 v204, v197
    s_nop 0
    v_mul_f32 v204, 0x3fb8aa3b, v204
    v_mul_f32_e64 v206, -v196, v204
    v_pk_fma_f32 v[176:177], v[144:145], v[204:205], v[206:207] op_sel_hi:[1,0,0]
    v_pk_fma_f32 v[178:179], v[146:147], v[204:205], v[206:207] op_sel_hi:[1,0,0]
    v_pk_fma_f32 v[180:181], v[148:149], v[204:205], v[206:207] op_sel_hi:[1,0,0]
    v_pk_fma_f32 v[182:183], v[150:151], v[204:205], v[206:207] op_sel_hi:[1,0,0]
    v_pk_fma_f32 v[184:185], v[152:153], v[204:205], v[206:207] op_sel_hi:[1,0,0]
    v_pk_fma_f32 v[186:187], v[154:155], v[204:205], v[206:207] op_sel_hi:[1,0,0]
    v_pk_fma_f32 v[188:189], v[156:157], v[204:205], v[206:207] op_sel_hi:[1,0,0]
    v_pk_fma_f32 v[190:191], v[158:159], v[204:205], v[206:207] op_sel_hi:[1,0,0]
    v_cvt_pk_bf16_f32 v216, v176, v177
    v_cvt_pk_bf16_f32 v217, v178, v179
    v_cvt_pk_bf16_f32 v218, v180, v181
    v_cvt_pk_bf16_f32 v219, v182, v183
    v_cvt_pk_bf16_f32 v220, v184, v185
    v_cvt_pk_bf16_f32 v221, v186, v187
    v_cvt_pk_bf16_f32 v222, v188, v189
    v_cvt_pk_bf16_f32 v223, v190, v191
    s_add_u32 s46, s34, 1048576
    s_add_u32 s47, s34, 1052672
    buffer_store_dwordx4 v[216:219], v7, s[4:7], s46 offen
    buffer_store_dwordx4 v[220:223], v7, s[4:7], s47 offen
    v_cvt_pk_bf16_f32 v208, v144, v145
    v_cvt_pk_bf16_f32 v209, v146, v147
    v_cvt_pk_bf16_f32 v210, v148, v149
    v_cvt_pk_bf16_f32 v211, v150, v151
    v_cvt_pk_bf16_f32 v212, v152, v153
    v_cvt_pk_bf16_f32 v213, v154, v155
    v_cvt_pk_bf16_f32 v214, v156, v157
    v_cvt_pk_bf16_f32 v215, v158, v159
    v_accvgpr_write_b32 a224, v208
    v_accvgpr_write_b32 a225, v209
    v_accvgpr_write_b32 a226, v210
    v_accvgpr_write_b32 a227, v211
    v_accvgpr_write_b32 a228, v212
    v_accvgpr_write_b32 a229, v213
    v_accvgpr_write_b32 a230, v214
    v_accvgpr_write_b32 a231, v215
    s_waitcnt vmcnt(0)
    buffer_wbl2 sc1
    s_waitcnt vmcnt(0)
    buffer_store_dword v18, v6, s[4:7], s40 offen sc1
    s_barrier
    s_waitcnt vmcnt(0)
    s_mov_b32 s49, 0
L_polll_100047:
    buffer_inv sc1
    s_waitcnt vmcnt(0)
    buffer_load_dword v17, v5, s[4:7], s41 offen sc1
    s_add_u32 s49, s49, 1
    s_waitcnt vmcnt(0)
    v_cmp_ne_u32 vcc, s51, v17
    s_cmp_gt_u32 s49, 0x2000
    s_cbranch_scc1 L_pollb_100046
    s_cbranch_vccnz L_polll_100047
L_pollb_100046:
    buffer_inv sc1
    s_waitcnt vmcnt(0)
    s_add_u32 s3, s35, 1048576
    buffer_load_dwordx4 v[128:131], v1, s[4:7], s3 offen sc1
    buffer_load_dwordx4 v[132:135], v1, s[4:7], s3 offen offset:1024 sc1
    buffer_load_dwordx4 v[136:139], v1, s[4:7], s3 offen offset:2048 sc1
    buffer_load_dwordx4 v[140:143], v1, s[4:7], s3 offen offset:3072 sc1
    s_add_u32 s3, s35, 1052672
    buffer_load_dwordx4 v[144:147], v1, s[4:7], s3 offen sc1
    s_waitcnt vmcnt(4)
    ds_read_b128 v[32:35], v2 offset:0
    ds_read_b128 v[36:39], v2 offset:32768
    ds_read_b128 v[40:43], v3 offset:0
    ds_read_b128 v[44:47], v2 offset:1024
    ds_read_b128 v[48:51], v2 offset:33792
    ds_read_b128 v[52:55], v3 offset:1024
    s_waitcnt lgkmcnt(4)
    v_mfma_f32_32x32x16_bf16 v[64:79], v[32:35], v[128:131], 0
    ds_read_b128 v[56:59], v2 offset:2048
    buffer_load_dwordx4 v[148:151], v1, s[4:7], s3 offen offset:1024 sc1
    v_mfma_f32_32x32x16_bf16 v[80:95], v[36:39], v[128:131], 0
    ds_read_b128 v[60:63], v2 offset:34816
    s_waitcnt lgkmcnt(4)
    v_mfma_f32_32x32x16_bf16 v[96:111], v[40:43], v[128:131], 0
    ds_read_b128 v[32:35], v3 offset:2048
    buffer_load_dwordx4 v[152:155], v1, s[4:7], s3 offen offset:2048 sc1
    s_waitcnt vmcnt(5)
    v_mfma_f32_32x32x16_bf16 v[64:79], v[44:47], v[132:135], v[64:79]
    ds_read_b128 v[36:39], v2 offset:3072
    s_waitcnt lgkmcnt(4)
    v_mfma_f32_32x32x16_bf16 v[80:95], v[48:51], v[132:135], v[80:95]
    ds_read_b128 v[40:43], v2 offset:35840
    buffer_load_dwordx4 v[156:159], v1, s[4:7], s3 offen offset:3072 sc1
    v_mfma_f32_32x32x16_bf16 v[96:111], v[52:55], v[132:135], v[96:111]
    ds_read_b128 v[44:47], v3 offset:3072
    s_waitcnt vmcnt(5)
    s_waitcnt lgkmcnt(4)
    v_mfma_f32_32x32x16_bf16 v[64:79], v[56:59], v[136:139], v[64:79]
    ds_read_b128 v[48:51], v2 offset:4096
    s_add_u32 s3, s35, 1056768
    v_mfma_f32_32x32x16_bf16 v[80:95], v[60:63], v[136:139], v[80:95]
    ds_read_b128 v[52:55], v2 offset:36864
    buffer_load_dwordx4 v[160:163], v1, s[4:7], s3 offen sc1
    s_waitcnt lgkmcnt(4)
    v_mfma_f32_32x32x16_bf16 v[96:111], v[32:35], v[136:139], v[96:111]
    ds_read_b128 v[56:59], v3 offset:4096
    s_waitcnt vmcnt(5)
    v_mfma_f32_32x32x16_bf16 v[64:79], v[36:39], v[140:143], v[64:79]
    ds_read_b128 v[60:63], v2 offset:5120
    buffer_load_dwordx4 v[164:167], v1, s[4:7], s3 offen offset:1024 sc1
    s_waitcnt lgkmcnt(4)
    v_mfma_f32_32x32x16_bf16 v[80:95], v[40:43], v[140:143], v[80:95]
    ds_read_b128 v[32:35], v2 offset:37888
    v_mfma_f32_32x32x16_bf16 v[96:111], v[44:47], v[140:143], v[96:111]
    ds_read_b128 v[36:39], v3 offset:5120
    buffer_load_dwordx4 v[168:171], v1, s[4:7], s3 offen offset:2048 sc1
    s_waitcnt vmcnt(6)
    s_waitcnt lgkmcnt(4)
    v_mfma_f32_32x32x16_bf16 v[64:79], v[48:51], v[144:147], v[64:79]
    ds_read_b128 v[40:43], v2 offset:6144
    v_mfma_f32_32x32x16_bf16 v[80:95], v[52:55], v[144:147], v[80:95]
    ds_read_b128 v[44:47], v2 offset:38912
    buffer_load_dwordx4 v[172:175], v1, s[4:7], s3 offen offset:3072 sc1
    s_waitcnt lgkmcnt(4)
    v_mfma_f32_32x32x16_bf16 v[96:111], v[56:59], v[144:147], v[96:111]
    ds_read_b128 v[48:51], v3 offset:6144
    s_add_u32 s3, s35, 1060864
    s_waitcnt vmcnt(6)
    v_mfma_f32_32x32x16_bf16 v[64:79], v[60:63], v[148:151], v[64:79]
    ds_read_b128 v[52:55], v2 offset:7168
    buffer_load_dwordx4 v[176:179], v1, s[4:7], s3 offen sc1
    s_waitcnt lgkmcnt(4)
    v_mfma_f32_32x32x16_bf16 v[80:95], v[32:35], v[148:151], v[80:95]
    ds_read_b128 v[56:59], v2 offset:39936
    v_mfma_f32_32x32x16_bf16 v[96:111], v[36:39], v[148:151], v[96:111]
    ds_read_b128 v[60:63], v3 offset:7168
    buffer_load_dwordx4 v[180:183], v1, s[4:7], s3 offen offset:1024 sc1
    s_waitcnt vmcnt(7)
    s_waitcnt lgkmcnt(4)
    v_mfma_f32_32x32x16_bf16 v[64:79], v[40:43], v[152:155], v[64:79]
    ds_read_b128 v[32:35], v2 offset:8192
    v_mfma_f32_32x32x16_bf16 v[80:95], v[44:47], v[152:155], v[80:95]
    ds_read_b128 v[36:39], v2 offset:40960
    buffer_load_dwordx4 v[184:187], v1, s[4:7], s3 offen offset:2048 sc1
    s_waitcnt lgkmcnt(4)
    v_mfma_f32_32x32x16_bf16 v[96:111], v[48:51], v[152:155], v[96:111]
    ds_read_b128 v[40:43], v3 offset:8192
    s_waitcnt vmcnt(7)
    v_mfma_f32_32x32x16_bf16 v[64:79], v[52:55], v[156:159], v[64:79]
    ds_read_b128 v[44:47], v2 offset:9216
    buffer_load_dwordx4 v[188:191], v1, s[4:7], s3 offen offset:3072 sc1
    s_waitcnt lgkmcnt(4)
    v_mfma_f32_32x32x16_bf16 v[80:95], v[56:59], v[156:159], v[80:95]
    ds_read_b128 v[48:51], v2 offset:41984
    s_add_u32 s3, s35, 1064960
    v_mfma_f32_32x32x16_bf16 v[96:111], v[60:63], v[156:159], v[96:111]
    ds_read_b128 v[52:55], v3 offset:9216
    buffer_load_dwordx4 v[192:195], v1, s[4:7], s3 offen sc1
    s_waitcnt vmcnt(8)
    s_waitcnt lgkmcnt(4)
    v_mfma_f32_32x32x16_bf16 v[64:79], v[32:35], v[160:163], v[64:79]
    ds_read_b128 v[56:59], v2 offset:10240
    v_mfma_f32_32x32x16_bf16 v[80:95], v[36:39], v[160:163], v[80:95]
    ds_read_b128 v[60:63], v2 offset:43008
    buffer_load_dwordx4 v[196:199], v1, s[4:7], s3 offen offset:1024 sc1
    s_waitcnt lgkmcnt(4)
    v_mfma_f32_32x32x16_bf16 v[96:111], v[40:43], v[160:163], v[96:111]
    ds_read_b128 v[32:35], v3 offset:10240
    s_waitcnt vmcnt(8)
    v_mfma_f32_32x32x16_bf16 v[64:79], v[44:47], v[164:167], v[64:79]
    ds_read_b128 v[36:39], v2 offset:11264
    buffer_load_dwordx4 v[200:203], v1, s[4:7], s3 offen offset:2048 sc1
    s_waitcnt lgkmcnt(4)
    v_mfma_f32_32x32x16_bf16 v[80:95], v[48:51], v[164:167], v[80:95]
    ds_read_b128 v[40:43], v2 offset:44032
    v_mfma_f32_32x32x16_bf16 v[96:111], v[52:55], v[164:167], v[96:111]
    ds_read_b128 v[44:47], v3 offset:11264
    buffer_load_dwordx4 v[204:207], v1, s[4:7], s3 offen offset:3072 sc1
    s_waitcnt vmcnt(9)
    s_waitcnt lgkmcnt(4)
    v_mfma_f32_32x32x16_bf16 v[64:79], v[56:59], v[168:171], v[64:79]
    ds_read_b128 v[48:51], v2 offset:12288
    s_add_u32 s3, s35, 1069056
    v_mfma_f32_32x32x16_bf16 v[80:95], v[60:63], v[168:171], v[80:95]
    ds_read_b128 v[52:55], v2 offset:45056
    buffer_load_dwordx4 v[208:211], v1, s[4:7], s3 offen sc1
    s_waitcnt lgkmcnt(4)
    v_mfma_f32_32x32x16_bf16 v[96:111], v[32:35], v[168:171], v[96:111]
    ds_read_b128 v[56:59], v3 offset:12288
    s_waitcnt vmcnt(9)
    v_mfma_f32_32x32x16_bf16 v[64:79], v[36:39], v[172:175], v[64:79]
    ds_read_b128 v[60:63], v2 offset:13312
    buffer_load_dwordx4 v[212:215], v1, s[4:7], s3 offen offset:1024 sc1
    s_waitcnt lgkmcnt(4)
    v_mfma_f32_32x32x16_bf16 v[80:95], v[40:43], v[172:175], v[80:95]
    ds_read_b128 v[32:35], v2 offset:46080
    v_mfma_f32_32x32x16_bf16 v[96:111], v[44:47], v[172:175], v[96:111]
    ds_read_b128 v[36:39], v3 offset:13312
    buffer_load_dwordx4 v[216:219], v1, s[4:7], s3 offen offset:2048 sc1
    s_waitcnt vmcnt(10)
    s_waitcnt lgkmcnt(4)
    v_mfma_f32_32x32x16_bf16 v[64:79], v[48:51], v[176:179], v[64:79]
    ds_read_b128 v[40:43], v2 offset:14336
    v_mfma_f32_32x32x16_bf16 v[80:95], v[52:55], v[176:179], v[80:95]
    ds_read_b128 v[44:47], v2 offset:47104
    buffer_load_dwordx4 v[220:223], v1, s[4:7], s3 offen offset:3072 sc1
    s_waitcnt lgkmcnt(4)
    v_mfma_f32_32x32x16_bf16 v[96:111], v[56:59], v[176:179], v[96:111]
    ds_read_b128 v[48:51], v3 offset:14336
    s_add_u32 s3, s35, 1073152
    s_waitcnt vmcnt(10)
    v_mfma_f32_32x32x16_bf16 v[64:79], v[60:63], v[180:183], v[64:79]
    ds_read_b128 v[52:55], v2 offset:15360
    buffer_load_dwordx4 v[224:227], v1, s[4:7], s3 offen sc1
    s_waitcnt lgkmcnt(4)
    v_mfma_f32_32x32x16_bf16 v[80:95], v[32:35], v[180:183], v[80:95]
    ds_read_b128 v[56:59], v2 offset:48128
    v_mfma_f32_32x32x16_bf16 v[96:111], v[36:39], v[180:183], v[96:111]
    ds_read_b128 v[60:63], v3 offset:15360
    buffer_load_dwordx4 v[228:231], v1, s[4:7], s3 offen offset:1024 sc1
    s_waitcnt vmcnt(11)
    s_waitcnt lgkmcnt(4)
    v_mfma_f32_32x32x16_bf16 v[64:79], v[40:43], v[184:187], v[64:79]
    ds_read_b128 v[32:35], v2 offset:16384
    v_mfma_f32_32x32x16_bf16 v[80:95], v[44:47], v[184:187], v[80:95]
    ds_read_b128 v[36:39], v2 offset:49152
    buffer_load_dwordx4 v[232:235], v1, s[4:7], s3 offen offset:2048 sc1
    s_waitcnt lgkmcnt(4)
    v_mfma_f32_32x32x16_bf16 v[96:111], v[48:51], v[184:187], v[96:111]
    ds_read_b128 v[40:43], v3 offset:16384
    s_waitcnt vmcnt(11)
    v_mfma_f32_32x32x16_bf16 v[64:79], v[52:55], v[188:191], v[64:79]
    ds_read_b128 v[44:47], v2 offset:17408
    buffer_load_dwordx4 v[236:239], v1, s[4:7], s3 offen offset:3072 sc1
    s_waitcnt lgkmcnt(4)
    v_mfma_f32_32x32x16_bf16 v[80:95], v[56:59], v[188:191], v[80:95]
    ds_read_b128 v[48:51], v2 offset:50176
    s_add_u32 s3, s35, 1077248
    v_mfma_f32_32x32x16_bf16 v[96:111], v[60:63], v[188:191], v[96:111]
    ds_read_b128 v[52:55], v3 offset:17408
    buffer_load_dwordx4 v[240:243], v1, s[4:7], s3 offen sc1
    s_waitcnt vmcnt(12)
    s_waitcnt lgkmcnt(4)
    v_mfma_f32_32x32x16_bf16 v[64:79], v[32:35], v[192:195], v[64:79]
    ds_read_b128 v[56:59], v2 offset:18432
    v_mfma_f32_32x32x16_bf16 v[80:95], v[36:39], v[192:195], v[80:95]
    ds_read_b128 v[60:63], v2 offset:51200
    buffer_load_dwordx4 v[244:247], v1, s[4:7], s3 offen offset:1024 sc1
    s_waitcnt lgkmcnt(4)
    v_mfma_f32_32x32x16_bf16 v[96:111], v[40:43], v[192:195], v[96:111]
    ds_read_b128 v[32:35], v3 offset:18432
    s_waitcnt vmcnt(12)
    v_mfma_f32_32x32x16_bf16 v[64:79], v[44:47], v[196:199], v[64:79]
    ds_read_b128 v[36:39], v2 offset:19456
    buffer_load_dwordx4 v[248:251], v1, s[4:7], s3 offen offset:2048 sc1
    s_waitcnt lgkmcnt(4)
    v_mfma_f32_32x32x16_bf16 v[80:95], v[48:51], v[196:199], v[80:95]
    ds_read_b128 v[40:43], v2 offset:52224
    v_mfma_f32_32x32x16_bf16 v[96:111], v[52:55], v[196:199], v[96:111]
    ds_read_b128 v[44:47], v3 offset:19456
    buffer_load_dwordx4 v[252:255], v1, s[4:7], s3 offen offset:3072 sc1
    s_waitcnt vmcnt(13)
    s_waitcnt lgkmcnt(4)
    v_mfma_f32_32x32x16_bf16 v[64:79], v[56:59], v[200:203], v[64:79]
    ds_read_b128 v[48:51], v2 offset:20480
    s_add_u32 s3, s34, s64
    v_mfma_f32_32x32x16_bf16 v[80:95], v[60:63], v[200:203], v[80:95]
    ds_read_b128 v[52:55], v2 offset:53248
    buffer_store_dwordx4 a[224:227], v7, s[4:7], s3 offen sc1
    s_add_u32 s3, s3, 4096
    s_waitcnt lgkmcnt(4)
    v_mfma_f32_32x32x16_bf16 v[96:111], v[32:35], v[200:203], v[96:111]
    ds_read_b128 v[56:59], v3 offset:20480
    s_waitcnt vmcnt(13)
    v_mfma_f32_32x32x16_bf16 v[64:79], v[36:39], v[204:207], v[64:79]
    ds_read_b128 v[60:63], v2 offset:21504
    buffer_store_dwordx4 a[228:231], v7, s[4:7], s3 offen sc1
    s_waitcnt lgkmcnt(4)
    v_mfma_f32_32x32x16_bf16 v[80:95], v[40:43], v[204:207], v[80:95]
    ds_read_b128 v[32:35], v2 offset:54272
    s_add_u32 m0, s23, 32768
    s_add_u32 s50, s39, 131072
    v_mfma_f32_32x32x16_bf16 v[96:111], v[44:47], v[204:207], v[96:111]
    ds_read_b128 v[36:39], v3 offset:21504
    buffer_load_dwordx4 v1, s[4:7], s50 offen lds
    s_waitcnt vmcnt(14)
    s_waitcnt lgkmcnt(4)
    v_mfma_f32_32x32x16_bf16 v[64:79], v[48:51], v[208:211], v[64:79]
    ds_read_b128 v[40:43], v2 offset:22528
    v_mfma_f32_32x32x16_bf16 v[80:95], v[52:55], v[208:211], v[80:95]
    ds_read_b128 v[44:47], v2 offset:55296
    buffer_load_dwordx4 v1, s[4:7], s50 offen offset:1024 lds
    s_waitcnt lgkmcnt(4)
    v_mfma_f32_32x32x16_bf16 v[96:111], v[56:59], v[208:211], v[96:111]
    ds_read_b128 v[48:51], v3 offset:22528
    s_waitcnt vmcnt(14)
    v_mfma_f32_32x32x16_bf16 v[64:79], v[60:63], v[212:215], v[64:79]
    ds_read_b128 v[52:55], v2 offset:23552
    buffer_load_dwordx4 v1, s[4:7], s50 offen offset:2048 lds
    s_waitcnt lgkmcnt(4)
    v_mfma_f32_32x32x16_bf16 v[80:95], v[32:35], v[212:215], v[80:95]
    ds_read_b128 v[56:59], v2 offset:56320
    v_mfma_f32_32x32x16_bf16 v[96:111], v[36:39], v[212:215], v[96:111]
    ds_read_b128 v[60:63], v3 offset:23552
    buffer_load_dwordx4 v1, s[4:7], s50 offen offset:3072 lds
    s_add_u32 m0, s23, 36864
    s_add_u32 s50, s39, 135168
    s_waitcnt vmcnt(15)
    s_waitcnt lgkmcnt(4)
    v_mfma_f32_32x32x16_bf16 v[64:79], v[40:43], v[216:219], v[64:79]
    ds_read_b128 v[32:35], v2 offset:24576
    v_mfma_f32_32x32x16_bf16 v[80:95], v[44:47], v[216:219], v[80:95]
    ds_read_b128 v[36:39], v2 offset:57344
    buffer_load_dwordx4 v1, s[4:7], s50 offen lds
    s_waitcnt lgkmcnt(4)
    v_mfma_f32_32x32x16_bf16 v[96:111], v[48:51], v[216:219], v[96:111]
    ds_read_b128 v[40:43], v3 offset:24576
    s_waitcnt vmcnt(15)
    v_mfma_f32_32x32x16_bf16 v[64:79], v[52:55], v[220:223], v[64:79]
    ds_read_b128 v[44:47], v2 offset:25600
    buffer_load_dwordx4 v1, s[4:7], s50 offen offset:1024 lds
    s_waitcnt lgkmcnt(4)
    v_mfma_f32_32x32x16_bf16 v[80:95], v[56:59], v[220:223], v[80:95]
    ds_read_b128 v[48:51], v2 offset:58368
    v_mfma_f32_32x32x16_bf16 v[96:111], v[60:63], v[220:223], v[96:111]
    ds_read_b128 v[52:55], v3 offset:25600
    buffer_load_dwordx4 v1, s[4:7], s50 offen offset:2048 lds
    s_waitcnt vmcnt(16)
    s_waitcnt lgkmcnt(4)
    v_mfma_f32_32x32x16_bf16 v[64:79], v[32:35], v[224:227], v[64:79]
    ds_read_b128 v[56:59], v2 offset:26624
    v_mfma_f32_32x32x16_bf16 v[80:95], v[36:39], v[224:227], v[80:95]
    ds_read_b128 v[60:63], v2 offset:59392
    buffer_load_dwordx4 v1, s[4:7], s50 offen offset:3072 lds
    s_waitcnt lgkmcnt(4)
    v_mfma_f32_32x32x16_bf16 v[96:111], v[40:43], v[224:227], v[96:111]
    ds_read_b128 v[32:35], v3 offset:26624
    s_waitcnt vmcnt(16)
    v_mfma_f32_32x32x16_bf16 v[64:79], v[44:47], v[228:231], v[64:79]
    ds_read_b128 v[36:39], v2 offset:27648
    s_waitcnt lgkmcnt(4)
    v_mfma_f32_32x32x16_bf16 v[80:95], v[48:51], v[228:231], v[80:95]
    ds_read_b128 v[40:43], v2 offset:60416
    v_mfma_f32_32x32x16_bf16 v[96:111], v[52:55], v[228:231], v[96:111]
    ds_read_b128 v[44:47], v3 offset:27648
    s_waitcnt vmcnt(15)
    s_waitcnt lgkmcnt(4)
    v_mfma_f32_32x32x16_bf16 v[64:79], v[56:59], v[232:235], v[64:79]
    ds_read_b128 v[48:51], v2 offset:28672
    v_mfma_f32_32x32x16_bf16 v[80:95], v[60:63], v[232:235], v[80:95]
    ds_read_b128 v[52:55], v2 offset:61440
    s_waitcnt lgkmcnt(4)
    v_mfma_f32_32x32x16_bf16 v[96:111], v[32:35], v[232:235], v[96:111]
    ds_read_b128 v[56:59], v3 offset:28672
    s_waitcnt vmcnt(14)
    v_mfma_f32_32x32x16_bf16 v[64:79], v[36:39], v[236:239], v[64:79]
    ds_read_b128 v[60:63], v2 offset:29696
    s_waitcnt lgkmcnt(4)
    v_mfma_f32_32x32x16_bf16 v[80:95], v[40:43], v[236:239], v[80:95]
    ds_read_b128 v[32:35], v2 offset:62464
    v_mfma_f32_32x32x16_bf16 v[96:111], v[44:47], v[236:239], v[96:111]
    ds_read_b128 v[36:39], v3 offset:29696
    s_waitcnt vmcnt(13)
    s_waitcnt lgkmcnt(4)
    v_mfma_f32_32x32x16_bf16 v[64:79], v[48:51], v[240:243], v[64:79]
    ds_read_b128 v[40:43], v2 offset:30720
    v_mfma_f32_32x32x16_bf16 v[80:95], v[52:55], v[240:243], v[80:95]
    ds_read_b128 v[44:47], v2 offset:63488
    s_waitcnt lgkmcnt(4)
    v_mfma_f32_32x32x16_bf16 v[96:111], v[56:59], v[240:243], v[96:111]
    ds_read_b128 v[48:51], v3 offset:30720
    s_waitcnt vmcnt(12)
    v_mfma_f32_32x32x16_bf16 v[64:79], v[60:63], v[244:247], v[64:79]
    ds_read_b128 v[52:55], v2 offset:31744
    s_waitcnt lgkmcnt(4)
    v_mfma_f32_32x32x16_bf16 v[80:95], v[32:35], v[244:247], v[80:95]
    ds_read_b128 v[56:59], v2 offset:64512
    v_mfma_f32_32x32x16_bf16 v[96:111], v[36:39], v[244:247], v[96:111]
    ds_read_b128 v[60:63], v3 offset:31744
    s_waitcnt vmcnt(11)
    s_waitcnt lgkmcnt(4)
    v_mfma_f32_32x32x16_bf16 v[64:79], v[40:43], v[248:251], v[64:79]
    ds_read_b128 v[32:35], v1 offset:0
    v_mfma_f32_32x32x16_bf16 v[80:95], v[44:47], v[248:251], v[80:95]
    ds_read_b128 v[36:39], v1 offset:1024
    s_waitcnt lgkmcnt(4)
    v_mfma_f32_32x32x16_bf16 v[96:111], v[48:51], v[248:251], v[96:111]
    ds_read_b128 v[40:43], v1 offset:2048
    s_waitcnt vmcnt(10)
    v_mfma_f32_32x32x16_bf16 v[64:79], v[52:55], v[252:255], v[64:79]
    ds_read_b128 v[44:47], v1 offset:3072
    s_waitcnt lgkmcnt(4)
    v_mfma_f32_32x32x16_bf16 v[80:95], v[56:59], v[252:255], v[80:95]
    ds_read_b128 v[48:51], v1 offset:4096
    v_mfma_f32_32x32x16_bf16 v[96:111], v[60:63], v[252:255], v[96:111]
    ds_read_b128 v[52:55], v1 offset:5120
    s_waitcnt lgkmcnt(4)
    v_mfma_f32_32x32x16_bf16 v[112:127], v[32:35], v[128:131], 0
    ds_read_b128 v[56:59], v1 offset:6144
    s_barrier
    v_mfma_f32_32x32x16_bf16 v[112:127], v[36:39], v[132:135], v[112:127]
    ds_read_b128 v[60:63], v1 offset:7168
    s_add_u32 m0, s23, 65536
    s_mov_b32 s50, s39
    s_waitcnt lgkmcnt(4)
    v_mfma_f32_32x32x16_bf16 v[112:127], v[40:43], v[136:139], v[112:127]
    ds_read_b128 v[32:35], v1 offset:8192
    buffer_load_dwordx4 v1, s[4:7], s50 offen lds
    v_mfma_f32_32x32x16_bf16 v[112:127], v[44:47], v[140:143], v[112:127]
    ds_read_b128 v[36:39], v1 offset:9216
    v_exp_f32_e64 v64, -v64
    s_waitcnt lgkmcnt(4)
    v_mfma_f32_32x32x16_bf16 v[112:127], v[48:51], v[144:147], v[112:127]
    ds_read_b128 v[40:43], v1 offset:10240
    buffer_load_dwordx4 v1, s[4:7], s50 offen offset:1024 lds
    v_add_f32 v64, 1.0, v64
    v_exp_f32_e64 v65, -v65
    v_mfma_f32_32x32x16_bf16 v[112:127], v[52:55], v[148:151], v[112:127]
    ds_read_b128 v[44:47], v1 offset:11264
    v_add_f32 v65, 1.0, v65
    v_exp_f32_e64 v66, -v66
    s_waitcnt lgkmcnt(4)
    v_mfma_f32_32x32x16_bf16 v[112:127], v[56:59], v[152:155], v[112:127]
    ds_read_b128 v[48:51], v1 offset:12288
    buffer_load_dwordx4 v1, s[4:7], s50 offen offset:2048 lds
    v_add_f32 v66, 1.0, v66
    v_exp_f32_e64 v67, -v67
    v_mfma_f32_32x32x16_bf16 v[112:127], v[60:63], v[156:159], v[112:127]
    ds_read_b128 v[52:55], v1 offset:13312
    v_add_f32 v67, 1.0, v67
    v_exp_f32_e64 v68, -v68
    s_waitcnt lgkmcnt(4)
    v_mfma_f32_32x32x16_bf16 v[112:127], v[32:35], v[160:163], v[112:127]
    ds_read_b128 v[56:59], v1 offset:14336
    buffer_load_dwordx4 v1, s[4:7], s50 offen offset:3072 lds
    v_add_f32 v68, 1.0, v68
    v_exp_f32_e64 v69, -v69
    v_mfma_f32_32x32x16_bf16 v[112:127], v[36:39], v[164:167], v[112:127]
    ds_read_b128 v[60:63], v1 offset:15360
    s_add_u32 m0, s23, 69632
    s_add_u32 s50, s39, 4096
    v_add_f32 v69, 1.0, v69
    v_exp_f32_e64 v70, -v70
    s_waitcnt lgkmcnt(4)
    v_mfma_f32_32x32x16_bf16 v[112:127], v[40:43], v[168:171], v[112:127]
    ds_read_b128 v[32:35], v1 offset:16384
    buffer_load_dwordx4 v1, s[4:7], s50 offen lds
    v_add_f32 v70, 1.0, v70
    v_exp_f32_e64 v71, -v71
    v_mfma_f32_32x32x16_bf16 v[112:127], v[44:47], v[172:175], v[112:127]
    ds_read_b128 v[36:39], v1 offset:17408
    v_rcp_f32 v64, v64
    v_add_f32 v71, 1.0, v71
    s_waitcnt lgkmcnt(4)
    v_mfma_f32_32x32x16_bf16 v[112:127], v[48:51], v[176:179], v[112:127]
    ds_read_b128 v[40:43], v1 offset:18432
    buffer_load_dwordx4 v1, s[4:7], s50 offen offset:1024 lds
    v_mul_f32 v64, v64, v72
    v_rcp_f32 v65, v65
    v_mfma_f32_32x32x16_bf16 v[112:127], v[52:55], v[180:183], v[112:127]
    ds_read_b128 v[44:47], v1 offset:19456
    s_add_u32 s94, s36, 13651968
    v_mul_f32 v65, v65, v73
    v_rcp_f32 v66, v66
    s_waitcnt lgkmcnt(4)
    v_mfma_f32_32x32x16_bf16 v[112:127], v[56:59], v[184:187], v[112:127]
    ds_read_b128 v[48:51], v1 offset:20480
    v_mul_f32 v66, v66, v74
    v_rcp_f32 v67, v67
    v_cvt_pk_bf16_f32 v72, v64, v65
    v_mfma_f32_32x32x16_bf16 v[112:127], v[60:63], v[188:191], v[112:127]
    ds_read_b128 v[52:55], v1 offset:21504
    buffer_load_dwordx4 v1, s[4:7], s50 offen offset:2048 lds
    v_mul_f32 v67, v67, v75
    v_rcp_f32 v68, v68
    s_waitcnt lgkmcnt(4)
    v_mfma_f32_32x32x16_bf16 v[112:127], v[32:35], v[192:195], v[112:127]
    ds_read_b128 v[56:59], v1 offset:22528
    v_mul_f32 v68, v68, v76
    v_rcp_f32 v69, v69
    v_cvt_pk_bf16_f32 v73, v66, v67
    v_mfma_f32_32x32x16_bf16 v[112:127], v[36:39], v[196:199], v[112:127]
    ds_read_b128 v[60:63], v1 offset:23552
    buffer_load_dwordx4 v1, s[4:7], s50 offen offset:3072 lds
    v_mul_f32 v69, v69, v77
    v_rcp_f32 v70, v70
    s_waitcnt lgkmcnt(4)
    v_mfma_f32_32x32x16_bf16 v[112:127], v[40:43], v[200:203], v[112:127]
    ds_read_b128 v[32:35], v1 offset:24576
    v_mul_f32 v70, v70, v78
    v_rcp_f32 v71, v71
    v_cvt_pk_bf16_f32 v74, v68, v69
    v_mfma_f32_32x32x16_bf16 v[112:127], v[44:47], v[204:207], v[112:127]
    ds_read_b128 v[36:39], v1 offset:25600
    s_add_u32 m0, s23, 98304
    s_add_u32 s50, s39, 32768
    v_mul_f32 v71, v71, v79
    v_exp_f32_e64 v80, -v80
    s_waitcnt lgkmcnt(4)
    v_mfma_f32_32x32x16_bf16 v[112:127], v[48:51], v[208:211], v[112:127]
    ds_read_b128 v[40:43], v1 offset:26624
    v_add_f32 v80, 1.0, v80
    v_exp_f32_e64 v81, -v81
    v_cvt_pk_bf16_f32 v75, v70, v71
    v_mfma_f32_32x32x16_bf16 v[112:127], v[52:55], v[212:215], v[112:127]
    ds_read_b128 v[44:47], v1 offset:27648
    buffer_store_dwordx4 v[72:75], v1, s[4:7], s94 offen nt sc0
    v_add_f32 v81, 1.0, v81
    v_exp_f32_e64 v82, -v82
    s_waitcnt lgkmcnt(4)
    v_mfma_f32_32x32x16_bf16 v[112:127], v[56:59], v[216:219], v[112:127]
    ds_read_b128 v[48:51], v1 offset:28672
    v_add_f32 v82, 1.0, v82
    v_exp_f32_e64 v83, -v83
    v_mfma_f32_32x32x16_bf16 v[112:127], v[60:63], v[220:223], v[112:127]
    ds_read_b128 v[52:55], v1 offset:29696
    buffer_load_dwordx4 v1, s[4:7], s50 offen lds
    v_add_f32 v83, 1.0, v83
    v_exp_f32_e64 v84, -v84
    s_waitcnt lgkmcnt(4)
    v_mfma_f32_32x32x16_bf16 v[112:127], v[32:35], v[224:227], v[112:127]
    ds_read_b128 v[56:59], v1 offset:30720
    v_add_f32 v84, 1.0, v84
    v_exp_f32_e64 v85, -v85
    v_mfma_f32_32x32x16_bf16 v[112:127], v[36:39], v[228:231], v[112:127]
    ds_read_b128 v[60:63], v1 offset:31744
    s_waitcnt vmcnt(10)
    s_barrier
    v_add_f32 v85, 1.0, v85
    v_exp_f32_e64 v86, -v86
    s_waitcnt lgkmcnt(4)
    v_mfma_f32_32x32x16_bf16 v[112:127], v[40:43], v[232:235], v[112:127]
    ds_read_b128 v[32:35], v1 offset:32768
    buffer_load_dwordx4 v1, s[4:7], s50 offen offset:1024 lds
    v_add_f32 v86, 1.0, v86
    v_exp_f32_e64 v87, -v87
    v_mfma_f32_32x32x16_bf16 v[112:127], v[44:47], v[236:239], v[112:127]
    ds_read_b128 v[36:39], v1 offset:33792
    v_rcp_f32 v80, v80
    v_add_f32 v87, 1.0, v87
    s_waitcnt lgkmcnt(4)
    v_mfma_f32_32x32x16_bf16 v[112:127], v[48:51], v[240:243], v[112:127]
    ds_read_b128 v[40:43], v1 offset:34816
    buffer_load_dwordx4 v1, s[4:7], s50 offen offset:2048 lds
    v_mul_f32 v80, v80, v88
    v_rcp_f32 v81, v81
    v_mfma_f32_32x32x16_bf16 v[112:127], v[52:55], v[244:247], v[112:127]
    ds_read_b128 v[44:47], v1 offset:35840
    s_add_u32 s95, s36, 13656064
    v_mul_f32 v81, v81, v89
    v_rcp_f32 v82, v82
    s_waitcnt lgkmcnt(4)
    v_mfma_f32_32x32x16_bf16 v[112:127], v[56:59], v[248:251], v[112:127]
    ds_read_b128 v[48:51], v1 offset:36864
    v_mul_f32 v82, v82, v90
    v_rcp_f32 v83, v83
    v_cvt_pk_bf16_f32 v88, v80, v81
    v_mfma_f32_32x32x16_bf16 v[112:127], v[60:63], v[252:255], v[112:127]
    ds_read_b128 v[52:55], v1 offset:37888
    buffer_load_dwordx4 v1, s[4:7], s50 offen offset:3072 lds
    s_add_u32 m0, s23, 102400
    v_mul_f32 v83, v83, v91
    v_rcp_f32 v84, v84
    s_waitcnt lgkmcnt(4)
    v_mfma_f32_32x32x16_bf16 v[64:79], v[32:35], v[128:131], 0
    ds_read_b128 v[56:59], v1 offset:38912
    v_mul_f32 v84, v84, v92
    v_rcp_f32 v85, v85
    v_cvt_pk_bf16_f32 v89, v82, v83
    v_mfma_f32_32x32x16_bf16 v[64:79], v[36:39], v[132:135], v[64:79]
    ds_read_b128 v[60:63], v1 offset:39936
    s_add_u32 s50, s39, 36864
    v_mul_f32 v85, v85, v93
    v_rcp_f32 v86, v86
    s_waitcnt lgkmcnt(4)
    v_mfma_f32_32x32x16_bf16 v[64:79], v[40:43], v[136:139], v[64:79]
    ds_read_b128 v[32:35], v1 offset:40960
    v_mul_f32 v86, v86, v94
    v_rcp_f32 v87, v87
    v_cvt_pk_bf16_f32 v90, v84, v85
    v_mfma_f32_32x32x16_bf16 v[64:79], v[44:47], v[140:143], v[64:79]
    ds_read_b128 v[36:39], v1 offset:41984
    buffer_load_dwordx4 v1, s[4:7], s50 offen lds
    v_mul_f32 v87, v87, v95
    v_exp_f32_e64 v96, -v96
    s_waitcnt lgkmcnt(4)
    v_mfma_f32_32x32x16_bf16 v[64:79], v[48:51], v[144:147], v[64:79]
    ds_read_b128 v[40:43], v1 offset:43008
    v_add_f32 v96, 1.0, v96
    v_exp_f32_e64 v97, -v97
    v_cvt_pk_bf16_f32 v91, v86, v87
    v_mfma_f32_32x32x16_bf16 v[64:79], v[52:55], v[148:151], v[64:79]
    ds_read_b128 v[44:47], v1 offset:44032
    buffer_store_dwordx4 v[88:91], v1, s[4:7], s95 offen nt sc0
    v_add_f32 v97, 1.0, v97
    v_exp_f32_e64 v98, -v98
    s_waitcnt lgkmcnt(4)
    v_mfma_f32_32x32x16_bf16 v[64:79], v[56:59], v[152:155], v[64:79]
    ds_read_b128 v[48:51], v1 offset:45056
    v_add_f32 v98, 1.0, v98
    v_exp_f32_e64 v99, -v99
    v_mfma_f32_32x32x16_bf16 v[64:79], v[60:63], v[156:159], v[64:79]
    ds_read_b128 v[52:55], v1 offset:46080
    buffer_load_dwordx4 v1, s[4:7], s50 offen offset:1024 lds
    v_add_f32 v99, 1.0, v99
    v_exp_f32_e64 v100, -v100
    s_waitcnt lgkmcnt(4)
    v_mfma_f32_32x32x16_bf16 v[64:79], v[32:35], v[160:163], v[64:79]
    ds_read_b128 v[56:59], v1 offset:47104
    v_add_f32 v100, 1.0, v100
    v_exp_f32_e64 v101, -v101
    v_mfma_f32_32x32x16_bf16 v[64:79], v[36:39], v[164:167], v[64:79]
    ds_read_b128 v[60:63], v1 offset:48128
    buffer_load_dwordx4 v1, s[4:7], s50 offen offset:2048 lds
    v_add_f32 v101, 1.0, v101
    v_exp_f32_e64 v102, -v102
    s_waitcnt lgkmcnt(4)
    v_mfma_f32_32x32x16_bf16 v[64:79], v[40:43], v[168:171], v[64:79]
    ds_read_b128 v[32:35], v1 offset:49152
    v_add_f32 v102, 1.0, v102
    v_exp_f32_e64 v103, -v103
    v_mfma_f32_32x32x16_bf16 v[64:79], v[44:47], v[172:175], v[64:79]
    ds_read_b128 v[36:39], v1 offset:50176
    buffer_load_dwordx4 v1, s[4:7], s50 offen offset:3072 lds
    v_rcp_f32 v96, v96
    v_add_f32 v103, 1.0, v103
    s_waitcnt lgkmcnt(4)
    v_mfma_f32_32x32x16_bf16 v[64:79], v[48:51], v[176:179], v[64:79]
    ds_read_b128 v[40:43], v1 offset:51200
    v_mul_f32 v96, v96, v104
    v_rcp_f32 v97, v97
    v_mfma_f32_32x32x16_bf16 v[64:79], v[52:55], v[180:183], v[64:79]
    ds_read_b128 v[44:47], v1 offset:52224
    s_add_u32 s94, s36, 13639680
    v_mul_f32 v97, v97, v105
    v_rcp_f32 v98, v98
    s_waitcnt lgkmcnt(4)
    v_mfma_f32_32x32x16_bf16 v[64:79], v[56:59], v[184:187], v[64:79]
    ds_read_b128 v[48:51], v1 offset:53248
    v_mul_f32 v98, v98, v106
    v_rcp_f32 v99, v99
    v_cvt_pk_bf16_f32 v104, v96, v97
    v_mfma_f32_32x32x16_bf16 v[64:79], v[60:63], v[188:191], v[64:79]
    ds_read_b128 v[52:55], v1 offset:54272
    v_mul_f32 v99, v99, v107
    v_rcp_f32 v100, v100
    s_waitcnt lgkmcnt(4)
    v_mfma_f32_32x32x16_bf16 v[64:79], v[32:35], v[192:195], v[64:79]
    ds_read_b128 v[56:59], v1 offset:55296
    v_mul_f32 v100, v100, v108
    v_rcp_f32 v101, v101
    v_cvt_pk_bf16_f32 v105, v98, v99
    v_mfma_f32_32x32x16_bf16 v[64:79], v[36:39], v[196:199], v[64:79]
    ds_read_b128 v[60:63], v1 offset:56320
    v_mul_f32 v101, v101, v109
    v_rcp_f32 v102, v102
    s_waitcnt lgkmcnt(4)
    v_mfma_f32_32x32x16_bf16 v[64:79], v[40:43], v[200:203], v[64:79]
    ds_read_b128 v[32:35], v1 offset:57344
    v_mul_f32 v102, v102, v110
    v_rcp_f32 v103, v103
    v_cvt_pk_bf16_f32 v106, v100, v101
    v_mfma_f32_32x32x16_bf16 v[64:79], v[44:47], v[204:207], v[64:79]
    ds_read_b128 v[36:39], v1 offset:58368
    v_mul_f32 v103, v103, v111
    v_exp_f32_e64 v112, -v112
    s_waitcnt lgkmcnt(4)
    v_mfma_f32_32x32x16_bf16 v[64:79], v[48:51], v[208:211], v[64:79]
    ds_read_b128 v[40:43], v1 offset:59392
    v_add_f32 v112, 1.0, v112
    v_exp_f32_e64 v113, -v113
    v_cvt_pk_bf16_f32 v107, v102, v103
    v_mfma_f32_32x32x16_bf16 v[64:79], v[52:55], v[212:215], v[64:79]
    ds_read_b128 v[44:47], v1 offset:60416
    buffer_store_dwordx4 v[104:107], v1, s[4:7], s94 offen nt sc0
    v_add_f32 v113, 1.0, v113
    v_exp_f32_e64 v114, -v114
    s_waitcnt lgkmcnt(4)
    v_mfma_f32_32x32x16_bf16 v[64:79], v[56:59], v[216:219], v[64:79]
    ds_read_b128 v[48:51], v1 offset:61440
    v_add_f32 v114, 1.0, v114
    v_exp_f32_e64 v115, -v115
    v_mfma_f32_32x32x16_bf16 v[64:79], v[60:63], v[220:223], v[64:79]
    ds_read_b128 v[52:55], v1 offset:62464
    v_add_f32 v115, 1.0, v115
    v_exp_f32_e64 v116, -v116
    s_waitcnt lgkmcnt(4)
    v_mfma_f32_32x32x16_bf16 v[64:79], v[32:35], v[224:227], v[64:79]
    ds_read_b128 v[56:59], v1 offset:63488
    v_add_f32 v116, 1.0, v116
    v_exp_f32_e64 v117, -v117
    v_mfma_f32_32x32x16_bf16 v[64:79], v[36:39], v[228:231], v[64:79]
    ds_read_b128 v[60:63], v1 offset:64512
    s_waitcnt vmcnt(11)
    s_barrier
    v_add_f32 v117, 1.0, v117
    v_exp_f32_e64 v118, -v118
    s_waitcnt lgkmcnt(4)
    v_mfma_f32_32x32x16_bf16 v[64:79], v[40:43], v[232:235], v[64:79]
    ds_read_b128 v[32:35], v2 offset:0
    v_add_f32 v118, 1.0, v118
    v_exp_f32_e64 v119, -v119
    v_mfma_f32_32x32x16_bf16 v[64:79], v[44:47], v[236:239], v[64:79]
    ds_read_b128 v[36:39], v2 offset:1024
    v_rcp_f32 v112, v112
    v_add_f32 v119, 1.0, v119
    s_waitcnt lgkmcnt(4)
    v_mfma_f32_32x32x16_bf16 v[64:79], v[48:51], v[240:243], v[64:79]
    ds_read_b128 v[40:43], v2 offset:2048
    v_mul_f32 v112, v112, v120
    v_rcp_f32 v113, v113
    v_mfma_f32_32x32x16_bf16 v[64:79], v[52:55], v[244:247], v[64:79]
    ds_read_b128 v[44:47], v2 offset:3072
    s_add_u32 s95, s36, 13643776
    v_mul_f32 v113, v113, v121
    v_rcp_f32 v114, v114
    s_waitcnt lgkmcnt(4)
    v_mfma_f32_32x32x16_bf16 v[64:79], v[56:59], v[248:251], v[64:79]
    ds_read_b128 v[48:51], v2 offset:4096
    v_mul_f32 v114, v114, v122
    v_rcp_f32 v115, v115
    v_cvt_pk_bf16_f32 v120, v112, v113
    v_mfma_f32_32x32x16_bf16 v[64:79], v[60:63], v[252:255], v[64:79]
    ds_read_b128 v[52:55], v2 offset:5120
    v_mul_f32 v115, v115, v123
    v_rcp_f32 v116, v116
    s_waitcnt lgkmcnt(4)
    v_mfma_f32_32x32x16_bf16 v[80:95], v[32:35], v[128:131], 0
    ds_read_b128 v[56:59], v2 offset:6144
    v_mul_f32 v116, v116, v124
    v_rcp_f32 v117, v117
    v_cvt_pk_bf16_f32 v121, v114, v115
    v_mfma_f32_32x32x16_bf16 v[80:95], v[36:39], v[132:135], v[80:95]
    ds_read_b128 v[60:63], v2 offset:7168
    s_waitcnt vmcnt(0)
    v_mul_f32 v117, v117, v125
    v_rcp_f32 v118, v118
    s_waitcnt lgkmcnt(4)
    v_mfma_f32_32x32x16_bf16 v[80:95], v[40:43], v[136:139], v[80:95]
    ds_read_b128 v[32:35], v2 offset:8192
    v_mul_f32 v118, v118, v126
    v_rcp_f32 v119, v119
    v_cvt_pk_bf16_f32 v122, v116, v117
    v_mfma_f32_32x32x16_bf16 v[80:95], v[44:47], v[140:143], v[80:95]
    ds_read_b128 v[36:39], v2 offset:9216
    s_waitcnt vmcnt(0)
    buffer_wbl2 sc1
    s_waitcnt vmcnt(0)
    buffer_store_dword v18, v6, s[4:7], s42 offen sc1
    v_mul_f32 v119, v119, v127
    v_exp_f32_e64 v64, -v64
    s_waitcnt lgkmcnt(4)
    v_mfma_f32_32x32x16_bf16 v[80:95], v[48:51], v[144:147], v[80:95]
    ds_read_b128 v[40:43], v2 offset:10240
    v_add_f32 v64, 1.0, v64
    v_exp_f32_e64 v65, -v65
    v_cvt_pk_bf16_f32 v123, v118, v119
    v_mfma_f32_32x32x16_bf16 v[80:95], v[52:55], v[148:151], v[80:95]
    ds_read_b128 v[44:47], v2 offset:11264
    buffer_store_dwordx4 v[120:123], v1, s[4:7], s95 offen nt sc0
    v_add_f32 v65, 1.0, v65
    v_exp_f32_e64 v66, -v66
    s_waitcnt lgkmcnt(4)
    v_mfma_f32_32x32x16_bf16 v[80:95], v[56:59], v[152:155], v[80:95]
    ds_read_b128 v[48:51], v2 offset:12288
    v_add_f32 v66, 1.0, v66
    v_exp_f32_e64 v67, -v67
    v_mfma_f32_32x32x16_bf16 v[80:95], v[60:63], v[156:159], v[80:95]
    ds_read_b128 v[52:55], v2 offset:13312
    v_add_f32 v67, 1.0, v67
    v_exp_f32_e64 v68, -v68
    s_waitcnt lgkmcnt(4)
    v_mfma_f32_32x32x16_bf16 v[80:95], v[32:35], v[160:163], v[80:95]
    ds_read_b128 v[56:59], v2 offset:14336
    v_add_f32 v68, 1.0, v68
    v_exp_f32_e64 v69, -v69
    v_mfma_f32_32x32x16_bf16 v[80:95], v[36:39], v[164:167], v[80:95]
    ds_read_b128 v[60:63], v2 offset:15360
    v_add_f32 v69, 1.0, v69
    v_exp_f32_e64 v70, -v70
    s_waitcnt lgkmcnt(4)
    v_mfma_f32_32x32x16_bf16 v[80:95], v[40:43], v[168:171], v[80:95]
    ds_read_b128 v[32:35], v2 offset:16384
    v_add_f32 v70, 1.0, v70
    v_exp_f32_e64 v71, -v71
    v_mfma_f32_32x32x16_bf16 v[80:95], v[44:47], v[172:175], v[80:95]
    ds_read_b128 v[36:39], v2 offset:17408
    v_rcp_f32 v64, v64
    v_add_f32 v71, 1.0, v71
    s_waitcnt lgkmcnt(4)
    v_mfma_f32_32x32x16_bf16 v[80:95], v[48:51], v[176:179], v[80:95]
    ds_read_b128 v[40:43], v2 offset:18432
    v_mul_f32 v64, v64, v72
    v_rcp_f32 v65, v65
    v_mfma_f32_32x32x16_bf16 v[80:95], v[52:55], v[180:183], v[80:95]
    ds_read_b128 v[44:47], v2 offset:19456
    s_add_u32 s94, s36, 13647872
    v_mul_f32 v65, v65, v73
    v_rcp_f32 v66, v66
    s_waitcnt lgkmcnt(4)
    v_mfma_f32_32x32x16_bf16 v[80:95], v[56:59], v[184:187], v[80:95]
    ds_read_b128 v[48:51], v2 offset:20480
    v_mul_f32 v66, v66, v74
    v_rcp_f32 v67, v67
    v_cvt_pk_bf16_f32 v72, v64, v65
    v_mfma_f32_32x32x16_bf16 v[80:95], v[60:63], v[188:191], v[80:95]
    ds_read_b128 v[52:55], v2 offset:21504
    v_mul_f32 v67, v67, v75
    v_rcp_f32 v68, v68
    s_waitcnt lgkmcnt(4)
    v_mfma_f32_32x32x16_bf16 v[80:95], v[32:35], v[192:195], v[80:95]
    ds_read_b128 v[56:59], v2 offset:22528
    v_mul_f32 v68, v68, v76
    v_rcp_f32 v69, v69
    v_cvt_pk_bf16_f32 v73, v66, v67
    v_mfma_f32_32x32x16_bf16 v[80:95], v[36:39], v[196:199], v[80:95]
    ds_read_b128 v[60:63], v2 offset:23552
    v_mul_f32 v69, v69, v77
    v_rcp_f32 v70, v70
    s_waitcnt lgkmcnt(4)
    v_mfma_f32_32x32x16_bf16 v[80:95], v[40:43], v[200:203], v[80:95]
    ds_read_b128 v[32:35], v2 offset:24576
    v_mul_f32 v70, v70, v78
    v_rcp_f32 v71, v71
    v_cvt_pk_bf16_f32 v74, v68, v69
    v_mfma_f32_32x32x16_bf16 v[80:95], v[44:47], v[204:207], v[80:95]
    ds_read_b128 v[36:39], v2 offset:25600
    v_mul_f32 v71, v71, v79
    s_waitcnt lgkmcnt(4)
    v_mfma_f32_32x32x16_bf16 v[80:95], v[48:51], v[208:211], v[80:95]
    ds_read_b128 v[40:43], v2 offset:26624
    v_cvt_pk_bf16_f32 v75, v70, v71
    v_mfma_f32_32x32x16_bf16 v[80:95], v[52:55], v[212:215], v[80:95]
    ds_read_b128 v[44:47], v2 offset:27648
    buffer_store_dwordx4 v[72:75], v1, s[4:7], s94 offen nt sc0
    s_add_u32 s96, s37, 13651968
    s_add_u32 s97, s37, 13656064
    s_waitcnt lgkmcnt(4)
    v_mfma_f32_32x32x16_bf16 v[80:95], v[56:59], v[216:219], v[80:95]
    ds_read_b128 v[48:51], v2 offset:28672
    v_mfma_f32_32x32x16_bf16 v[80:95], v[60:63], v[220:223], v[80:95]
    ds_read_b128 v[52:55], v2 offset:29696
    s_waitcnt vmcnt(0)
    s_mov_b32 s49, 0
L_polll_100050:
    buffer_inv sc1
    s_waitcnt vmcnt(0)
    buffer_load_dword v17, v4, s[4:7], s43 offen sc1
    s_add_u32 s49, s49, 1
    s_waitcnt vmcnt(0)
    v_cmp_ne_u32 vcc, s51, v17
    s_cmp_gt_u32 s49, 0x2000
    s_cbranch_scc1 L_pollb_100049
    s_cbranch_vccnz L_polll_100050
L_pollb_100049:
    buffer_inv sc1
    s_waitcnt vmcnt(0)
    s_waitcnt lgkmcnt(4)
    v_mfma_f32_32x32x16_bf16 v[80:95], v[32:35], v[224:227], v[80:95]
    ds_read_b128 v[56:59], v2 offset:30720
    buffer_load_dwordx4 a[236:239], v1, s[4:7], s96 offen sc1
    v_mfma_f32_32x32x16_bf16 v[80:95], v[36:39], v[228:231], v[80:95]
    ds_read_b128 v[60:63], v2 offset:31744
    s_barrier
    s_waitcnt lgkmcnt(4)
    v_mfma_f32_32x32x16_bf16 v[80:95], v[40:43], v[232:235], v[80:95]
    ds_read_b128 v[32:35], v2 offset:32768
    s_add_u32 s3, s38, s64
    v_mfma_f32_32x32x16_bf16 v[80:95], v[44:47], v[236:239], v[80:95]
    ds_read_b128 v[36:39], v2 offset:33792
    buffer_load_dwordx4 v[20:23], v1, s[4:7], s3 offen sc1
    s_waitcnt lgkmcnt(4)
    v_mfma_f32_32x32x16_bf16 v[80:95], v[48:51], v[240:243], v[80:95]
    ds_read_b128 v[40:43], v2 offset:34816
    s_add_u32 s3, s3, 32768
    v_mfma_f32_32x32x16_bf16 v[80:95], v[52:55], v[244:247], v[80:95]
    ds_read_b128 v[44:47], v2 offset:35840
    buffer_load_dwordx4 v[24:27], v1, s[4:7], s3 offen sc1
    s_waitcnt lgkmcnt(4)
    v_mfma_f32_32x32x16_bf16 v[80:95], v[56:59], v[248:251], v[80:95]
    ds_read_b128 v[48:51], v2 offset:36864
    v_mfma_f32_32x32x16_bf16 v[80:95], v[60:63], v[252:255], v[80:95]
    ds_read_b128 v[52:55], v2 offset:37888
    buffer_load_dwordx4 a[240:243], v1, s[4:7], s96 offen offset:1024 sc1
    s_waitcnt lgkmcnt(4)
    v_mfma_f32_32x32x16_bf16 v[96:111], v[32:35], v[128:131], 0
    ds_read_b128 v[56:59], v2 offset:38912
    v_mfma_f32_32x32x16_bf16 v[96:111], v[36:39], v[132:135], v[96:111]
    ds_read_b128 v[60:63], v2 offset:39936
    buffer_load_dwordx4 a[244:247], v1, s[4:7], s96 offen offset:2048 sc1
    s_waitcnt lgkmcnt(4)
    v_mfma_f32_32x32x16_bf16 v[96:111], v[40:43], v[136:139], v[96:111]
    ds_read_b128 v[32:35], v2 offset:40960
    v_mfma_f32_32x32x16_bf16 v[96:111], v[44:47], v[140:143], v[96:111]
    ds_read_b128 v[36:39], v2 offset:41984
    buffer_load_dwordx4 a[248:251], v1, s[4:7], s96 offen offset:3072 sc1
    s_add_u32 s96, s37, 13639680
    s_waitcnt lgkmcnt(4)
    v_mfma_f32_32x32x16_bf16 v[96:111], v[48:51], v[144:147], v[96:111]
    ds_read_b128 v[40:43], v2 offset:43008
    v_exp_f32_e64 v80, -v80
    v_mfma_f32_32x32x16_bf16 v[96:111], v[52:55], v[148:151], v[96:111]
    ds_read_b128 v[44:47], v2 offset:44032
    buffer_load_dwordx4 a[252:255], v1, s[4:7], s97 offen sc1
    v_add_f32 v80, 1.0, v80
    v_exp_f32_e64 v81, -v81
    s_waitcnt lgkmcnt(4)
    v_mfma_f32_32x32x16_bf16 v[96:111], v[56:59], v[152:155], v[96:111]
    ds_read_b128 v[48:51], v2 offset:45056
    v_add_f32 v81, 1.0, v81
    v_exp_f32_e64 v82, -v82
    v_mfma_f32_32x32x16_bf16 v[96:111], v[60:63], v[156:159], v[96:111]
    ds_read_b128 v[52:55], v2 offset:46080
    buffer_load_dwordx4 v[128:131], v1, s[4:7], s97 offen offset:1024 sc1
    v_add_f32 v82, 1.0, v82
    v_exp_f32_e64 v83, -v83
    s_waitcnt lgkmcnt(4)
    v_mfma_f32_32x32x16_bf16 v[96:111], v[32:35], v[160:163], v[96:111]
    ds_read_b128 v[56:59], v2 offset:47104
    v_add_f32 v83, 1.0, v83
    v_exp_f32_e64 v84, -v84
    v_mfma_f32_32x32x16_bf16 v[96:111], v[36:39], v[164:167], v[96:111]
    ds_read_b128 v[60:63], v2 offset:48128
    buffer_load_dwordx4 v[132:135], v1, s[4:7], s97 offen offset:2048 sc1
    v_add_f32 v84, 1.0, v84
    v_exp_f32_e64 v85, -v85
    s_waitcnt lgkmcnt(4)
    v_mfma_f32_32x32x16_bf16 v[96:111], v[40:43], v[168:171], v[96:111]
    ds_read_b128 v[32:35], v2 offset:49152
    v_add_f32 v85, 1.0, v85
    v_exp_f32_e64 v86, -v86
    v_mfma_f32_32x32x16_bf16 v[96:111], v[44:47], v[172:175], v[96:111]
    ds_read_b128 v[36:39], v2 offset:50176
    buffer_load_dwordx4 v[136:139], v1, s[4:7], s97 offen offset:3072 sc1
    s_add_u32 s97, s37, 13766656
    v_add_f32 v86, 1.0, v86
    v_exp_f32_e64 v87, -v87
    s_waitcnt lgkmcnt(4)
    v_mfma_f32_32x32x16_bf16 v[96:111], v[48:51], v[176:179], v[96:111]
    ds_read_b128 v[40:43], v2 offset:51200
    v_rcp_f32 v80, v80
    v_add_f32 v87, 1.0, v87
    v_mfma_f32_32x32x16_bf16 v[96:111], v[52:55], v[180:183], v[96:111]
    ds_read_b128 v[44:47], v2 offset:52224
    buffer_load_dwordx4 v[140:143], v1, s[4:7], s96 offen sc1
    v_mul_f32 v80, v80, v88
    v_rcp_f32 v81, v81
    s_waitcnt lgkmcnt(4)
    v_mfma_f32_32x32x16_bf16 v[96:111], v[56:59], v[184:187], v[96:111]
    ds_read_b128 v[48:51], v2 offset:53248
    s_add_u32 s95, s36, 13631488
    v_mul_f32 v81, v81, v89
    v_rcp_f32 v82, v82
    v_mfma_f32_32x32x16_bf16 v[96:111], v[60:63], v[188:191], v[96:111]
    ds_read_b128 v[52:55], v2 offset:54272
    buffer_load_dwordx4 v[144:147], v1, s[4:7], s96 offen offset:1024 sc1
    v_mul_f32 v82, v82, v90
    v_rcp_f32 v83, v83
    v_cvt_pk_bf16_f32 v88, v80, v81
    s_waitcnt lgkmcnt(4)
    v_mfma_f32_32x32x16_bf16 v[96:111], v[32:35], v[192:195], v[96:111]
    ds_read_b128 v[56:59], v2 offset:55296
    v_mul_f32 v83, v83, v91
    v_rcp_f32 v84, v84
    v_mfma_f32_32x32x16_bf16 v[96:111], v[36:39], v[196:199], v[96:111]
    ds_read_b128 v[60:63], v2 offset:56320
    buffer_load_dwordx4 v[148:151], v1, s[4:7], s96 offen offset:2048 sc1
    v_mul_f32 v84, v84, v92
    v_rcp_f32 v85, v85
    v_cvt_pk_bf16_f32 v89, v82, v83
    s_waitcnt lgkmcnt(4)
    v_mfma_f32_32x32x16_bf16 v[96:111], v[40:43], v[200:203], v[96:111]
    ds_read_b128 v[32:35], v2 offset:57344
    v_mul_f32 v85, v85, v93
    v_rcp_f32 v86, v86
    v_mfma_f32_32x32x16_bf16 v[96:111], v[44:47], v[204:207], v[96:111]
    ds_read_b128 v[36:39], v2 offset:58368
    buffer_load_dwordx4 v[152:155], v1, s[4:7], s96 offen offset:3072 sc1
    v_mul_f32 v86, v86, v94
    v_rcp_f32 v87, v87
    v_cvt_pk_bf16_f32 v90, v84, v85
    s_waitcnt lgkmcnt(4)
    v_mfma_f32_32x32x16_bf16 v[96:111], v[48:51], v[208:211], v[96:111]
    ds_read_b128 v[40:43], v2 offset:59392
    s_add_u32 s96, s37, 13770752
    v_mul_f32 v87, v87, v95
    v_mfma_f32_32x32x16_bf16 v[96:111], v[52:55], v[212:215], v[96:111]
    ds_read_b128 v[44:47], v2 offset:60416
    v_cvt_pk_bf16_f32 v91, v86, v87
    s_waitcnt lgkmcnt(4)
    v_mfma_f32_32x32x16_bf16 v[96:111], v[56:59], v[216:219], v[96:111]
    ds_read_b128 v[48:51], v2 offset:61440
    buffer_store_dwordx4 v[88:91], v1, s[4:7], s95 offen nt sc0
    v_mfma_f32_32x32x16_bf16 v[96:111], v[60:63], v[220:223], v[96:111]
    ds_read_b128 v[52:55], v2 offset:62464
    s_waitcnt lgkmcnt(4)
    v_mfma_f32_32x32x16_bf16 v[96:111], v[32:35], v[224:227], v[96:111]
    ds_read_b128 v[56:59], v2 offset:63488
    buffer_load_dwordx4 v[156:159], v1, s[4:7], s97 offen sc1
    v_mfma_f32_32x32x16_bf16 v[96:111], v[36:39], v[228:231], v[96:111]
    ds_read_b128 v[60:63], v2 offset:64512
    s_waitcnt lgkmcnt(4)
    v_mfma_f32_32x32x16_bf16 v[96:111], v[40:43], v[232:235], v[96:111]
    buffer_load_dwordx4 v[160:163], v1, s[4:7], s97 offen offset:1024 sc1
    v_mfma_f32_32x32x16_bf16 v[96:111], v[44:47], v[236:239], v[96:111]
    s_waitcnt lgkmcnt(2)
    v_mfma_f32_32x32x16_bf16 v[96:111], v[48:51], v[240:243], v[96:111]
    buffer_load_dwordx4 v[164:167], v1, s[4:7], s97 offen offset:2048 sc1
    v_mfma_f32_32x32x16_bf16 v[96:111], v[52:55], v[244:247], v[96:111]
    s_waitcnt lgkmcnt(0)
    v_mfma_f32_32x32x16_bf16 v[96:111], v[56:59], v[248:251], v[96:111]
    buffer_load_dwordx4 v[168:171], v1, s[4:7], s97 offen offset:3072 sc1
    s_add_u32 s97, s37, 13754368
    v_mfma_f32_32x32x16_bf16 v[96:111], v[60:63], v[252:255], v[96:111]
    s_waitcnt vmcnt(18)
    v_mfma_f32_32x32x16_bf16 v[64:79], a[40:43], a[236:239], 0
    buffer_load_dwordx4 v[172:175], v1, s[4:7], s96 offen sc1
    v_mfma_f32_32x32x16_bf16 v[80:95], a[44:47], a[236:239], 0
    s_waitcnt vmcnt(16)
    v_mfma_f32_32x32x16_bf16 v[64:79], a[96:99], a[240:243], v[64:79]
    buffer_load_dwordx4 v[176:179], v1, s[4:7], s96 offen offset:1024 sc1
    s_waitcnt vmcnt(6)
    v_mfma_f32_32x32x16_bf16 v[80:95], a[100:103], a[240:243], v[80:95]
    s_waitcnt vmcnt(0)
    buffer_wbl2 sc1
    s_waitcnt vmcnt(0)
    buffer_store_dword v18, v6, s[4:7], s42 offen offset:256 sc1
    v_mfma_f32_32x32x16_bf16 v[64:79], a[152:155], a[244:247], v[64:79]
    buffer_load_dwordx4 v[180:183], v1, s[4:7], s96 offen offset:2048 sc1
    v_exp_f32_e64 v96, -v96
    v_mfma_f32_32x32x16_bf16 v[80:95], a[156:159], a[244:247], v[80:95]
    v_add_f32 v96, 1.0, v96
    v_exp_f32_e64 v97, -v97
    v_mfma_f32_32x32x16_bf16 v[64:79], a[208:211], a[248:251], v[64:79]
    buffer_load_dwordx4 v[184:187], v1, s[4:7], s96 offen offset:3072 sc1
    v_add_f32 v97, 1.0, v97
    v_exp_f32_e64 v98, -v98
    v_mfma_f32_32x32x16_bf16 v[80:95], a[212:215], a[248:251], v[80:95]
    v_add_f32 v98, 1.0, v98
    v_exp_f32_e64 v99, -v99
    v_mfma_f32_32x32x16_bf16 v[64:79], a[48:51], a[252:255], v[64:79]
    buffer_load_dwordx4 v[188:191], v1, s[4:7], s97 offen sc1
    v_add_f32 v99, 1.0, v99
    v_exp_f32_e64 v100, -v100
    v_mfma_f32_32x32x16_bf16 v[80:95], a[52:55], a[252:255], v[80:95]
    v_add_f32 v100, 1.0, v100
    v_exp_f32_e64 v101, -v101
    v_mfma_f32_32x32x16_bf16 v[64:79], a[104:107], v[128:131], v[64:79]
    buffer_load_dwordx4 v[192:195], v1, s[4:7], s97 offen offset:1024 sc1
    v_add_f32 v101, 1.0, v101
    v_exp_f32_e64 v102, -v102
    v_mfma_f32_32x32x16_bf16 v[80:95], a[108:111], v[128:131], v[80:95]
    v_add_f32 v102, 1.0, v102
    v_exp_f32_e64 v103, -v103
    v_mfma_f32_32x32x16_bf16 v[64:79], a[160:163], v[132:135], v[64:79]
    buffer_load_dwordx4 v[196:199], v1, s[4:7], s97 offen offset:2048 sc1
    v_rcp_f32 v96, v96
    v_add_f32 v103, 1.0, v103
    v_mfma_f32_32x32x16_bf16 v[80:95], a[164:167], v[132:135], v[80:95]
    v_mul_f32 v96, v96, v104
    v_rcp_f32 v97, v97
    v_mfma_f32_32x32x16_bf16 v[64:79], a[216:219], v[136:139], v[64:79]
    buffer_load_dwordx4 v[200:203], v1, s[4:7], s97 offen offset:3072 sc1
    s_add_u32 s94, s36, 13635584
    v_mul_f32 v97, v97, v105
    v_rcp_f32 v98, v98
    v_mfma_f32_32x32x16_bf16 v[80:95], a[220:223], v[136:139], v[80:95]
    v_mul_f32 v98, v98, v106
    v_rcp_f32 v99, v99
    v_cvt_pk_bf16_f32 v104, v96, v97
    v_mfma_f32_32x32x16_bf16 v[64:79], a[16:19], v[140:143], v[64:79]
    v_mul_f32 v99, v99, v107
    v_rcp_f32 v100, v100
    v_mfma_f32_32x32x16_bf16 v[80:95], a[20:23], v[140:143], v[80:95]
    v_mul_f32 v100, v100, v108
    v_rcp_f32 v101, v101
    v_cvt_pk_bf16_f32 v105, v98, v99
    v_mfma_f32_32x32x16_bf16 v[64:79], a[72:75], v[144:147], v[64:79]
    v_mul_f32 v101, v101, v109
    v_rcp_f32 v102, v102
    v_mfma_f32_32x32x16_bf16 v[80:95], a[76:79], v[144:147], v[80:95]
    v_mul_f32 v102, v102, v110
    v_rcp_f32 v103, v103
    v_cvt_pk_bf16_f32 v106, v100, v101
    v_mfma_f32_32x32x16_bf16 v[64:79], a[128:131], v[148:151], v[64:79]
    v_mul_f32 v103, v103, v111
    v_mfma_f32_32x32x16_bf16 v[80:95], a[132:135], v[148:151], v[80:95]
    v_cvt_pk_bf16_f32 v107, v102, v103
    v_mfma_f32_32x32x16_bf16 v[64:79], a[184:187], v[152:155], v[64:79]
    buffer_store_dwordx4 v[104:107], v1, s[4:7], s94 offen nt sc0
    v_mfma_f32_32x32x16_bf16 v[80:95], a[188:191], v[152:155], v[80:95]
    s_add_u32 s96, s37, 13643776
    s_add_u32 s97, s37, 13647872
    v_mfma_f32_32x32x16_bf16 v[112:127], a[40:43], v[156:159], 0
    v_mfma_f32_32x32x16_bf16 v[96:111], a[44:47], v[156:159], 0
    s_waitcnt vmcnt(0)
    s_mov_b32 s49, 0
L_polll_100053:
    buffer_inv sc1
    s_waitcnt vmcnt(0)
    buffer_load_dword v17, v4, s[4:7], s43 offen offset:256 sc1
    s_add_u32 s49, s49, 1
    s_waitcnt vmcnt(0)
    v_cmp_ne_u32 vcc, s51, v17
    s_cmp_gt_u32 s49, 0x2000
    s_cbranch_scc1 L_pollb_100052
    s_cbranch_vccnz L_polll_100053
L_pollb_100052:
    buffer_inv sc1
    s_waitcnt vmcnt(0)
    v_mfma_f32_32x32x16_bf16 v[112:127], a[96:99], v[160:163], v[112:127]
    buffer_load_dwordx4 v[204:207], v1, s[4:7], s96 offen sc1
    v_mfma_f32_32x32x16_bf16 v[96:111], a[100:103], v[160:163], v[96:111]
    v_mfma_f32_32x32x16_bf16 v[112:127], a[152:155], v[164:167], v[112:127]
    buffer_load_dwordx4 v[208:211], v1, s[4:7], s96 offen offset:1024 sc1
    v_mfma_f32_32x32x16_bf16 v[96:111], a[156:159], v[164:167], v[96:111]
    v_mfma_f32_32x32x16_bf16 v[112:127], a[208:211], v[168:171], v[112:127]
    buffer_load_dwordx4 v[212:215], v1, s[4:7], s96 offen offset:2048 sc1
    v_mfma_f32_32x32x16_bf16 v[96:111], a[212:215], v[168:171], v[96:111]
    v_mfma_f32_32x32x16_bf16 v[112:127], a[48:51], v[172:175], v[112:127]
    buffer_load_dwordx4 v[216:219], v1, s[4:7], s96 offen offset:3072 sc1
    s_add_u32 s96, s37, 13631488
    v_mfma_f32_32x32x16_bf16 v[96:111], a[52:55], v[172:175], v[96:111]
    v_mfma_f32_32x32x16_bf16 v[112:127], a[104:107], v[176:179], v[112:127]
    buffer_load_dwordx4 v[220:223], v1, s[4:7], s97 offen sc1
    v_mfma_f32_32x32x16_bf16 v[96:111], a[108:111], v[176:179], v[96:111]
    s_waitcnt vmcnt(0)
    buffer_wbl2 sc1
    s_waitcnt vmcnt(0)
    buffer_store_dword v18, v6, s[4:7], s42 offen offset:512 sc1
    v_mfma_f32_32x32x16_bf16 v[112:127], a[160:163], v[180:183], v[112:127]
    buffer_load_dwordx4 v[224:227], v1, s[4:7], s97 offen offset:1024 sc1
    v_mfma_f32_32x32x16_bf16 v[96:111], a[164:167], v[180:183], v[96:111]
    v_mfma_f32_32x32x16_bf16 v[112:127], a[216:219], v[184:187], v[112:127]
    buffer_load_dwordx4 v[228:231], v1, s[4:7], s97 offen offset:2048 sc1
    v_mfma_f32_32x32x16_bf16 v[96:111], a[220:223], v[184:187], v[96:111]
    v_mfma_f32_32x32x16_bf16 v[112:127], a[16:19], v[188:191], v[112:127]
    buffer_load_dwordx4 v[232:235], v1, s[4:7], s97 offen offset:3072 sc1
    s_add_u32 s97, s37, 13758464
    v_lshlrev_b32 v56, 16, v24
    v_and_b32 v57, s31, v24
    v_mfma_f32_32x32x16_bf16 v[96:111], a[20:23], v[188:191], v[96:111]
    v_lshlrev_b32 v58, 16, v25
    v_and_b32 v59, s31, v25
    v_lshlrev_b32 v60, 16, v26
    v_and_b32 v61, s31, v26
    v_lshlrev_b32 v62, 16, v27
    v_and_b32 v63, s31, v27
    v_mfma_f32_32x32x16_bf16 v[112:127], a[72:75], v[192:195], v[112:127]
    buffer_load_dwordx4 v[236:239], v1, s[4:7], s96 offen sc1
    v_mfma_f32_32x32x16_bf16 v[96:111], a[76:79], v[192:195], v[96:111]
    v_mfma_f32_32x32x16_bf16 v[112:127], a[128:131], v[196:199], v[112:127]
    buffer_load_dwordx4 v[240:243], v1, s[4:7], s96 offen offset:1024 sc1
    v_mfma_f32_32x32x16_bf16 v[96:111], a[132:135], v[196:199], v[96:111]
    v_mfma_f32_32x32x16_bf16 v[112:127], a[184:187], v[200:203], v[112:127]
    buffer_load_dwordx4 v[244:247], v1, s[4:7], s96 offen offset:2048 sc1
    v_mfma_f32_32x32x16_bf16 v[96:111], a[188:191], v[200:203], v[96:111]
    v_mfma_f32_32x32x16_bf16 v[64:79], a[24:27], v[204:207], v[64:79]
    buffer_load_dwordx4 v[248:251], v1, s[4:7], s96 offen offset:3072 sc1
    v_mfma_f32_32x32x16_bf16 v[80:95], a[28:31], v[204:207], v[80:95]
    v_mfma_f32_32x32x16_bf16 v[64:79], a[80:83], v[208:211], v[64:79]
    buffer_load_dwordx4 v[252:255], v1, s[4:7], s97 offen sc1
    v_mfma_f32_32x32x16_bf16 v[80:95], a[84:87], v[208:211], v[80:95]
    v_mfma_f32_32x32x16_bf16 v[64:79], a[136:139], v[212:215], v[64:79]
    buffer_load_dwordx4 a[236:239], v1, s[4:7], s97 offen offset:1024 sc1
    v_mfma_f32_32x32x16_bf16 v[80:95], a[140:143], v[212:215], v[80:95]
    v_mfma_f32_32x32x16_bf16 v[64:79], a[192:195], v[216:219], v[64:79]
    buffer_load_dwordx4 a[240:243], v1, s[4:7], s97 offen offset:2048 sc1
    v_mfma_f32_32x32x16_bf16 v[80:95], a[196:199], v[216:219], v[80:95]
    s_add_u32 s96, s37, 13635584
    v_mfma_f32_32x32x16_bf16 v[64:79], a[32:35], v[220:223], v[64:79]
    buffer_load_dwordx4 a[244:247], v1, s[4:7], s97 offen offset:3072 sc1
    s_add_u32 s97, s37, 13762560
    v_mfma_f32_32x32x16_bf16 v[80:95], a[36:39], v[220:223], v[80:95]
    s_waitcnt vmcnt(0)
    s_mov_b32 s49, 0
L_polll_100056:
    buffer_inv sc1
    s_waitcnt vmcnt(0)
    buffer_load_dword v17, v4, s[4:7], s43 offen offset:512 sc1
    s_add_u32 s49, s49, 1
    s_waitcnt vmcnt(0)
    v_cmp_ne_u32 vcc, s51, v17
    s_cmp_gt_u32 s49, 0x2000
    s_cbranch_scc1 L_pollb_100055
    s_cbranch_vccnz L_polll_100056
L_pollb_100055:
    buffer_inv sc1
    s_waitcnt vmcnt(0)
    v_mfma_f32_32x32x16_bf16 v[64:79], a[88:91], v[224:227], v[64:79]
    buffer_load_dwordx4 a[248:251], v1, s[4:7], s96 offen sc1
    v_mfma_f32_32x32x16_bf16 v[80:95], a[92:95], v[224:227], v[80:95]
    v_mfma_f32_32x32x16_bf16 v[64:79], a[144:147], v[228:231], v[64:79]
    buffer_load_dwordx4 a[252:255], v1, s[4:7], s96 offen offset:1024 sc1
    v_mfma_f32_32x32x16_bf16 v[80:95], a[148:151], v[228:231], v[80:95]
    v_mfma_f32_32x32x16_bf16 v[64:79], a[200:203], v[232:235], v[64:79]
    buffer_load_dwordx4 v[128:131], v1, s[4:7], s96 offen offset:2048 sc1
    v_mfma_f32_32x32x16_bf16 v[80:95], a[204:207], v[232:235], v[80:95]
    v_mfma_f32_32x32x16_bf16 v[64:79], a[0:3], v[236:239], v[64:79]
    buffer_load_dwordx4 v[132:135], v1, s[4:7], s96 offen offset:3072 sc1
    s_add_u32 s96, s37, 13746176
    v_mfma_f32_32x32x16_bf16 v[80:95], a[4:7], v[236:239], v[80:95]
    v_mfma_f32_32x32x16_bf16 v[64:79], a[56:59], v[240:243], v[64:79]
    buffer_load_dwordx4 v[136:139], v1, s[4:7], s97 offen sc1
    v_mfma_f32_32x32x16_bf16 v[80:95], a[60:63], v[240:243], v[80:95]
    v_mfma_f32_32x32x16_bf16 v[64:79], a[112:115], v[244:247], v[64:79]
    buffer_load_dwordx4 v[140:143], v1, s[4:7], s97 offen offset:1024 sc1
    v_mfma_f32_32x32x16_bf16 v[80:95], a[116:119], v[244:247], v[80:95]
    v_mfma_f32_32x32x16_bf16 v[64:79], a[168:171], v[248:251], v[64:79]
    buffer_load_dwordx4 v[144:147], v1, s[4:7], s97 offen offset:2048 sc1
    v_mfma_f32_32x32x16_bf16 v[80:95], a[172:175], v[248:251], v[80:95]
    v_mfma_f32_32x32x16_bf16 v[112:127], a[24:27], v[252:255], v[112:127]
    buffer_load_dwordx4 v[148:151], v1, s[4:7], s97 offen offset:3072 sc1
    s_add_u32 s97, s37, 13750272
    v_mfma_f32_32x32x16_bf16 v[96:111], a[28:31], v[252:255], v[96:111]
    v_mfma_f32_32x32x16_bf16 v[112:127], a[80:83], a[236:239], v[112:127]
    buffer_load_dwordx4 v[152:155], v1, s[4:7], s96 offen sc1
    v_mfma_f32_32x32x16_bf16 v[96:111], a[84:87], a[236:239], v[96:111]
    v_mfma_f32_32x32x16_bf16 v[112:127], a[136:139], a[240:243], v[112:127]
    buffer_load_dwordx4 v[156:159], v1, s[4:7], s96 offen offset:1024 sc1
    v_mfma_f32_32x32x16_bf16 v[96:111], a[140:143], a[240:243], v[96:111]
    v_mfma_f32_32x32x16_bf16 v[112:127], a[192:195], a[244:247], v[112:127]
    buffer_load_dwordx4 v[160:163], v1, s[4:7], s96 offen offset:2048 sc1
    v_mfma_f32_32x32x16_bf16 v[96:111], a[196:199], a[244:247], v[96:111]
    s_waitcnt vmcnt(10)
    v_mfma_f32_32x32x16_bf16 v[64:79], a[8:11], a[248:251], v[64:79]
    buffer_load_dwordx4 v[164:167], v1, s[4:7], s96 offen offset:3072 sc1
    v_mfma_f32_32x32x16_bf16 v[80:95], a[12:15], a[248:251], v[80:95]
    s_waitcnt vmcnt(10)
    v_mfma_f32_32x32x16_bf16 v[64:79], a[64:67], a[252:255], v[64:79]
    buffer_load_dwordx4 v[168:171], v1, s[4:7], s97 offen sc1
    v_mfma_f32_32x32x16_bf16 v[80:95], a[68:71], a[252:255], v[80:95]
    s_waitcnt vmcnt(10)
    v_mfma_f32_32x32x16_bf16 v[64:79], a[120:123], v[128:131], v[64:79]
    buffer_load_dwordx4 v[172:175], v1, s[4:7], s97 offen offset:1024 sc1
    v_mfma_f32_32x32x16_bf16 v[80:95], a[124:127], v[128:131], v[80:95]
    s_waitcnt vmcnt(10)
    v_mfma_f32_32x32x16_bf16 v[80:95], a[180:183], v[132:135], v[80:95]
    buffer_load_dwordx4 v[176:179], v1, s[4:7], s97 offen offset:2048 sc1
    v_mfma_f32_32x32x16_bf16 v[64:79], a[176:179], v[132:135], v[64:79]
    s_waitcnt vmcnt(10)
    v_mfma_f32_32x32x16_bf16 v[112:127], a[32:35], v[136:139], v[112:127]
    buffer_load_dwordx4 v[180:183], v1, s[4:7], s97 offen offset:3072 sc1
    v_and_b32 v28, 31, v0
    v_lshlrev_b32 v28, 10, v28
    v_bfe_u32 v29, v0, 5, 1
    v_lshl_add_u32 v28, v29, 4, v28
    v_mfma_f32_32x32x16_bf16 v[96:111], a[36:39], v[136:139], v[96:111]
    s_lshl_b32 s30, s18, 17
    s_lshl_b32 s25, s19, 16
    s_add_u32 s30, s30, s25
    s_and_b32 s25, s16, 1
    s_lshl_b32 s25, s25, 1
    s_lshr_b32 s26, s16, 1
    s_waitcnt vmcnt(10)
    v_mfma_f32_32x32x16_bf16 v[112:127], a[88:91], v[140:143], v[112:127]
    s_add_u32 s25, s25, s26
    s_lshl_b32 s26, s20, 2
    s_add_u32 s25, s25, s26
    s_lshl_b32 s25, s25, 5
    s_add_u32 s30, s30, s25
    v_mfma_f32_32x32x16_bf16 v[96:111], a[92:95], v[140:143], v[96:111]
    s_waitcnt vmcnt(9)
    v_mfma_f32_32x32x16_bf16 v[112:127], a[144:147], v[144:147], v[112:127]
    ds_write_b128 v13, v[80:83] offset:0
    ds_write_b128 v13, v[84:87] offset:1024
    v_mfma_f32_32x32x16_bf16 v[96:111], a[148:151], v[144:147], v[96:111]
    ds_write_b128 v15, v[88:91] offset:0
    ds_write_b128 v15, v[92:95] offset:1024
    ds_write_b128 v14, v[72:75] offset:0
    s_waitcnt vmcnt(8)
    v_mfma_f32_32x32x16_bf16 v[112:127], a[200:203], v[148:151], v[112:127]
    ds_write_b128 v14, v[76:79] offset:1024
    v_mfma_f32_32x32x16_bf16 v[96:111], a[204:207], v[148:151], v[96:111]
    s_waitcnt lgkmcnt(0)
    s_barrier
    s_waitcnt vmcnt(7)
    v_mfma_f32_32x32x16_bf16 v[112:127], a[0:3], v[152:155], v[112:127]
    ds_read_b128 v[32:35], v16 offset:0
    ds_read_b128 v[36:39], v16 offset:1024
    ds_read_b128 v[40:43], v16 offset:2048
    ds_read_b128 v[44:47], v16 offset:3072
    ds_read_b128 v[48:51], v16 offset:4096
    v_mfma_f32_32x32x16_bf16 v[96:111], a[4:7], v[152:155], v[96:111]
    ds_read_b128 v[52:55], v16 offset:5120
    s_waitcnt vmcnt(6)
    v_mfma_f32_32x32x16_bf16 v[112:127], a[56:59], v[156:159], v[112:127]
    v_mfma_f32_32x32x16_bf16 v[96:111], a[60:63], v[156:159], v[96:111]
    s_waitcnt vmcnt(5)
    v_mfma_f32_32x32x16_bf16 v[112:127], a[112:115], v[160:163], v[112:127]
    s_waitcnt lgkmcnt(0)
    v_add_f32 v32, v32, v40
    v_add_f32 v33, v33, v41
    v_add_f32 v34, v34, v42
    v_add_f32 v35, v35, v43
    v_mfma_f32_32x32x16_bf16 v[96:111], a[116:119], v[160:163], v[96:111]
    v_add_f32 v36, v36, v44
    v_add_f32 v37, v37, v45
    v_add_f32 v38, v38, v46
    v_add_f32 v39, v39, v47
    v_add_f32 v64, v64, v48
    v_add_f32 v65, v65, v49
    s_waitcnt vmcnt(4)
    v_mfma_f32_32x32x16_bf16 v[112:127], a[168:171], v[164:167], v[112:127]
    v_add_f32 v66, v66, v50
    v_add_f32 v67, v67, v51
    v_add_f32 v68, v68, v52
    v_add_f32 v69, v69, v53
    v_add_f32 v70, v70, v54
    v_mfma_f32_32x32x16_bf16 v[96:111], a[172:175], v[164:167], v[96:111]
    v_add_f32 v71, v71, v55
    v_lshlrev_b32 v40, 16, v20
    v_and_b32 v41, s31, v20
    v_lshlrev_b32 v42, 16, v21
    v_and_b32 v43, s31, v21
    v_lshlrev_b32 v44, 16, v22
    s_waitcnt vmcnt(3)
    v_mfma_f32_32x32x16_bf16 v[112:127], a[8:11], v[168:171], v[112:127]
    v_and_b32 v45, s31, v22
    v_lshlrev_b32 v46, 16, v23
    v_and_b32 v47, s31, v23
    v_add_f32 v64, v64, v32
    v_add_f32 v65, v65, v33
    v_mfma_f32_32x32x16_bf16 v[96:111], a[12:15], v[168:171], v[96:111]
    v_add_f32 v66, v66, v34
    v_add_f32 v67, v67, v35
    v_add_f32 v68, v68, v36
    v_add_f32 v69, v69, v37
    v_add_f32 v70, v70, v38
    v_add_f32 v71, v71, v39
    s_waitcnt vmcnt(2)
    v_mfma_f32_32x32x16_bf16 v[112:127], a[64:67], v[172:175], v[112:127]
    v_fma_f32 v64, v64, s98, v40
    v_fma_f32 v65, v65, s98, v41
    v_fma_f32 v66, v66, s98, v42
    v_fma_f32 v67, v67, s98, v43
    v_fma_f32 v68, v68, s98, v44
    v_mfma_f32_32x32x16_bf16 v[96:111], a[68:71], v[172:175], v[96:111]
    v_fma_f32 v69, v69, s98, v45
    v_fma_f32 v70, v70, s98, v46
    v_fma_f32 v71, v71, s98, v47
    v_cvt_pk_bf16_f32 v32, v64, v65
    v_cvt_pk_bf16_f32 v33, v66, v67
    v_cvt_pk_bf16_f32 v34, v68, v69
    s_waitcnt vmcnt(1)
    v_mfma_f32_32x32x16_bf16 v[112:127], a[120:123], v[176:179], v[112:127]
    s_barrier
    v_cvt_pk_bf16_f32 v35, v70, v71
    v_mfma_f32_32x32x16_bf16 v[96:111], a[124:127], v[176:179], v[96:111]
    s_mov_b32 s46, s30
    buffer_store_dwordx4 v[32:35], v28, s[12:15], s46 offen
    s_waitcnt vmcnt(1)
    v_mfma_f32_32x32x16_bf16 v[96:111], a[180:183], v[180:183], v[96:111]
    v_mfma_f32_32x32x16_bf16 v[112:127], a[176:179], v[180:183], v[112:127]
    s_nop 10
    ds_write_b128 v13, v[96:99] offset:0
    ds_write_b128 v13, v[100:103] offset:1024
    ds_write_b128 v15, v[104:107] offset:0
    ds_write_b128 v15, v[108:111] offset:1024
    ds_write_b128 v14, v[120:123] offset:0
    ds_write_b128 v14, v[124:127] offset:1024
    s_waitcnt lgkmcnt(0)
    s_barrier
    ds_read_b128 v[32:35], v16 offset:0
    ds_read_b128 v[36:39], v16 offset:1024
    ds_read_b128 v[40:43], v16 offset:2048
    ds_read_b128 v[44:47], v16 offset:3072
    ds_read_b128 v[48:51], v16 offset:4096
    ds_read_b128 v[52:55], v16 offset:5120
    s_waitcnt lgkmcnt(0)
    v_pk_add_f32 v[32:33], v[32:33], v[40:41]
    v_pk_add_f32 v[34:35], v[34:35], v[42:43]
    v_pk_add_f32 v[36:37], v[36:37], v[44:45]
    v_pk_add_f32 v[38:39], v[38:39], v[46:47]
    v_pk_add_f32 v[112:113], v[112:113], v[48:49]
    v_pk_add_f32 v[114:115], v[114:115], v[50:51]
    v_pk_add_f32 v[116:117], v[116:117], v[52:53]
    v_pk_add_f32 v[118:119], v[118:119], v[54:55]
    v_pk_add_f32 v[112:113], v[112:113], v[32:33]
    v_pk_add_f32 v[114:115], v[114:115], v[34:35]
    v_pk_add_f32 v[116:117], v[116:117], v[36:37]
    v_pk_add_f32 v[118:119], v[118:119], v[38:39]
    v_pk_fma_f32 v[112:113], v[112:113], s[98:99], v[56:57]
    v_pk_fma_f32 v[114:115], v[114:115], s[98:99], v[58:59]
    v_pk_fma_f32 v[116:117], v[116:117], s[98:99], v[60:61]
    v_pk_fma_f32 v[118:119], v[118:119], s[98:99], v[62:63]
    v_cvt_pk_bf16_f32 v32, v112, v113
    v_cvt_pk_bf16_f32 v33, v114, v115
    v_cvt_pk_bf16_f32 v34, v116, v117
    v_cvt_pk_bf16_f32 v35, v118, v119
    s_add_u32 s46, s30, 32768
    buffer_store_dwordx4 v[32:35], v28, s[12:15], s46 offen
    s_waitcnt vmcnt(0)
    s_branch L_fin
L_mks_100003:
    s_mov_b32 s49, 0
L_mkl_100005:
    v_cmp_eq_u32 vcc, -1, v64
    s_cbranch_vccz L_mkn_100006
    buffer_load_dwordx4 v[64:67], v1, s[4:7], s72 offen sc1
L_mkn_100006:
    v_cmp_eq_u32 vcc, -1, v68
    s_cbranch_vccz L_mkn_100007
    buffer_load_dwordx4 v[68:71], v1, s[4:7], s72 offen offset:1024 sc1
L_mkn_100007:
    v_cmp_eq_u32 vcc, -1, v72
    s_cbranch_vccz L_mkn_100008
    buffer_load_dwordx4 v[72:75], v1, s[4:7], s72 offen offset:2048 sc1
L_mkn_100008:
    v_cmp_eq_u32 vcc, -1, v76
    s_cbranch_vccz L_mkn_100009
    buffer_load_dwordx4 v[76:79], v1, s[4:7], s72 offen offset:3072 sc1
L_mkn_100009:
    s_add_u32 s49, s49, 1
    s_waitcnt vmcnt(0)
    v_max3_u32 v31, v64, v68, v72
    v_max_u32 v31, v31, v76
    v_cmp_eq_u32 vcc, -1, v31
    s_cmp_gt_u32 s49, 0x2000
    s_cbranch_vccz L_mkb_100004
    s_cbranch_scc0 L_mkl_100005
    s_branch L_mkb_100004
L_afs_100010:
    s_mov_b32 s49, 0
L_afl_100012:
    buffer_load_dwordx4 v[24:27], v253, s[4:7], 0 offen sc1
    s_add_u32 s49, s49, 1
    s_waitcnt vmcnt(0)
    v_xor_b32 v24, s51, v24
    v_xor_b32 v25, s51, v25
    v_xor_b32 v26, s51, v26
    v_xor_b32 v27, s51, v27
    v_or3_b32 v24, v24, v25, v26
    v_or_b32 v24, v24, v27
    v_cmp_ne_u32 vcc, 0, v24
    s_nop 4
    s_cbranch_vccz L_afb_100011
    s_cmp_lt_u32 s49, 8192
    s_cbranch_scc1 L_afl_100012
    s_branch L_afb_100011
L_qs_100013:
    s_mov_b32 s49, 0
    s_mov_b32 s25, 24576
L_ql_100015:
    buffer_load_dword v17, v30, s[4:7], s25 offen sc1
    s_add_u32 s49, s49, 1
    s_waitcnt vmcnt(0)
    v_cmp_ne_u32 vcc, s51, v17
    s_nop 4
    s_cbranch_vccz L_qb_100014
    s_cmp_lt_u32 s49, 0x2000
    s_cbranch_scc1 L_ql_100015
    s_branch L_qb_100014
L_mks_100016:
    s_mov_b32 s49, 0
L_mkl_100018:
    v_cmp_eq_u32 vcc, -1, v136
    s_cbranch_vccz L_mkn_100019
    buffer_load_dword v136, v10, s[4:7], s59 offen sc1
L_mkn_100019:
    v_cmp_eq_u32 vcc, -1, v137
    s_cbranch_vccz L_mkn_100020
    buffer_load_dword v137, v10, s[4:7], s59 offen offset:512 sc1
L_mkn_100020:
    v_cmp_eq_u32 vcc, -1, v138
    s_cbranch_vccz L_mkn_100021
    buffer_load_dword v138, v10, s[4:7], s59 offen offset:1024 sc1
L_mkn_100021:
    v_cmp_eq_u32 vcc, -1, v139
    s_cbranch_vccz L_mkn_100022
    buffer_load_dword v139, v10, s[4:7], s59 offen offset:1536 sc1
L_mkn_100022:
    v_cmp_eq_u32 vcc, -1, v140
    s_cbranch_vccz L_mkn_100023
    buffer_load_dword v140, v10, s[4:7], s24 offen sc1
L_mkn_100023:
    v_cmp_eq_u32 vcc, -1, v141
    s_cbranch_vccz L_mkn_100024
    buffer_load_dword v141, v10, s[4:7], s24 offen offset:512 sc1
L_mkn_100024:
    v_cmp_eq_u32 vcc, -1, v142
    s_cbranch_vccz L_mkn_100025
    buffer_load_dword v142, v10, s[4:7], s24 offen offset:1024 sc1
L_mkn_100025:
    v_cmp_eq_u32 vcc, -1, v143
    s_cbranch_vccz L_mkn_100026
    buffer_load_dword v143, v10, s[4:7], s24 offen offset:1536 sc1
L_mkn_100026:
    s_add_u32 s49, s49, 1
    s_waitcnt vmcnt(0)
    v_max3_u32 v31, v136, v137, v138
    v_max3_u32 v31, v31, v139, v140
    v_max3_u32 v31, v31, v141, v142
    v_max_u32 v31, v31, v143
    v_cmp_eq_u32 vcc, -1, v31
    s_cmp_gt_u32 s49, 0x2000
    s_cbranch_vccz L_mkb_100017
    s_cbranch_scc0 L_mkl_100018
    s_branch L_mkb_100017
L_qs_100027:
    s_mov_b32 s49, 0
    s_mov_b32 s25, 98304
L_ql_100029:
    buffer_load_dword v17, v30, s[4:7], s25 offen sc1
    s_add_u32 s49, s49, 1
    s_waitcnt vmcnt(0)
    v_cmp_ne_u32 vcc, s51, v17
    s_nop 4
    s_cbranch_vccz L_qb_100028
    s_cmp_lt_u32 s49, 0x2000
    s_cbranch_scc1 L_ql_100029
    s_branch L_qb_100028
    s_endpgm
.section .rodata,"a"
.p2align 6
.amdhsa_kernel interleave_layers__ssm_conv_h3__glu_gated_glu__prompt_kernel
  .amdhsa_next_free_vgpr 512
  .amdhsa_next_free_sgpr 102
  .amdhsa_accum_offset 256
  .amdhsa_group_segment_fixed_size 0
  .amdhsa_kernarg_size 104
  .amdhsa_user_sgpr_count 2
  .amdhsa_user_sgpr_kernarg_segment_ptr 1
  .amdhsa_system_sgpr_workgroup_id_x 1
.end_amdhsa_kernel
.text
.text
.fill 64, 4, 0xbf800000
```
